```python
import torch

def _softmax(x, axis=-1):
    return torch.softmax(x, dim=axis)
def _gelu(x):
    return torch.nn.functional.gelu(x, approximate="tanh")
def _silu(x):
    return torch.nn.functional.silu(x)
def _sigmoid(x):
    return torch.sigmoid(x)
def _layernorm(x, axis=-1, eps=1e-5):
    m = x.mean(dim=axis, keepdim=True)
    v = x.var(dim=axis, keepdim=True, unbiased=False)
    return (x - m) / torch.sqrt(v + eps)
def _scatter_add(tgt, idx, src, axis=0):
    return tgt.clone().index_add_(axis, idx, src)
def _segment_sum(src, seg, n):
    out = torch.zeros((n,) + src.shape[1:], dtype=src.dtype)
    return out.index_add_(0, seg, src)
def _pad(x, pw):
    flat = tuple(v for pair in reversed(pw) for v in pair)
    return torch.nn.functional.pad(x, flat)

kernel_name = 'recurrent_scan__compressed_kv_cla__glu_gated_glu__prompt'

def setup_inputs():

    _w = (lambda a: (lambda t: t.to(torch.bfloat16) if t.is_floating_point() else t)(torch.as_tensor(a)))
    def _A_setup():
        B, H, Sq, Sk, D, M = 1, 32, 2048, 2048, 128, 512
        Dc = 4 * D
        return {
            "x": _w((lambda *s: torch.randn(*s, dtype=torch.bfloat16) * 0.05)(B, Sq, M)),
            "c_kv": _w((lambda *s: torch.randn(*s, dtype=torch.bfloat16) * 0.2)(B, Sk, Dc)),
            "w_q": _w((lambda *s: torch.randn(*s, dtype=torch.bfloat16) * 3.2)(M, H, D) * (M ** -0.5)),
            "w_uk": _w((lambda *s: torch.randn(*s, dtype=torch.bfloat16) * 3.2)(Dc, H, D) * (Dc ** -0.5)),
            "w_uv": _w((lambda *s: torch.randn(*s, dtype=torch.bfloat16) * 0.2)(Dc, H, D) * (Dc ** -0.5)),
            "w_o": _w((lambda *s: torch.randn(*s, dtype=torch.bfloat16) * 0.2)(H, D, M) * ((H * D) ** -0.5)),
        }
    _A_in = _A_setup()

    def _B_setup():
        B, S, D, F = 1, 2048, 512, 1792
        return {
            "x": _w((lambda *s: torch.randn(*s, dtype=torch.bfloat16) * 0.05)(B, S, D)),
            "w_gate": _w((lambda *s: torch.randn(*s, dtype=torch.bfloat16) * 0.2)(D, F)),
            "w_up": _w((lambda *s: torch.randn(*s, dtype=torch.bfloat16) * 0.1)(D, F)),
            "w_down": _w((lambda *s: torch.randn(*s, dtype=torch.bfloat16) * 0.1)(F, D)),
        }
    _B_in = _B_setup()

    return {
        "A_x": _A_in["x"],
        "A_c_kv": _A_in["c_kv"],
        "A_w_q": _A_in["w_q"],
        "A_w_uk": _A_in["w_uk"],
        "A_w_uv": _A_in["w_uv"],
        "A_w_o": _A_in["w_o"],
        "B_x": _B_in["x"],
        "B_w_gate": _B_in["w_gate"],
        "B_w_up": _B_in["w_up"],
        "B_w_down": _B_in["w_down"],
    }

def reference(A_x, A_c_kv, A_w_q, A_w_uk, A_w_uv, A_w_o, B_x, B_w_gate, B_w_up, B_w_down):
    def _A_ref(x, c_kv, w_q, w_uk, w_uv, w_o):
        B, Sq, M = x.shape[0], x.shape[1], x.shape[2]
        Sk = c_kv.shape[1]
        H, D = w_q.shape[1], w_q.shape[2]
        q = torch.einsum("bqm,mhd->bhqd", x, w_q)
        k = torch.einsum("bkc,chd->bhkd", c_kv, w_uk)
        v = torch.einsum("bkc,chd->bhkd", c_kv, w_uv)
        scores = torch.einsum("bhqd,bhkd->bhqk", q, k) * (D ** -0.5)
        off = Sk - Sq
        qi = torch.arange(Sq)[:, None]
        kj = torch.arange(Sk)[None, :]
        cmask = kj <= (qi + off)
        scores = torch.where(cmask[None, None], scores, -1e9)
        p = _softmax(scores, axis=-1)
        ctx = torch.einsum("bhqk,bhkd->bhqd", p, v)
        return torch.einsum("bhqd,hdm->bqm", ctx, w_o)

    def _B_ref(x, w_gate, w_up, w_down):
        g = torch.einsum("bsd,df->bsf", x, w_gate)
        u = torch.einsum("bsd,df->bsf", x, w_up)
        h = _sigmoid(g) * u
        return torch.einsum("bsf,fd->bsd", h, w_down)

    x = A_x
    xn = _layernorm(x, axis=-1)
    s = _A_ref(xn, A_c_kv, A_w_q, A_w_uk, A_w_uv, A_w_o)
    g = _silu(_B_ref(xn, B_w_gate, B_w_up, B_w_down))
    return x + s * g
```

```asm
; @launch kernel=k2_kernel grid=(256,1,1) block=(512,1,1) lds=163840
.amdgcn_target "amdgcn-amd-amdhsa--gfx950"
.text
.globl k2_kernel
.p2align 8
.type k2_kernel,@function
k2_kernel:
    s_cmp_ge_u32 s2, 256
    s_cbranch_scc1 k2_kernel_end
    s_load_dwordx16 s[8:23], s[0:1], 0
    s_load_dwordx8 s[24:31], s[0:1], 64
    s_load_dwordx2 s[32:33], s[0:1], 96
    v_and_b32 v224, 63, v0
    v_lshrrev_b32 v240, 6, v0
    s_nop 0
    v_readfirstlane_b32 s34, v240
    s_and_b32 s35, s2, 7
    s_lshl_b32 s35, s35, 2
    s_bfe_u32 s37, s2, 0x20003
    s_add_u32 s35, s35, s37
    s_lshr_b32 s36, s2, 5
    s_lshl_b32 s54, s2, 3
    s_add_u32 s54, s54, s34
    v_lshrrev_b32 v240, 5, v224
    v_lshlrev_b32 v237, 10, v240
    v_bfe_u32 v240, v224, 2, 2
    v_lshl_add_u32 v237, v240, 7, v237
    v_bfe_u32 v240, v224, 3, 1
    v_lshl_add_u32 v237, v240, 6, v237
    v_bfe_u32 v240, v224, 4, 1
    v_lshl_add_u32 v237, v240, 5, v237
    v_and_b32 v240, 3, v224
    v_lshl_add_u32 v237, v240, 3, v237
    v_add_u32 v237, 0x18000, v237
    v_xor_b32 v238, 64, v237
    s_lshl_b32 s38, s35, 8
    v_lshrrev_b32 v240, 3, v224
    s_lshl_b32 s37, s34, 3
    v_add_u32 v240, s37, v240
    s_movk_i32 s37, 8192
    v_mul_lo_u32 v226, v240, s37
    v_and_b32 v240, 7, v224
    v_lshl_add_u32 v226, v240, 4, v226
    v_bfe_u32 v240, v224, 4, 1
    v_lshlrev_b32 v240, 6, v240
    v_xor_b32 v226, v226, v240
    v_add_u32 v226, s38, v226
    v_lshrrev_b32 v240, 3, v224
    v_lshrrev_b32 v241, 4, v224
    v_and_b32 v242, 7, v224
    v_xor_b32 v241, v241, v242
    v_lshlrev_b32 v241, 4, v241
    v_lshl_add_u32 v225, v240, 10, v241
    v_xor_b32 v239, 64, v225
    s_mul_i32 s49, s34, 12288
    s_lshl_b32 s39, s34, 10
    s_add_u32 s39, s39, 98304
    s_lshl_b32 s50, s36, 3
    s_add_u32 s50, s50, s34
    s_lshl_b32 s50, s50, 15
    v_lshlrev_b32 v228, 4, v224
    s_waitcnt lgkmcnt(0)
    s_mov_b32 s72, s8
    s_mov_b32 s73, s9
    s_mov_b32 s74, 0x200000
    s_mov_b32 s75, 0x00020000
    s_mov_b32 s80, s10
    s_mov_b32 s81, s11
    s_mov_b32 s82, 0x200000
    s_mov_b32 s83, 0x00020000
    s_mov_b32 s68, s14
    s_mov_b32 s69, s15
    s_mov_b32 s70, 0x400000
    s_mov_b32 s71, 0x00020000
    s_lshl_b32 s37, s54, 10
    buffer_load_dwordx4 v[244:247], v228, s[72:75], s37 offen
    s_add_u32 s55, s36, 0
    s_and_b32 s55, s55, 7
    s_lshl_b32 s55, s55, 7
    s_add_u32 s55, s55, s50
    s_add_u32 m0, s49, 0x0
    s_nop 0
    buffer_load_dwordx4 v225, s[80:83], s55 offen lds
    s_add_u32 s55, s55, 8192
    s_add_u32 m0, s49, 0x400
    s_nop 0
    buffer_load_dwordx4 v239, s[80:83], s55 offen lds
    s_add_u32 s55, s55, 8192
    s_add_u32 m0, s49, 0x800
    s_nop 0
    buffer_load_dwordx4 v225, s[80:83], s55 offen lds
    s_add_u32 s55, s55, 8192
    s_add_u32 m0, s49, 0xc00
    s_nop 0
    buffer_load_dwordx4 v239, s[80:83], s55 offen lds
    s_add_u32 s37, s36, 0
    s_and_b32 s37, s37, 7
    s_mul_i32 s37, s37, 0x80000
    s_add_u32 m0, s39, 0x0
    s_nop 0
    buffer_load_dwordx4 v226, s[68:71], s37 offen offset:0 lds
    s_add_u32 m0, s39, 0x1f80
    s_nop 0
    buffer_load_dwordx4 v226, s[68:71], s37 offen offset:128 lds
    s_mov_b32 s64, s16
    s_mov_b32 s65, s17
    s_mov_b32 s66, 0x400000
    s_mov_b32 s67, 0x00020000
    s_mov_b32 s60, s32
    s_mov_b32 s61, s33
    s_mov_b32 s62, 0x200000
    s_mov_b32 s63, 0x00020000
    s_add_u32 s76, s32, 0x200000
    s_addc_u32 s77, s33, 0
    s_mov_b32 s78, 0x2000000
    s_mov_b32 s79, 0x00020000
    s_add_u32 s84, s32, 0x4600000
    s_addc_u32 s85, s33, 0
    s_mov_b32 s86, 0x10000
    s_mov_b32 s87, 0x00020000
    v_and_b32 v240, 31, v224
    v_bfe_u32 v241, v224, 1, 3
    v_lshrrev_b32 v242, 5, v224
    v_xor_b32 v241, v241, v242
    v_lshlrev_b32 v241, 4, v241
    v_lshl_add_u32 v240, v240, 7, v241
    v_add_u32 v229, s49, v240
    v_xor_b32 v230, 32, v229
    v_xor_b32 v231, 64, v229
    v_xor_b32 v232, 96, v229
    s_lshl_b32 s37, s35, 20
    s_lshl_b32 s38, s36, 17
    s_add_u32 s37, s37, s38
    s_lshr_b32 s38, s34, 1
    s_lshl_b32 s38, s38, 15
    s_add_u32 s37, s37, s38
    s_and_b32 s38, s34, 1
    s_lshl_b32 s38, s38, 13
    s_add_u32 s37, s37, s38
    v_add_u32 v233, s37, v228
    s_lshr_b32 s41, s34, 2
    s_and_b32 s42, s34, 3
    s_sub_u32 s37, 15, s36
    s_cmp_eq_u32 s41, 0
    s_cselect_b32 s40, s37, s36
    s_lshl_b32 s40, s40, 2
    s_add_u32 s40, s40, s42
    s_lshl_b32 s52, s37, 2
    s_add_u32 s52, s52, s42
    s_min_u32 s44, s35, 27
    s_lshl_b32 s38, s44, 7
    v_lshrrev_b32 v240, 3, v224
    s_lshl_b32 s37, s34, 3
    v_add_u32 v240, s37, v240
    s_movk_i32 s37, 3584
    v_mul_lo_u32 v227, v240, s37
    v_and_b32 v240, 7, v224
    v_lshl_add_u32 v227, v240, 4, v227
    v_bfe_u32 v240, v224, 4, 1
    v_lshlrev_b32 v240, 6, v240
    v_xor_b32 v227, v227, v240
    v_add_u32 v227, s38, v227
    s_lshl_b32 s51, s40, 15
    s_lshl_b32 s48, s35, 20
    s_lshl_b32 s37, s41, 15
    s_add_u32 s48, s48, s37
    s_lshl_b32 s46, s42, 11
    s_add_u32 s48, s48, s46
    s_lshl_b32 s37, s41, 14
    s_add_u32 s46, s46, s37
    s_add_u32 s47, s46, 65536
    s_cmp_ge_u32 s2, 8
    s_cbranch_scc1 k2_nz
    v_mov_b32 v252, 0
    v_mov_b32 v253, 0
    v_mov_b32 v254, 0
    v_mov_b32 v255, 0
    s_lshl_b32 s37, s54, 10
    buffer_store_dwordx4 v[252:255], v228, s[84:87], s37 offen sc1
k2_nz:
    s_waitcnt vmcnt(6)
    v_lshlrev_b32 v0, 16, v244
    v_and_b32 v1, 0xffff0000, v244
    v_lshlrev_b32 v2, 16, v245
    v_and_b32 v3, 0xffff0000, v245
    v_lshlrev_b32 v4, 16, v246
    v_and_b32 v5, 0xffff0000, v246
    v_lshlrev_b32 v6, 16, v247
    v_and_b32 v7, 0xffff0000, v247
    v_add_f32 v8, v0, v1
    v_add_f32 v8, v8, v2
    v_add_f32 v8, v8, v3
    v_add_f32 v8, v8, v4
    v_add_f32 v8, v8, v5
    v_add_f32 v8, v8, v6
    v_add_f32 v8, v8, v7
    s_nop 1
    v_add_f32_dpp v8, v8, v8 quad_perm:[1,0,3,2] row_mask:0xf bank_mask:0xf
    s_nop 1
    v_add_f32_dpp v8, v8, v8 quad_perm:[2,3,0,1] row_mask:0xf bank_mask:0xf
    s_nop 1
    v_add_f32_dpp v8, v8, v8 row_half_mirror row_mask:0xf bank_mask:0xf
    s_nop 1
    v_add_f32_dpp v8, v8, v8 row_mirror row_mask:0xf bank_mask:0xf
    v_mov_b32 v9, v8
    s_nop 1
    v_permlane16_swap_b32 v9, v8
    v_add_f32 v8, v8, v9
    v_mov_b32 v9, v8
    s_nop 1
    v_permlane32_swap_b32 v9, v8
    v_add_f32 v8, v8, v9
    v_mul_f32 v18, 0x3b000000, v8
    v_sub_f32 v10, v0, v18
    v_sub_f32 v11, v1, v18
    v_sub_f32 v12, v2, v18
    v_sub_f32 v13, v3, v18
    v_sub_f32 v14, v4, v18
    v_sub_f32 v15, v5, v18
    v_sub_f32 v16, v6, v18
    v_sub_f32 v17, v7, v18
    v_mul_f32 v8, v10, v10
    v_fmac_f32 v8, v11, v11
    v_fmac_f32 v8, v12, v12
    v_fmac_f32 v8, v13, v13
    v_fmac_f32 v8, v14, v14
    v_fmac_f32 v8, v15, v15
    v_fmac_f32 v8, v16, v16
    v_fmac_f32 v8, v17, v17
    s_nop 1
    v_add_f32_dpp v8, v8, v8 quad_perm:[1,0,3,2] row_mask:0xf bank_mask:0xf
    s_nop 1
    v_add_f32_dpp v8, v8, v8 quad_perm:[2,3,0,1] row_mask:0xf bank_mask:0xf
    s_nop 1
    v_add_f32_dpp v8, v8, v8 row_half_mirror row_mask:0xf bank_mask:0xf
    s_nop 1
    v_add_f32_dpp v8, v8, v8 row_mirror row_mask:0xf bank_mask:0xf
    v_mov_b32 v9, v8
    s_nop 1
    v_permlane16_swap_b32 v9, v8
    v_add_f32 v8, v8, v9
    v_mov_b32 v9, v8
    s_nop 1
    v_permlane32_swap_b32 v9, v8
    v_add_f32 v8, v8, v9
    v_mul_f32 v8, 0x3b000000, v8
    v_cvt_pk_bf16_f32 v8, v8, v8
    v_lshlrev_b32 v8, 16, v8
    v_add_f32 v8, 0x3727c5ac, v8
    v_cvt_pk_bf16_f32 v8, v8, v8
    v_lshlrev_b32 v8, 16, v8
    v_sqrt_f32 v8, v8
    s_nop 0
    v_cvt_pk_bf16_f32 v8, v8, v8
    v_lshlrev_b32 v8, 16, v8
    v_rcp_f32 v8, v8
    v_cvt_pk_bf16_f32 v18, v18, v18
    v_lshlrev_b32 v18, 16, v18
    v_sub_f32 v10, v0, v18
    v_sub_f32 v11, v1, v18
    v_sub_f32 v12, v2, v18
    v_sub_f32 v13, v3, v18
    v_sub_f32 v14, v4, v18
    v_sub_f32 v15, v5, v18
    v_sub_f32 v16, v6, v18
    v_sub_f32 v17, v7, v18
    v_cvt_pk_bf16_f32 v244, v10, v11
    v_cvt_pk_bf16_f32 v245, v12, v13
    v_cvt_pk_bf16_f32 v246, v14, v15
    v_cvt_pk_bf16_f32 v247, v16, v17
    v_lshlrev_b32 v0, 16, v244
    v_and_b32 v1, 0xffff0000, v244
    v_lshlrev_b32 v2, 16, v245
    v_and_b32 v3, 0xffff0000, v245
    v_lshlrev_b32 v4, 16, v246
    v_and_b32 v5, 0xffff0000, v246
    v_lshlrev_b32 v6, 16, v247
    v_and_b32 v7, 0xffff0000, v247
    v_mul_f32 v0, v0, v8
    v_mul_f32 v1, v1, v8
    v_mul_f32 v2, v2, v8
    v_mul_f32 v3, v3, v8
    v_mul_f32 v4, v4, v8
    v_mul_f32 v5, v5, v8
    v_mul_f32 v6, v6, v8
    v_mul_f32 v7, v7, v8
    v_cvt_pk_bf16_f32 v244, v0, v1
    v_cvt_pk_bf16_f32 v245, v2, v3
    v_cvt_pk_bf16_f32 v246, v4, v5
    v_cvt_pk_bf16_f32 v247, v6, v7
    v_lshrrev_b32 v240, 1, v224
    v_and_b32 v241, 1, v224
    v_lshlrev_b32 v241, 9, v241
    v_lshl_add_u32 v240, v240, 10, v241
    s_lshr_b32 s37, s54, 5
    s_lshl_b32 s37, s37, 15
    s_and_b32 s38, s54, 31
    s_lshl_b32 s38, s38, 4
    s_add_u32 s37, s37, s38
    s_lshl_b32 s38, s34, 4
    s_add_u32 s38, s38, 147456
    v_lshl_add_u32 v240, v224, 7, s38
    ds_write_b128 v240, v[244:247]
    v_add_u32 v241, s39, v228
    s_nop 0
    v_lshrrev_b32 v240, 3, v224
    v_and_b32 v242, 7, v224
    v_lshlrev_b32 v242, 4, v242
    v_lshl_add_u32 v240, v240, 9, v242
    s_lshr_b32 s59, s2, 2
    s_lshl_b32 s59, s59, 15
    s_and_b32 s38, s2, 3
    s_lshl_b32 s38, s38, 7
    s_add_u32 s59, s59, s38
    s_lshl_b32 s38, s34, 12
    s_add_u32 s59, s59, s38
    s_mov_b32 s72, s30
    s_mov_b32 s73, s31
    s_mov_b32 s74, 0x100
    s_mov_b32 s75, 0x00020000
    s_waitcnt vmcnt(0)
    s_waitcnt lgkmcnt(0)
    s_barrier
    ds_read_b128 v[244:247], v241 offset:49152
    ds_read_b128 v[64:67], v229 offset:0
    ds_read_b128 v[68:71], v230 offset:0
    ds_read_b128 v[72:75], v231 offset:0
    ds_read_b128 v[76:79], v232 offset:0
    s_add_u32 s55, s36, 1
    s_and_b32 s55, s55, 7
    s_lshl_b32 s55, s55, 7
    s_add_u32 s55, s55, s50
    s_add_u32 m0, s49, 0x1000
    s_nop 0
    buffer_load_dwordx4 v225, s[80:83], s55 offen lds
    s_add_u32 s55, s55, 8192
    s_add_u32 m0, s49, 0x1400
    s_nop 0
    buffer_load_dwordx4 v239, s[80:83], s55 offen lds
    s_add_u32 s55, s55, 8192
    s_add_u32 m0, s49, 0x1800
    s_nop 0
    buffer_load_dwordx4 v225, s[80:83], s55 offen lds
    s_add_u32 s55, s55, 8192
    s_add_u32 m0, s49, 0x1c00
    s_nop 0
    buffer_load_dwordx4 v239, s[80:83], s55 offen lds
    s_add_u32 s37, s36, 1
    s_and_b32 s37, s37, 7
    s_mul_i32 s37, s37, 0x80000
    s_add_u32 m0, s39, 0x4000
    s_nop 0
    buffer_load_dwordx4 v226, s[68:71], s37 offen offset:0 lds
    s_add_u32 m0, s39, 0x5f80
    s_nop 0
    buffer_load_dwordx4 v226, s[68:71], s37 offen offset:128 lds
    s_add_u32 s55, s36, 2
    s_and_b32 s55, s55, 7
    s_lshl_b32 s55, s55, 7
    s_add_u32 s55, s55, s50
    s_add_u32 m0, s49, 0x2000
    s_nop 0
    buffer_load_dwordx4 v225, s[80:83], s55 offen lds
    s_add_u32 s55, s55, 8192
    s_add_u32 m0, s49, 0x2400
    s_nop 0
    buffer_load_dwordx4 v239, s[80:83], s55 offen lds
    s_add_u32 s55, s55, 8192
    s_add_u32 m0, s49, 0x2800
    s_nop 0
    buffer_load_dwordx4 v225, s[80:83], s55 offen lds
    s_add_u32 s55, s55, 8192
    s_add_u32 m0, s49, 0x2c00
    s_nop 0
    buffer_load_dwordx4 v239, s[80:83], s55 offen lds
    s_add_u32 s37, s36, 2
    s_and_b32 s37, s37, 7
    s_mul_i32 s37, s37, 0x80000
    s_add_u32 m0, s39, 0x8000
    s_nop 0
    buffer_load_dwordx4 v226, s[68:71], s37 offen offset:0 lds
    s_add_u32 m0, s39, 0x9f80
    s_nop 0
    buffer_load_dwordx4 v226, s[68:71], s37 offen offset:128 lds
    s_waitcnt lgkmcnt(4)
    buffer_store_dwordx4 v[244:247], v240, s[60:63], s59 offen sc1
    ds_read_b64_tr_b16 v[192:193], v237 offset:0
    ds_read_b64_tr_b16 v[194:195], v237 offset:512
    ds_read_b64_tr_b16 v[196:197], v238 offset:0
    ds_read_b64_tr_b16 v[198:199], v238 offset:512
    ds_read_b64_tr_b16 v[200:201], v237 offset:8192
    ds_read_b64_tr_b16 v[202:203], v237 offset:8704
    ds_read_b64_tr_b16 v[204:205], v238 offset:8192
    ds_read_b64_tr_b16 v[206:207], v238 offset:8704
    s_waitcnt lgkmcnt(11)
    ds_read_b64_tr_b16 v[208:209], v237 offset:2048
    ds_read_b64_tr_b16 v[210:211], v237 offset:2560
    s_waitcnt lgkmcnt(8)
    v_mfma_f32_32x32x16_bf16 v[0:15], v[192:195], v[64:67], 0
    ds_read_b64_tr_b16 v[212:213], v238 offset:2048
    ds_read_b64_tr_b16 v[214:215], v238 offset:2560
    s_waitcnt lgkmcnt(8)
    v_mfma_f32_32x32x16_bf16 v[16:31], v[196:199], v[64:67], 0
    ds_read_b64_tr_b16 v[216:217], v237 offset:10240
    ds_read_b64_tr_b16 v[218:219], v237 offset:10752
    s_waitcnt lgkmcnt(8)
    v_mfma_f32_32x32x16_bf16 v[32:47], v[200:203], v[64:67], 0
    ds_read_b64_tr_b16 v[220:221], v238 offset:10240
    ds_read_b64_tr_b16 v[222:223], v238 offset:10752
    s_waitcnt lgkmcnt(8)
    v_mfma_f32_32x32x16_bf16 v[48:63], v[204:207], v[64:67], 0
    ds_read_b64_tr_b16 v[192:193], v237 offset:4096
    ds_read_b64_tr_b16 v[194:195], v237 offset:4608
    s_waitcnt lgkmcnt(8)
    v_mfma_f32_32x32x16_bf16 v[0:15], v[208:211], v[68:71], v[0:15]
    ds_read_b64_tr_b16 v[196:197], v238 offset:4096
    ds_read_b64_tr_b16 v[198:199], v238 offset:4608
    s_waitcnt lgkmcnt(8)
    v_mfma_f32_32x32x16_bf16 v[16:31], v[212:215], v[68:71], v[16:31]
    ds_read_b64_tr_b16 v[200:201], v237 offset:12288
    ds_read_b64_tr_b16 v[202:203], v237 offset:12800
    s_waitcnt lgkmcnt(8)
    v_mfma_f32_32x32x16_bf16 v[32:47], v[216:219], v[68:71], v[32:47]
    ds_read_b64_tr_b16 v[204:205], v238 offset:12288
    ds_read_b64_tr_b16 v[206:207], v238 offset:12800
    s_waitcnt lgkmcnt(8)
    v_mfma_f32_32x32x16_bf16 v[48:63], v[220:223], v[68:71], v[48:63]
    s_waitcnt vmcnt(7)
    s_barrier
    s_lshr_b32 s6, s2, 3
    s_or_b32 s6, s6, s34
    s_cmp_lg_u32 s6, 0
    s_cbranch_scc1 k2_w1
    s_lshl_b32 s38, s2, 2
    v_mov_b32 v250, 1
    s_mov_b64 exec, 1
    buffer_store_dword v250, off, s[72:75], s38 sc1
    s_mov_b64 exec, -1
k2_w1:
    ds_read_b128 v[80:83], v229 offset:4096
    ds_read_b128 v[84:87], v230 offset:4096
    ds_read_b128 v[88:91], v231 offset:4096
    ds_read_b128 v[92:95], v232 offset:4096
    s_add_u32 s55, s36, 3
    s_and_b32 s55, s55, 7
    s_lshl_b32 s55, s55, 7
    s_add_u32 s55, s55, s50
    s_add_u32 m0, s49, 0x0
    s_nop 0
    buffer_load_dwordx4 v225, s[80:83], s55 offen lds
    ds_read_b64_tr_b16 v[208:209], v237 offset:6144
    ds_read_b64_tr_b16 v[210:211], v237 offset:6656
    s_waitcnt lgkmcnt(12)
    v_mfma_f32_32x32x16_bf16 v[0:15], v[192:195], v[72:75], v[0:15]
    ds_read_b64_tr_b16 v[212:213], v238 offset:6144
    ds_read_b64_tr_b16 v[214:215], v238 offset:6656
    s_waitcnt lgkmcnt(12)
    v_mfma_f32_32x32x16_bf16 v[16:31], v[196:199], v[72:75], v[16:31]
    ds_read_b64_tr_b16 v[216:217], v237 offset:14336
    ds_read_b64_tr_b16 v[218:219], v237 offset:14848
    s_waitcnt lgkmcnt(12)
    v_mfma_f32_32x32x16_bf16 v[32:47], v[200:203], v[72:75], v[32:47]
    s_add_u32 s55, s55, 8192
    s_add_u32 m0, s49, 0x400
    s_nop 0
    buffer_load_dwordx4 v239, s[80:83], s55 offen lds
    ds_read_b64_tr_b16 v[220:221], v238 offset:14336
    ds_read_b64_tr_b16 v[222:223], v238 offset:14848
    s_waitcnt lgkmcnt(12)
    v_mfma_f32_32x32x16_bf16 v[48:63], v[204:207], v[72:75], v[48:63]
    ds_read_b64_tr_b16 v[192:193], v237 offset:16384
    ds_read_b64_tr_b16 v[194:195], v237 offset:16896
    s_waitcnt lgkmcnt(8)
    v_mfma_f32_32x32x16_bf16 v[0:15], v[208:211], v[76:79], v[0:15]
    ds_read_b64_tr_b16 v[196:197], v238 offset:16384
    ds_read_b64_tr_b16 v[198:199], v238 offset:16896
    s_waitcnt lgkmcnt(8)
    v_mfma_f32_32x32x16_bf16 v[16:31], v[212:215], v[76:79], v[16:31]
    s_add_u32 s55, s55, 8192
    s_add_u32 m0, s49, 0x800
    s_nop 0
    buffer_load_dwordx4 v225, s[80:83], s55 offen lds
    ds_read_b64_tr_b16 v[200:201], v237 offset:24576
    ds_read_b64_tr_b16 v[202:203], v237 offset:25088
    s_waitcnt lgkmcnt(8)
    v_mfma_f32_32x32x16_bf16 v[32:47], v[216:219], v[76:79], v[32:47]
    ds_read_b64_tr_b16 v[204:205], v238 offset:24576
    ds_read_b64_tr_b16 v[206:207], v238 offset:25088
    s_waitcnt lgkmcnt(8)
    v_mfma_f32_32x32x16_bf16 v[48:63], v[220:223], v[76:79], v[48:63]
    s_add_u32 s55, s55, 8192
    s_add_u32 m0, s49, 0xc00
    s_nop 0
    buffer_load_dwordx4 v239, s[80:83], s55 offen lds
    ds_read_b64_tr_b16 v[208:209], v237 offset:18432
    ds_read_b64_tr_b16 v[210:211], v237 offset:18944
    s_waitcnt lgkmcnt(8)
    v_mfma_f32_32x32x16_bf16 v[0:15], v[192:195], v[80:83], v[0:15]
    ds_read_b64_tr_b16 v[212:213], v238 offset:18432
    ds_read_b64_tr_b16 v[214:215], v238 offset:18944
    s_waitcnt lgkmcnt(8)
    v_mfma_f32_32x32x16_bf16 v[16:31], v[196:199], v[80:83], v[16:31]
    ds_read_b64_tr_b16 v[216:217], v237 offset:26624
    ds_read_b64_tr_b16 v[218:219], v237 offset:27136
    s_waitcnt lgkmcnt(8)
    v_mfma_f32_32x32x16_bf16 v[32:47], v[200:203], v[80:83], v[32:47]
    s_add_u32 s37, s36, 3
    s_and_b32 s37, s37, 7
    s_mul_i32 s37, s37, 0x80000
    s_add_u32 m0, s39, 0xc000
    s_nop 0
    buffer_load_dwordx4 v226, s[68:71], s37 offen offset:0 lds
    ds_read_b64_tr_b16 v[220:221], v238 offset:26624
    ds_read_b64_tr_b16 v[222:223], v238 offset:27136
    s_waitcnt lgkmcnt(8)
    v_mfma_f32_32x32x16_bf16 v[48:63], v[204:207], v[80:83], v[48:63]
    ds_read_b64_tr_b16 v[192:193], v237 offset:20480
    ds_read_b64_tr_b16 v[194:195], v237 offset:20992
    s_waitcnt lgkmcnt(8)
    v_mfma_f32_32x32x16_bf16 v[0:15], v[208:211], v[84:87], v[0:15]
    ds_read_b64_tr_b16 v[196:197], v238 offset:20480
    ds_read_b64_tr_b16 v[198:199], v238 offset:20992
    s_waitcnt lgkmcnt(8)
    v_mfma_f32_32x32x16_bf16 v[16:31], v[212:215], v[84:87], v[16:31]
    s_add_u32 m0, s39, 0xdf80
    s_nop 0
    buffer_load_dwordx4 v226, s[68:71], s37 offen offset:128 lds
    ds_read_b64_tr_b16 v[200:201], v237 offset:28672
    ds_read_b64_tr_b16 v[202:203], v237 offset:29184
    s_waitcnt lgkmcnt(8)
    v_mfma_f32_32x32x16_bf16 v[32:47], v[216:219], v[84:87], v[32:47]
    ds_read_b64_tr_b16 v[204:205], v238 offset:28672
    ds_read_b64_tr_b16 v[206:207], v238 offset:29184
    s_waitcnt lgkmcnt(8)
    v_mfma_f32_32x32x16_bf16 v[48:63], v[220:223], v[84:87], v[48:63]
    s_waitcnt vmcnt(7)
    s_barrier
    ds_read_b128 v[96:99], v229 offset:8192
    ds_read_b128 v[100:103], v230 offset:8192
    ds_read_b128 v[104:107], v231 offset:8192
    ds_read_b128 v[108:111], v232 offset:8192
    s_add_u32 s55, s36, 4
    s_and_b32 s55, s55, 7
    s_lshl_b32 s55, s55, 7
    s_add_u32 s55, s55, s50
    s_add_u32 m0, s49, 0x1000
    s_nop 0
    buffer_load_dwordx4 v225, s[80:83], s55 offen lds
    ds_read_b64_tr_b16 v[208:209], v237 offset:22528
    ds_read_b64_tr_b16 v[210:211], v237 offset:23040
    s_waitcnt lgkmcnt(12)
    v_mfma_f32_32x32x16_bf16 v[0:15], v[192:195], v[88:91], v[0:15]
    ds_read_b64_tr_b16 v[212:213], v238 offset:22528
    ds_read_b64_tr_b16 v[214:215], v238 offset:23040
    s_waitcnt lgkmcnt(12)
    v_mfma_f32_32x32x16_bf16 v[16:31], v[196:199], v[88:91], v[16:31]
    ds_read_b64_tr_b16 v[216:217], v237 offset:30720
    ds_read_b64_tr_b16 v[218:219], v237 offset:31232
    s_waitcnt lgkmcnt(12)
    v_mfma_f32_32x32x16_bf16 v[32:47], v[200:203], v[88:91], v[32:47]
    s_add_u32 s55, s55, 8192
    s_add_u32 m0, s49, 0x1400
    s_nop 0
    buffer_load_dwordx4 v239, s[80:83], s55 offen lds
    ds_read_b64_tr_b16 v[220:221], v238 offset:30720
    ds_read_b64_tr_b16 v[222:223], v238 offset:31232
    s_waitcnt lgkmcnt(12)
    v_mfma_f32_32x32x16_bf16 v[48:63], v[204:207], v[88:91], v[48:63]
    ds_read_b64_tr_b16 v[192:193], v237 offset:32768
    ds_read_b64_tr_b16 v[194:195], v237 offset:33280
    s_waitcnt lgkmcnt(8)
    v_mfma_f32_32x32x16_bf16 v[0:15], v[208:211], v[92:95], v[0:15]
    ds_read_b64_tr_b16 v[196:197], v238 offset:32768
    ds_read_b64_tr_b16 v[198:199], v238 offset:33280
    s_waitcnt lgkmcnt(8)
    v_mfma_f32_32x32x16_bf16 v[16:31], v[212:215], v[92:95], v[16:31]
    s_add_u32 s55, s55, 8192
    s_add_u32 m0, s49, 0x1800
    s_nop 0
    buffer_load_dwordx4 v225, s[80:83], s55 offen lds
    ds_read_b64_tr_b16 v[200:201], v237 offset:40960
    ds_read_b64_tr_b16 v[202:203], v237 offset:41472
    s_waitcnt lgkmcnt(8)
    v_mfma_f32_32x32x16_bf16 v[32:47], v[216:219], v[92:95], v[32:47]
    ds_read_b64_tr_b16 v[204:205], v238 offset:40960
    ds_read_b64_tr_b16 v[206:207], v238 offset:41472
    s_waitcnt lgkmcnt(8)
    v_mfma_f32_32x32x16_bf16 v[48:63], v[220:223], v[92:95], v[48:63]
    s_add_u32 s55, s55, 8192
    s_add_u32 m0, s49, 0x1c00
    s_nop 0
    buffer_load_dwordx4 v239, s[80:83], s55 offen lds
    ds_read_b64_tr_b16 v[208:209], v237 offset:34816
    ds_read_b64_tr_b16 v[210:211], v237 offset:35328
    s_waitcnt lgkmcnt(8)
    v_mfma_f32_32x32x16_bf16 v[0:15], v[192:195], v[96:99], v[0:15]
    ds_read_b64_tr_b16 v[212:213], v238 offset:34816
    ds_read_b64_tr_b16 v[214:215], v238 offset:35328
    s_waitcnt lgkmcnt(8)
    v_mfma_f32_32x32x16_bf16 v[16:31], v[196:199], v[96:99], v[16:31]
    ds_read_b64_tr_b16 v[216:217], v237 offset:43008
    ds_read_b64_tr_b16 v[218:219], v237 offset:43520
    s_waitcnt lgkmcnt(8)
    v_mfma_f32_32x32x16_bf16 v[32:47], v[200:203], v[96:99], v[32:47]
    s_add_u32 s37, s36, 4
    s_and_b32 s37, s37, 7
    s_mul_i32 s37, s37, 0x80000
    s_add_u32 m0, s39, 0x0
    s_nop 0
    buffer_load_dwordx4 v226, s[68:71], s37 offen offset:0 lds
    ds_read_b64_tr_b16 v[220:221], v238 offset:43008
    ds_read_b64_tr_b16 v[222:223], v238 offset:43520
    s_waitcnt lgkmcnt(8)
    v_mfma_f32_32x32x16_bf16 v[48:63], v[204:207], v[96:99], v[48:63]
    ds_read_b64_tr_b16 v[192:193], v237 offset:36864
    ds_read_b64_tr_b16 v[194:195], v237 offset:37376
    s_waitcnt lgkmcnt(8)
    v_mfma_f32_32x32x16_bf16 v[0:15], v[208:211], v[100:103], v[0:15]
    ds_read_b64_tr_b16 v[196:197], v238 offset:36864
    ds_read_b64_tr_b16 v[198:199], v238 offset:37376
    s_waitcnt lgkmcnt(8)
    v_mfma_f32_32x32x16_bf16 v[16:31], v[212:215], v[100:103], v[16:31]
    s_add_u32 m0, s39, 0x1f80
    s_nop 0
    buffer_load_dwordx4 v226, s[68:71], s37 offen offset:128 lds
    ds_read_b64_tr_b16 v[200:201], v237 offset:45056
    ds_read_b64_tr_b16 v[202:203], v237 offset:45568
    s_waitcnt lgkmcnt(8)
    v_mfma_f32_32x32x16_bf16 v[32:47], v[216:219], v[100:103], v[32:47]
    ds_read_b64_tr_b16 v[204:205], v238 offset:45056
    ds_read_b64_tr_b16 v[206:207], v238 offset:45568
    s_waitcnt lgkmcnt(8)
    v_mfma_f32_32x32x16_bf16 v[48:63], v[220:223], v[100:103], v[48:63]
    s_waitcnt vmcnt(6)
    s_barrier
    ds_read_b128 v[112:115], v229 offset:0
    ds_read_b128 v[116:119], v230 offset:0
    ds_read_b128 v[120:123], v231 offset:0
    ds_read_b128 v[124:127], v232 offset:0
    s_add_u32 s55, s36, 5
    s_and_b32 s55, s55, 7
    s_lshl_b32 s55, s55, 7
    s_add_u32 s55, s55, s50
    s_add_u32 m0, s49, 0x2000
    s_nop 0
    buffer_load_dwordx4 v225, s[80:83], s55 offen lds
    ds_read_b64_tr_b16 v[208:209], v237 offset:38912
    ds_read_b64_tr_b16 v[210:211], v237 offset:39424
    s_waitcnt lgkmcnt(12)
    v_mfma_f32_32x32x16_bf16 v[0:15], v[192:195], v[104:107], v[0:15]
    ds_read_b64_tr_b16 v[212:213], v238 offset:38912
    ds_read_b64_tr_b16 v[214:215], v238 offset:39424
    s_waitcnt lgkmcnt(12)
    v_mfma_f32_32x32x16_bf16 v[16:31], v[196:199], v[104:107], v[16:31]
    ds_read_b64_tr_b16 v[216:217], v237 offset:47104
    ds_read_b64_tr_b16 v[218:219], v237 offset:47616
    s_waitcnt lgkmcnt(12)
    v_mfma_f32_32x32x16_bf16 v[32:47], v[200:203], v[104:107], v[32:47]
    s_add_u32 s55, s55, 8192
    s_add_u32 m0, s49, 0x2400
    s_nop 0
    buffer_load_dwordx4 v239, s[80:83], s55 offen lds
    ds_read_b64_tr_b16 v[220:221], v238 offset:47104
    ds_read_b64_tr_b16 v[222:223], v238 offset:47616
    s_waitcnt lgkmcnt(12)
    v_mfma_f32_32x32x16_bf16 v[48:63], v[204:207], v[104:107], v[48:63]
    ds_read_b64_tr_b16 v[192:193], v237 offset:49152
    ds_read_b64_tr_b16 v[194:195], v237 offset:49664
    s_waitcnt lgkmcnt(8)
    v_mfma_f32_32x32x16_bf16 v[0:15], v[208:211], v[108:111], v[0:15]
    ds_read_b64_tr_b16 v[196:197], v238 offset:49152
    ds_read_b64_tr_b16 v[198:199], v238 offset:49664
    s_waitcnt lgkmcnt(8)
    v_mfma_f32_32x32x16_bf16 v[16:31], v[212:215], v[108:111], v[16:31]
    s_add_u32 s55, s55, 8192
    s_add_u32 m0, s49, 0x2800
    s_nop 0
    buffer_load_dwordx4 v225, s[80:83], s55 offen lds
    ds_read_b64_tr_b16 v[200:201], v237 offset:57344
    ds_read_b64_tr_b16 v[202:203], v237 offset:57856
    s_waitcnt lgkmcnt(8)
    v_mfma_f32_32x32x16_bf16 v[32:47], v[216:219], v[108:111], v[32:47]
    ds_read_b64_tr_b16 v[204:205], v238 offset:57344
    ds_read_b64_tr_b16 v[206:207], v238 offset:57856
    s_waitcnt lgkmcnt(8)
    v_mfma_f32_32x32x16_bf16 v[48:63], v[220:223], v[108:111], v[48:63]
    s_add_u32 s55, s55, 8192
    s_add_u32 m0, s49, 0x2c00
    s_nop 0
    buffer_load_dwordx4 v239, s[80:83], s55 offen lds
    ds_read_b64_tr_b16 v[208:209], v237 offset:51200
    ds_read_b64_tr_b16 v[210:211], v237 offset:51712
    s_waitcnt lgkmcnt(8)
    v_mfma_f32_32x32x16_bf16 v[0:15], v[192:195], v[112:115], v[0:15]
    ds_read_b64_tr_b16 v[212:213], v238 offset:51200
    ds_read_b64_tr_b16 v[214:215], v238 offset:51712
    s_waitcnt lgkmcnt(8)
    v_mfma_f32_32x32x16_bf16 v[16:31], v[196:199], v[112:115], v[16:31]
    ds_read_b64_tr_b16 v[216:217], v237 offset:59392
    ds_read_b64_tr_b16 v[218:219], v237 offset:59904
    s_waitcnt lgkmcnt(8)
    v_mfma_f32_32x32x16_bf16 v[32:47], v[200:203], v[112:115], v[32:47]
    s_add_u32 s37, s36, 5
    s_and_b32 s37, s37, 7
    s_mul_i32 s37, s37, 0x80000
    s_add_u32 m0, s39, 0x4000
    s_nop 0
    buffer_load_dwordx4 v226, s[68:71], s37 offen offset:0 lds
    ds_read_b64_tr_b16 v[220:221], v238 offset:59392
    ds_read_b64_tr_b16 v[222:223], v238 offset:59904
    s_waitcnt lgkmcnt(8)
    v_mfma_f32_32x32x16_bf16 v[48:63], v[204:207], v[112:115], v[48:63]
    ds_read_b64_tr_b16 v[192:193], v237 offset:53248
    ds_read_b64_tr_b16 v[194:195], v237 offset:53760
    s_waitcnt lgkmcnt(8)
    v_mfma_f32_32x32x16_bf16 v[0:15], v[208:211], v[116:119], v[0:15]
    ds_read_b64_tr_b16 v[196:197], v238 offset:53248
    ds_read_b64_tr_b16 v[198:199], v238 offset:53760
    s_waitcnt lgkmcnt(8)
    v_mfma_f32_32x32x16_bf16 v[16:31], v[212:215], v[116:119], v[16:31]
    s_add_u32 m0, s39, 0x5f80
    s_nop 0
    buffer_load_dwordx4 v226, s[68:71], s37 offen offset:128 lds
    ds_read_b64_tr_b16 v[200:201], v237 offset:61440
    ds_read_b64_tr_b16 v[202:203], v237 offset:61952
    s_waitcnt lgkmcnt(8)
    v_mfma_f32_32x32x16_bf16 v[32:47], v[216:219], v[116:119], v[32:47]
    ds_read_b64_tr_b16 v[204:205], v238 offset:61440
    ds_read_b64_tr_b16 v[206:207], v238 offset:61952
    s_waitcnt lgkmcnt(8)
    v_mfma_f32_32x32x16_bf16 v[48:63], v[220:223], v[116:119], v[48:63]
    s_waitcnt vmcnt(6)
    s_barrier
    ds_read_b128 v[128:131], v229 offset:4096
    ds_read_b128 v[132:135], v230 offset:4096
    ds_read_b128 v[136:139], v231 offset:4096
    ds_read_b128 v[140:143], v232 offset:4096
    s_add_u32 s55, s36, 6
    s_and_b32 s55, s55, 7
    s_lshl_b32 s55, s55, 7
    s_add_u32 s55, s55, s50
    s_add_u32 m0, s49, 0x0
    s_nop 0
    buffer_load_dwordx4 v225, s[80:83], s55 offen lds
    ds_read_b64_tr_b16 v[208:209], v237 offset:55296
    ds_read_b64_tr_b16 v[210:211], v237 offset:55808
    s_waitcnt lgkmcnt(12)
    v_mfma_f32_32x32x16_bf16 v[0:15], v[192:195], v[120:123], v[0:15]
    ds_read_b64_tr_b16 v[212:213], v238 offset:55296
    ds_read_b64_tr_b16 v[214:215], v238 offset:55808
    s_waitcnt lgkmcnt(12)
    v_mfma_f32_32x32x16_bf16 v[16:31], v[196:199], v[120:123], v[16:31]
    ds_read_b64_tr_b16 v[216:217], v237 offset:63488
    ds_read_b64_tr_b16 v[218:219], v237 offset:64000
    s_waitcnt lgkmcnt(12)
    v_mfma_f32_32x32x16_bf16 v[32:47], v[200:203], v[120:123], v[32:47]
    s_add_u32 s55, s55, 8192
    s_add_u32 m0, s49, 0x400
    s_nop 0
    buffer_load_dwordx4 v239, s[80:83], s55 offen lds
    ds_read_b64_tr_b16 v[220:221], v238 offset:63488
    ds_read_b64_tr_b16 v[222:223], v238 offset:64000
    s_waitcnt lgkmcnt(12)
    v_mfma_f32_32x32x16_bf16 v[48:63], v[204:207], v[120:123], v[48:63]
    ds_read_b64_tr_b16 v[192:193], v237 offset:0
    ds_read_b64_tr_b16 v[194:195], v237 offset:512
    s_waitcnt lgkmcnt(8)
    v_mfma_f32_32x32x16_bf16 v[0:15], v[208:211], v[124:127], v[0:15]
    ds_read_b64_tr_b16 v[196:197], v238 offset:0
    ds_read_b64_tr_b16 v[198:199], v238 offset:512
    s_waitcnt lgkmcnt(8)
    v_mfma_f32_32x32x16_bf16 v[16:31], v[212:215], v[124:127], v[16:31]
    s_add_u32 s55, s55, 8192
    s_add_u32 m0, s49, 0x800
    s_nop 0
    buffer_load_dwordx4 v225, s[80:83], s55 offen lds
    ds_read_b64_tr_b16 v[200:201], v237 offset:8192
    ds_read_b64_tr_b16 v[202:203], v237 offset:8704
    s_waitcnt lgkmcnt(8)
    v_mfma_f32_32x32x16_bf16 v[32:47], v[216:219], v[124:127], v[32:47]
    ds_read_b64_tr_b16 v[204:205], v238 offset:8192
    ds_read_b64_tr_b16 v[206:207], v238 offset:8704
    s_waitcnt lgkmcnt(8)
    v_mfma_f32_32x32x16_bf16 v[48:63], v[220:223], v[124:127], v[48:63]
    s_add_u32 s55, s55, 8192
    s_add_u32 m0, s49, 0xc00
    s_nop 0
    buffer_load_dwordx4 v239, s[80:83], s55 offen lds
    ds_read_b64_tr_b16 v[208:209], v237 offset:2048
    ds_read_b64_tr_b16 v[210:211], v237 offset:2560
    s_waitcnt lgkmcnt(8)
    v_mfma_f32_32x32x16_bf16 v[0:15], v[192:195], v[128:131], v[0:15]
    ds_read_b64_tr_b16 v[212:213], v238 offset:2048
    ds_read_b64_tr_b16 v[214:215], v238 offset:2560
    s_waitcnt lgkmcnt(8)
    v_mfma_f32_32x32x16_bf16 v[16:31], v[196:199], v[128:131], v[16:31]
    ds_read_b64_tr_b16 v[216:217], v237 offset:10240
    ds_read_b64_tr_b16 v[218:219], v237 offset:10752
    s_waitcnt lgkmcnt(8)
    v_mfma_f32_32x32x16_bf16 v[32:47], v[200:203], v[128:131], v[32:47]
    s_add_u32 s37, s36, 6
    s_and_b32 s37, s37, 7
    s_mul_i32 s37, s37, 0x80000
    s_add_u32 m0, s39, 0x8000
    s_nop 0
    buffer_load_dwordx4 v226, s[68:71], s37 offen offset:0 lds
    ds_read_b64_tr_b16 v[220:221], v238 offset:10240
    ds_read_b64_tr_b16 v[222:223], v238 offset:10752
    s_waitcnt lgkmcnt(8)
    v_mfma_f32_32x32x16_bf16 v[48:63], v[204:207], v[128:131], v[48:63]
    ds_read_b64_tr_b16 v[192:193], v237 offset:4096
    ds_read_b64_tr_b16 v[194:195], v237 offset:4608
    s_waitcnt lgkmcnt(8)
    v_mfma_f32_32x32x16_bf16 v[0:15], v[208:211], v[132:135], v[0:15]
    ds_read_b64_tr_b16 v[196:197], v238 offset:4096
    ds_read_b64_tr_b16 v[198:199], v238 offset:4608
    s_waitcnt lgkmcnt(8)
    v_mfma_f32_32x32x16_bf16 v[16:31], v[212:215], v[132:135], v[16:31]
    s_add_u32 m0, s39, 0x9f80
    s_nop 0
    buffer_load_dwordx4 v226, s[68:71], s37 offen offset:128 lds
    ds_read_b64_tr_b16 v[200:201], v237 offset:12288
    ds_read_b64_tr_b16 v[202:203], v237 offset:12800
    s_waitcnt lgkmcnt(8)
    v_mfma_f32_32x32x16_bf16 v[32:47], v[216:219], v[132:135], v[32:47]
    ds_read_b64_tr_b16 v[204:205], v238 offset:12288
    ds_read_b64_tr_b16 v[206:207], v238 offset:12800
    s_waitcnt lgkmcnt(8)
    v_mfma_f32_32x32x16_bf16 v[48:63], v[220:223], v[132:135], v[48:63]
    s_waitcnt vmcnt(6)
    s_barrier
    v_and_b32 v249, 7, v224
    v_lshlrev_b32 v249, 2, v249
    s_cmp_lg_u32 s34, 0
    s_cbranch_scc1 k2_w2
    buffer_load_dword v248, v249, s[72:75], 0 offen
k2_w2:
    ds_read_b128 v[144:147], v229 offset:8192
    ds_read_b128 v[148:151], v230 offset:8192
    ds_read_b128 v[152:155], v231 offset:8192
    ds_read_b128 v[156:159], v232 offset:8192
    s_add_u32 s55, s36, 7
    s_and_b32 s55, s55, 7
    s_lshl_b32 s55, s55, 7
    s_add_u32 s55, s55, s50
    s_add_u32 m0, s49, 0x1000
    s_nop 0
    buffer_load_dwordx4 v225, s[80:83], s55 offen lds
    ds_read_b64_tr_b16 v[208:209], v237 offset:6144
    ds_read_b64_tr_b16 v[210:211], v237 offset:6656
    s_waitcnt lgkmcnt(12)
    v_mfma_f32_32x32x16_bf16 v[0:15], v[192:195], v[136:139], v[0:15]
    ds_read_b64_tr_b16 v[212:213], v238 offset:6144
    ds_read_b64_tr_b16 v[214:215], v238 offset:6656
    s_waitcnt lgkmcnt(12)
    v_mfma_f32_32x32x16_bf16 v[16:31], v[196:199], v[136:139], v[16:31]
    ds_read_b64_tr_b16 v[216:217], v237 offset:14336
    ds_read_b64_tr_b16 v[218:219], v237 offset:14848
    s_waitcnt lgkmcnt(12)
    v_mfma_f32_32x32x16_bf16 v[32:47], v[200:203], v[136:139], v[32:47]
    s_add_u32 s55, s55, 8192
    s_add_u32 m0, s49, 0x1400
    s_nop 0
    buffer_load_dwordx4 v239, s[80:83], s55 offen lds
    ds_read_b64_tr_b16 v[220:221], v238 offset:14336
    ds_read_b64_tr_b16 v[222:223], v238 offset:14848
    s_waitcnt lgkmcnt(12)
    v_mfma_f32_32x32x16_bf16 v[48:63], v[204:207], v[136:139], v[48:63]
    ds_read_b64_tr_b16 v[192:193], v237 offset:16384
    ds_read_b64_tr_b16 v[194:195], v237 offset:16896
    s_waitcnt lgkmcnt(8)
    v_mfma_f32_32x32x16_bf16 v[0:15], v[208:211], v[140:143], v[0:15]
    ds_read_b64_tr_b16 v[196:197], v238 offset:16384
    ds_read_b64_tr_b16 v[198:199], v238 offset:16896
    s_waitcnt lgkmcnt(8)
    v_mfma_f32_32x32x16_bf16 v[16:31], v[212:215], v[140:143], v[16:31]
    s_add_u32 s55, s55, 8192
    s_add_u32 m0, s49, 0x1800
    s_nop 0
    buffer_load_dwordx4 v225, s[80:83], s55 offen lds
    ds_read_b64_tr_b16 v[200:201], v237 offset:24576
    ds_read_b64_tr_b16 v[202:203], v237 offset:25088
    s_waitcnt lgkmcnt(8)
    v_mfma_f32_32x32x16_bf16 v[32:47], v[216:219], v[140:143], v[32:47]
    ds_read_b64_tr_b16 v[204:205], v238 offset:24576
    ds_read_b64_tr_b16 v[206:207], v238 offset:25088
    s_waitcnt lgkmcnt(8)
    v_mfma_f32_32x32x16_bf16 v[48:63], v[220:223], v[140:143], v[48:63]
    s_add_u32 s55, s55, 8192
    s_add_u32 m0, s49, 0x1c00
    s_nop 0
    buffer_load_dwordx4 v239, s[80:83], s55 offen lds
    ds_read_b64_tr_b16 v[208:209], v237 offset:18432
    ds_read_b64_tr_b16 v[210:211], v237 offset:18944
    s_waitcnt lgkmcnt(8)
    v_mfma_f32_32x32x16_bf16 v[0:15], v[192:195], v[144:147], v[0:15]
    ds_read_b64_tr_b16 v[212:213], v238 offset:18432
    ds_read_b64_tr_b16 v[214:215], v238 offset:18944
    s_waitcnt lgkmcnt(8)
    v_mfma_f32_32x32x16_bf16 v[16:31], v[196:199], v[144:147], v[16:31]
    ds_read_b64_tr_b16 v[216:217], v237 offset:26624
    ds_read_b64_tr_b16 v[218:219], v237 offset:27136
    s_waitcnt lgkmcnt(8)
    v_mfma_f32_32x32x16_bf16 v[32:47], v[200:203], v[144:147], v[32:47]
    s_add_u32 s37, s36, 7
    s_and_b32 s37, s37, 7
    s_mul_i32 s37, s37, 0x80000
    s_add_u32 m0, s39, 0xc000
    s_nop 0
    buffer_load_dwordx4 v226, s[68:71], s37 offen offset:0 lds
    ds_read_b64_tr_b16 v[220:221], v238 offset:26624
    ds_read_b64_tr_b16 v[222:223], v238 offset:27136
    s_waitcnt lgkmcnt(8)
    v_mfma_f32_32x32x16_bf16 v[48:63], v[204:207], v[144:147], v[48:63]
    ds_read_b64_tr_b16 v[192:193], v237 offset:20480
    ds_read_b64_tr_b16 v[194:195], v237 offset:20992
    s_waitcnt lgkmcnt(8)
    v_mfma_f32_32x32x16_bf16 v[0:15], v[208:211], v[148:151], v[0:15]
    ds_read_b64_tr_b16 v[196:197], v238 offset:20480
    ds_read_b64_tr_b16 v[198:199], v238 offset:20992
    s_waitcnt lgkmcnt(8)
    v_mfma_f32_32x32x16_bf16 v[16:31], v[212:215], v[148:151], v[16:31]
    s_add_u32 m0, s39, 0xdf80
    s_nop 0
    buffer_load_dwordx4 v226, s[68:71], s37 offen offset:128 lds
    ds_read_b64_tr_b16 v[200:201], v237 offset:28672
    ds_read_b64_tr_b16 v[202:203], v237 offset:29184
    s_waitcnt lgkmcnt(8)
    v_mfma_f32_32x32x16_bf16 v[32:47], v[216:219], v[148:151], v[32:47]
    ds_read_b64_tr_b16 v[204:205], v238 offset:28672
    ds_read_b64_tr_b16 v[206:207], v238 offset:29184
    s_waitcnt lgkmcnt(8)
    v_mfma_f32_32x32x16_bf16 v[48:63], v[220:223], v[148:151], v[48:63]
    s_waitcnt vmcnt(6)
    s_barrier
    ds_read_b128 v[160:163], v229 offset:0
    ds_read_b128 v[164:167], v230 offset:0
    ds_read_b128 v[168:171], v231 offset:0
    ds_read_b128 v[172:175], v232 offset:0
    s_add_u32 s37, s36, 0
    s_and_b32 s37, s37, 7
    s_mul_i32 s37, s37, 0x80000
    s_add_u32 m0, s39, 0x0
    s_nop 0
    buffer_load_dwordx4 v226, s[64:67], s37 offen offset:0 lds
    ds_read_b64_tr_b16 v[208:209], v237 offset:22528
    ds_read_b64_tr_b16 v[210:211], v237 offset:23040
    s_waitcnt lgkmcnt(12)
    v_mfma_f32_32x32x16_bf16 v[0:15], v[192:195], v[152:155], v[0:15]
    ds_read_b64_tr_b16 v[212:213], v238 offset:22528
    ds_read_b64_tr_b16 v[214:215], v238 offset:23040
    s_waitcnt lgkmcnt(12)
    v_mfma_f32_32x32x16_bf16 v[16:31], v[196:199], v[152:155], v[16:31]
    ds_read_b64_tr_b16 v[216:217], v237 offset:30720
    ds_read_b64_tr_b16 v[218:219], v237 offset:31232
    s_waitcnt lgkmcnt(12)
    v_mfma_f32_32x32x16_bf16 v[32:47], v[200:203], v[152:155], v[32:47]
    ds_read_b64_tr_b16 v[220:221], v238 offset:30720
    ds_read_b64_tr_b16 v[222:223], v238 offset:31232
    s_waitcnt lgkmcnt(12)
    v_mfma_f32_32x32x16_bf16 v[48:63], v[204:207], v[152:155], v[48:63]
    ds_read_b64_tr_b16 v[192:193], v237 offset:32768
    ds_read_b64_tr_b16 v[194:195], v237 offset:33280
    s_waitcnt lgkmcnt(8)
    v_mfma_f32_32x32x16_bf16 v[0:15], v[208:211], v[156:159], v[0:15]
    ds_read_b64_tr_b16 v[196:197], v238 offset:32768
    ds_read_b64_tr_b16 v[198:199], v238 offset:33280
    s_waitcnt lgkmcnt(8)
    v_mfma_f32_32x32x16_bf16 v[16:31], v[212:215], v[156:159], v[16:31]
    ds_read_b64_tr_b16 v[200:201], v237 offset:40960
    ds_read_b64_tr_b16 v[202:203], v237 offset:41472
    s_waitcnt lgkmcnt(8)
    v_mfma_f32_32x32x16_bf16 v[32:47], v[216:219], v[156:159], v[32:47]
    ds_read_b64_tr_b16 v[204:205], v238 offset:40960
    ds_read_b64_tr_b16 v[206:207], v238 offset:41472
    s_waitcnt lgkmcnt(8)
    v_mfma_f32_32x32x16_bf16 v[48:63], v[220:223], v[156:159], v[48:63]
    s_add_u32 m0, s39, 0x1f80
    s_nop 0
    buffer_load_dwordx4 v226, s[64:67], s37 offen offset:128 lds
    ds_read_b64_tr_b16 v[208:209], v237 offset:34816
    ds_read_b64_tr_b16 v[210:211], v237 offset:35328
    s_waitcnt lgkmcnt(8)
    v_mfma_f32_32x32x16_bf16 v[0:15], v[192:195], v[160:163], v[0:15]
    ds_read_b64_tr_b16 v[212:213], v238 offset:34816
    ds_read_b64_tr_b16 v[214:215], v238 offset:35328
    s_waitcnt lgkmcnt(8)
    v_mfma_f32_32x32x16_bf16 v[16:31], v[196:199], v[160:163], v[16:31]
    ds_read_b64_tr_b16 v[216:217], v237 offset:43008
    ds_read_b64_tr_b16 v[218:219], v237 offset:43520
    s_waitcnt lgkmcnt(8)
    v_mfma_f32_32x32x16_bf16 v[32:47], v[200:203], v[160:163], v[32:47]
    ds_read_b64_tr_b16 v[220:221], v238 offset:43008
    ds_read_b64_tr_b16 v[222:223], v238 offset:43520
    s_waitcnt lgkmcnt(8)
    v_mfma_f32_32x32x16_bf16 v[48:63], v[204:207], v[160:163], v[48:63]
    ds_read_b64_tr_b16 v[192:193], v237 offset:36864
    ds_read_b64_tr_b16 v[194:195], v237 offset:37376
    s_waitcnt lgkmcnt(8)
    v_mfma_f32_32x32x16_bf16 v[0:15], v[208:211], v[164:167], v[0:15]
    ds_read_b64_tr_b16 v[196:197], v238 offset:36864
    ds_read_b64_tr_b16 v[198:199], v238 offset:37376
    s_waitcnt lgkmcnt(8)
    v_mfma_f32_32x32x16_bf16 v[16:31], v[212:215], v[164:167], v[16:31]
    ds_read_b64_tr_b16 v[200:201], v237 offset:45056
    ds_read_b64_tr_b16 v[202:203], v237 offset:45568
    s_waitcnt lgkmcnt(8)
    v_mfma_f32_32x32x16_bf16 v[32:47], v[216:219], v[164:167], v[32:47]
    ds_read_b64_tr_b16 v[204:205], v238 offset:45056
    ds_read_b64_tr_b16 v[206:207], v238 offset:45568
    s_waitcnt lgkmcnt(8)
    v_mfma_f32_32x32x16_bf16 v[48:63], v[220:223], v[164:167], v[48:63]
    s_waitcnt vmcnt(2)
    s_barrier
    s_cmp_lg_u32 s34, 0
    s_cbranch_scc1 k2_w3
    v_and_b32 v248, 1, v248
    v_cmp_ne_u32 vcc, 1, v248
    s_cbranch_vccnz k2_spinz
k2_spz:
k2_w3:
    s_cmp_lg_u32 s34, 0
    s_cbranch_scc1 k2_w4
    s_lshr_b32 s6, s2, 4
    s_sub_u32 s7, 15, s6
    s_min_u32 s6, s6, s7
    s_lshl_b32 s6, s6, 11
    s_lshr_b32 s7, s2, 7
    s_lshl_b32 s7, s7, 8
    s_add_u32 s6, s6, s7
    s_and_b32 s7, s2, 15
    s_lshl_b32 s7, s7, 4
    s_add_u32 s6, s6, s7
    s_add_u32 s6, s6, 49152
    v_lshlrev_b32 v249, 9, v224
    v_mov_b32 v250, 1
    s_mov_b64 exec, 15
    buffer_store_dword v250, v249, s[84:87], s6 offen offset:8 sc1
    s_mov_b64 exec, -1
k2_w4:
    ds_read_b128 v[176:179], v229 offset:4096
    ds_read_b128 v[180:183], v230 offset:4096
    ds_read_b128 v[184:187], v231 offset:4096
    ds_read_b128 v[188:191], v232 offset:4096
    s_add_u32 s37, s36, 1
    s_and_b32 s37, s37, 7
    s_mul_i32 s37, s37, 0x80000
    s_add_u32 m0, s39, 0x4000
    s_nop 0
    buffer_load_dwordx4 v226, s[64:67], s37 offen offset:0 lds
    ds_read_b64_tr_b16 v[208:209], v237 offset:38912
    ds_read_b64_tr_b16 v[210:211], v237 offset:39424
    s_waitcnt lgkmcnt(12)
    v_mfma_f32_32x32x16_bf16 v[0:15], v[192:195], v[168:171], v[0:15]
    ds_read_b64_tr_b16 v[212:213], v238 offset:38912
    ds_read_b64_tr_b16 v[214:215], v238 offset:39424
    s_waitcnt lgkmcnt(12)
    v_mfma_f32_32x32x16_bf16 v[16:31], v[196:199], v[168:171], v[16:31]
    ds_read_b64_tr_b16 v[216:217], v237 offset:47104
    ds_read_b64_tr_b16 v[218:219], v237 offset:47616
    s_waitcnt lgkmcnt(12)
    v_mfma_f32_32x32x16_bf16 v[32:47], v[200:203], v[168:171], v[32:47]
    ds_read_b64_tr_b16 v[220:221], v238 offset:47104
    ds_read_b64_tr_b16 v[222:223], v238 offset:47616
    s_waitcnt lgkmcnt(12)
    v_mfma_f32_32x32x16_bf16 v[48:63], v[204:207], v[168:171], v[48:63]
    ds_read_b64_tr_b16 v[192:193], v237 offset:49152
    ds_read_b64_tr_b16 v[194:195], v237 offset:49664
    s_waitcnt lgkmcnt(8)
    v_mfma_f32_32x32x16_bf16 v[0:15], v[208:211], v[172:175], v[0:15]
    ds_read_b64_tr_b16 v[196:197], v238 offset:49152
    ds_read_b64_tr_b16 v[198:199], v238 offset:49664
    s_waitcnt lgkmcnt(8)
    v_mfma_f32_32x32x16_bf16 v[16:31], v[212:215], v[172:175], v[16:31]
    ds_read_b64_tr_b16 v[200:201], v237 offset:57344
    ds_read_b64_tr_b16 v[202:203], v237 offset:57856
    s_waitcnt lgkmcnt(8)
    v_mfma_f32_32x32x16_bf16 v[32:47], v[216:219], v[172:175], v[32:47]
    ds_read_b64_tr_b16 v[204:205], v238 offset:57344
    ds_read_b64_tr_b16 v[206:207], v238 offset:57856
    s_waitcnt lgkmcnt(8)
    v_mfma_f32_32x32x16_bf16 v[48:63], v[220:223], v[172:175], v[48:63]
    s_add_u32 m0, s39, 0x5f80
    s_nop 0
    buffer_load_dwordx4 v226, s[64:67], s37 offen offset:128 lds
    ds_read_b64_tr_b16 v[208:209], v237 offset:51200
    ds_read_b64_tr_b16 v[210:211], v237 offset:51712
    s_waitcnt lgkmcnt(8)
    v_mfma_f32_32x32x16_bf16 v[0:15], v[192:195], v[176:179], v[0:15]
    ds_read_b64_tr_b16 v[212:213], v238 offset:51200
    ds_read_b64_tr_b16 v[214:215], v238 offset:51712
    s_waitcnt lgkmcnt(8)
    v_mfma_f32_32x32x16_bf16 v[16:31], v[196:199], v[176:179], v[16:31]
    ds_read_b64_tr_b16 v[216:217], v237 offset:59392
    ds_read_b64_tr_b16 v[218:219], v237 offset:59904
    s_waitcnt lgkmcnt(8)
    v_mfma_f32_32x32x16_bf16 v[32:47], v[200:203], v[176:179], v[32:47]
    ds_read_b64_tr_b16 v[220:221], v238 offset:59392
    ds_read_b64_tr_b16 v[222:223], v238 offset:59904
    s_waitcnt lgkmcnt(8)
    v_mfma_f32_32x32x16_bf16 v[48:63], v[204:207], v[176:179], v[48:63]
    ds_read_b64_tr_b16 v[192:193], v237 offset:53248
    ds_read_b64_tr_b16 v[194:195], v237 offset:53760
    s_waitcnt lgkmcnt(8)
    v_mfma_f32_32x32x16_bf16 v[0:15], v[208:211], v[180:183], v[0:15]
    ds_read_b64_tr_b16 v[196:197], v238 offset:53248
    ds_read_b64_tr_b16 v[198:199], v238 offset:53760
    s_waitcnt lgkmcnt(8)
    v_mfma_f32_32x32x16_bf16 v[16:31], v[212:215], v[180:183], v[16:31]
    ds_read_b64_tr_b16 v[200:201], v237 offset:61440
    ds_read_b64_tr_b16 v[202:203], v237 offset:61952
    s_waitcnt lgkmcnt(8)
    v_mfma_f32_32x32x16_bf16 v[32:47], v[216:219], v[180:183], v[32:47]
    ds_read_b64_tr_b16 v[204:205], v238 offset:61440
    ds_read_b64_tr_b16 v[206:207], v238 offset:61952
    s_waitcnt lgkmcnt(8)
    v_mfma_f32_32x32x16_bf16 v[48:63], v[220:223], v[180:183], v[48:63]
    s_waitcnt vmcnt(2)
    s_barrier
    s_add_u32 s37, s36, 2
    s_and_b32 s37, s37, 7
    s_mul_i32 s37, s37, 0x80000
    s_add_u32 m0, s39, 0x8000
    s_nop 0
    buffer_load_dwordx4 v226, s[64:67], s37 offen offset:0 lds
    ds_read_b64_tr_b16 v[208:209], v237 offset:55296
    ds_read_b64_tr_b16 v[210:211], v237 offset:55808
    s_waitcnt lgkmcnt(8)
    v_mfma_f32_32x32x16_bf16 v[0:15], v[192:195], v[184:187], v[0:15]
    ds_read_b64_tr_b16 v[212:213], v238 offset:55296
    ds_read_b64_tr_b16 v[214:215], v238 offset:55808
    s_waitcnt lgkmcnt(8)
    v_mfma_f32_32x32x16_bf16 v[16:31], v[196:199], v[184:187], v[16:31]
    ds_read_b64_tr_b16 v[216:217], v237 offset:63488
    ds_read_b64_tr_b16 v[218:219], v237 offset:64000
    s_waitcnt lgkmcnt(8)
    v_mfma_f32_32x32x16_bf16 v[32:47], v[200:203], v[184:187], v[32:47]
    ds_read_b64_tr_b16 v[220:221], v238 offset:63488
    ds_read_b64_tr_b16 v[222:223], v238 offset:64000
    s_waitcnt lgkmcnt(8)
    v_mfma_f32_32x32x16_bf16 v[48:63], v[204:207], v[184:187], v[48:63]
    ds_read_b64_tr_b16 v[192:193], v237 offset:0
    ds_read_b64_tr_b16 v[194:195], v237 offset:512
    s_waitcnt lgkmcnt(8)
    v_mfma_f32_32x32x16_bf16 v[0:15], v[208:211], v[188:191], v[0:15]
    ds_read_b64_tr_b16 v[196:197], v238 offset:0
    ds_read_b64_tr_b16 v[198:199], v238 offset:512
    s_waitcnt lgkmcnt(8)
    v_mfma_f32_32x32x16_bf16 v[16:31], v[212:215], v[188:191], v[16:31]
    ds_read_b64_tr_b16 v[200:201], v237 offset:8192
    ds_read_b64_tr_b16 v[202:203], v237 offset:8704
    s_waitcnt lgkmcnt(8)
    v_mfma_f32_32x32x16_bf16 v[32:47], v[216:219], v[188:191], v[32:47]
    ds_read_b64_tr_b16 v[204:205], v238 offset:8192
    ds_read_b64_tr_b16 v[206:207], v238 offset:8704
    s_waitcnt lgkmcnt(8)
    v_mfma_f32_32x32x16_bf16 v[48:63], v[220:223], v[188:191], v[48:63]
    s_add_u32 m0, s39, 0x9f80
    s_nop 0
    buffer_load_dwordx4 v226, s[64:67], s37 offen offset:128 lds
    v_cvt_pk_bf16_f32 v240, v0, v1
    v_cvt_pk_bf16_f32 v241, v2, v3
    v_cvt_pk_bf16_f32 v242, v4, v5
    v_cvt_pk_bf16_f32 v243, v6, v7
    s_mov_b32 s38, 0x0
    buffer_store_dwordx4 v[240:243], v233, s[76:79], s38 offen offset:0 sc1
    v_cvt_pk_bf16_f32 v244, v8, v9
    v_cvt_pk_bf16_f32 v245, v10, v11
    v_cvt_pk_bf16_f32 v246, v12, v13
    v_cvt_pk_bf16_f32 v247, v14, v15
    buffer_store_dwordx4 v[244:247], v233, s[76:79], s38 offen offset:1024 sc1
    v_cvt_pk_bf16_f32 v240, v16, v17
    v_cvt_pk_bf16_f32 v241, v18, v19
    v_cvt_pk_bf16_f32 v242, v20, v21
    v_cvt_pk_bf16_f32 v243, v22, v23
    buffer_store_dwordx4 v[240:243], v233, s[76:79], s38 offen offset:2048 sc1
    v_cvt_pk_bf16_f32 v244, v24, v25
    v_cvt_pk_bf16_f32 v245, v26, v27
    v_cvt_pk_bf16_f32 v246, v28, v29
    v_cvt_pk_bf16_f32 v247, v30, v31
    buffer_store_dwordx4 v[244:247], v233, s[76:79], s38 offen offset:3072 sc1
    v_cvt_pk_bf16_f32 v240, v32, v33
    v_cvt_pk_bf16_f32 v241, v34, v35
    v_cvt_pk_bf16_f32 v242, v36, v37
    v_cvt_pk_bf16_f32 v243, v38, v39
    s_mov_b32 s38, 0x1000
    buffer_store_dwordx4 v[240:243], v233, s[76:79], s38 offen offset:0 sc1
    v_cvt_pk_bf16_f32 v244, v40, v41
    v_cvt_pk_bf16_f32 v245, v42, v43
    v_cvt_pk_bf16_f32 v246, v44, v45
    v_cvt_pk_bf16_f32 v247, v46, v47
    buffer_store_dwordx4 v[244:247], v233, s[76:79], s38 offen offset:1024 sc1
    v_cvt_pk_bf16_f32 v240, v48, v49
    v_cvt_pk_bf16_f32 v241, v50, v51
    v_cvt_pk_bf16_f32 v242, v52, v53
    v_cvt_pk_bf16_f32 v243, v54, v55
    buffer_store_dwordx4 v[240:243], v233, s[76:79], s38 offen offset:2048 sc1
    v_cvt_pk_bf16_f32 v244, v56, v57
    v_cvt_pk_bf16_f32 v245, v58, v59
    v_cvt_pk_bf16_f32 v246, v60, v61
    v_cvt_pk_bf16_f32 v247, v62, v63
    buffer_store_dwordx4 v[244:247], v233, s[76:79], s38 offen offset:3072 sc1
    ds_read_b64_tr_b16 v[208:209], v237 offset:2048
    ds_read_b64_tr_b16 v[210:211], v237 offset:2560
    s_waitcnt lgkmcnt(8)
    v_mfma_f32_32x32x16_bf16 v[0:15], v[64:67], v[192:195], 0
    ds_read_b64_tr_b16 v[212:213], v238 offset:2048
    ds_read_b64_tr_b16 v[214:215], v238 offset:2560
    s_waitcnt lgkmcnt(8)
    v_mfma_f32_32x32x16_bf16 v[16:31], v[64:67], v[196:199], 0
    ds_read_b64_tr_b16 v[216:217], v237 offset:10240
    ds_read_b64_tr_b16 v[218:219], v237 offset:10752
    s_waitcnt lgkmcnt(8)
    v_mfma_f32_32x32x16_bf16 v[32:47], v[64:67], v[200:203], 0
    ds_read_b64_tr_b16 v[220:221], v238 offset:10240
    ds_read_b64_tr_b16 v[222:223], v238 offset:10752
    s_waitcnt lgkmcnt(8)
    v_mfma_f32_32x32x16_bf16 v[48:63], v[64:67], v[204:207], 0
    ds_read_b64_tr_b16 v[192:193], v237 offset:4096
    ds_read_b64_tr_b16 v[194:195], v237 offset:4608
    s_waitcnt lgkmcnt(8)
    v_mfma_f32_32x32x16_bf16 v[0:15], v[68:71], v[208:211], v[0:15]
    ds_read_b64_tr_b16 v[196:197], v238 offset:4096
    ds_read_b64_tr_b16 v[198:199], v238 offset:4608
    s_waitcnt lgkmcnt(8)
    v_mfma_f32_32x32x16_bf16 v[16:31], v[68:71], v[212:215], v[16:31]
    ds_read_b64_tr_b16 v[200:201], v237 offset:12288
    ds_read_b64_tr_b16 v[202:203], v237 offset:12800
    s_waitcnt lgkmcnt(8)
    v_mfma_f32_32x32x16_bf16 v[32:47], v[68:71], v[216:219], v[32:47]
    ds_read_b64_tr_b16 v[204:205], v238 offset:12288
    ds_read_b64_tr_b16 v[206:207], v238 offset:12800
    s_waitcnt lgkmcnt(8)
    v_mfma_f32_32x32x16_bf16 v[48:63], v[68:71], v[220:223], v[48:63]
    s_waitcnt vmcnt(10)
    s_barrier
    s_add_u32 s37, s36, 3
    s_and_b32 s37, s37, 7
    s_mul_i32 s37, s37, 0x80000
    s_add_u32 m0, s39, 0xc000
    s_nop 0
    buffer_load_dwordx4 v226, s[64:67], s37 offen offset:0 lds
    ds_read_b64_tr_b16 v[208:209], v237 offset:6144
    ds_read_b64_tr_b16 v[210:211], v237 offset:6656
    s_waitcnt lgkmcnt(8)
    v_mfma_f32_32x32x16_bf16 v[0:15], v[72:75], v[192:195], v[0:15]
    ds_read_b64_tr_b16 v[212:213], v238 offset:6144
    ds_read_b64_tr_b16 v[214:215], v238 offset:6656
    s_waitcnt lgkmcnt(8)
    v_mfma_f32_32x32x16_bf16 v[16:31], v[72:75], v[196:199], v[16:31]
    ds_read_b64_tr_b16 v[216:217], v237 offset:14336
    ds_read_b64_tr_b16 v[218:219], v237 offset:14848
    s_waitcnt lgkmcnt(8)
    v_mfma_f32_32x32x16_bf16 v[32:47], v[72:75], v[200:203], v[32:47]
    ds_read_b64_tr_b16 v[220:221], v238 offset:14336
    ds_read_b64_tr_b16 v[222:223], v238 offset:14848
    s_waitcnt lgkmcnt(8)
    v_mfma_f32_32x32x16_bf16 v[48:63], v[72:75], v[204:207], v[48:63]
    ds_read_b64_tr_b16 v[192:193], v237 offset:16384
    ds_read_b64_tr_b16 v[194:195], v237 offset:16896
    s_waitcnt lgkmcnt(8)
    v_mfma_f32_32x32x16_bf16 v[0:15], v[76:79], v[208:211], v[0:15]
    ds_read_b64_tr_b16 v[196:197], v238 offset:16384
    ds_read_b64_tr_b16 v[198:199], v238 offset:16896
    s_waitcnt lgkmcnt(8)
    v_mfma_f32_32x32x16_bf16 v[16:31], v[76:79], v[212:215], v[16:31]
    ds_read_b64_tr_b16 v[200:201], v237 offset:24576
    ds_read_b64_tr_b16 v[202:203], v237 offset:25088
    s_waitcnt lgkmcnt(8)
    v_mfma_f32_32x32x16_bf16 v[32:47], v[76:79], v[216:219], v[32:47]
    ds_read_b64_tr_b16 v[204:205], v238 offset:24576
    ds_read_b64_tr_b16 v[206:207], v238 offset:25088
    s_waitcnt lgkmcnt(8)
    v_mfma_f32_32x32x16_bf16 v[48:63], v[76:79], v[220:223], v[48:63]
    s_add_u32 m0, s39, 0xdf80
    s_nop 0
    buffer_load_dwordx4 v226, s[64:67], s37 offen offset:128 lds
    ds_read_b64_tr_b16 v[208:209], v237 offset:18432
    ds_read_b64_tr_b16 v[210:211], v237 offset:18944
    s_waitcnt lgkmcnt(8)
    v_mfma_f32_32x32x16_bf16 v[0:15], v[80:83], v[192:195], v[0:15]
    ds_read_b64_tr_b16 v[212:213], v238 offset:18432
    ds_read_b64_tr_b16 v[214:215], v238 offset:18944
    s_waitcnt lgkmcnt(8)
    v_mfma_f32_32x32x16_bf16 v[16:31], v[80:83], v[196:199], v[16:31]
    ds_read_b64_tr_b16 v[216:217], v237 offset:26624
    ds_read_b64_tr_b16 v[218:219], v237 offset:27136
    s_waitcnt lgkmcnt(8)
    v_mfma_f32_32x32x16_bf16 v[32:47], v[80:83], v[200:203], v[32:47]
    ds_read_b64_tr_b16 v[220:221], v238 offset:26624
    ds_read_b64_tr_b16 v[222:223], v238 offset:27136
    s_waitcnt lgkmcnt(8)
    v_mfma_f32_32x32x16_bf16 v[48:63], v[80:83], v[204:207], v[48:63]
    ds_read_b64_tr_b16 v[192:193], v237 offset:20480
    ds_read_b64_tr_b16 v[194:195], v237 offset:20992
    s_waitcnt lgkmcnt(8)
    v_mfma_f32_32x32x16_bf16 v[0:15], v[84:87], v[208:211], v[0:15]
    ds_read_b64_tr_b16 v[196:197], v238 offset:20480
    ds_read_b64_tr_b16 v[198:199], v238 offset:20992
    s_waitcnt lgkmcnt(8)
    v_mfma_f32_32x32x16_bf16 v[16:31], v[84:87], v[212:215], v[16:31]
    ds_read_b64_tr_b16 v[200:201], v237 offset:28672
    ds_read_b64_tr_b16 v[202:203], v237 offset:29184
    s_waitcnt lgkmcnt(8)
    v_mfma_f32_32x32x16_bf16 v[32:47], v[84:87], v[216:219], v[32:47]
    ds_read_b64_tr_b16 v[204:205], v238 offset:28672
    ds_read_b64_tr_b16 v[206:207], v238 offset:29184
    s_waitcnt lgkmcnt(8)
    v_mfma_f32_32x32x16_bf16 v[48:63], v[84:87], v[220:223], v[48:63]
    s_waitcnt vmcnt(10)
    s_barrier
    s_lshl_b32 s6, s36, 11
    s_and_b32 s7, s2, 3
    s_lshl_b32 s7, s7, 9
    s_add_u32 s6, s6, s7
    s_add_u32 s6, s6, 49160
    v_and_b32 v249, 31, v224
    v_lshl_add_u32 v249, v249, 4, s6
    s_cmp_lg_u32 s34, 0
    s_cbranch_scc1 k2_w5
    buffer_load_dword v248, v249, s[84:87], 0 offen sc1
k2_w5:
    s_mov_b32 s72, s22
    s_mov_b32 s73, s23
    s_mov_b32 s74, 0x1c0000
    s_mov_b32 s75, 0x00020000
    s_min_u32 s55, s54, 1791
    s_lshl_b32 s55, s55, 10
    buffer_load_dwordx4 v[252:255], v228, s[72:75], s55 offen offset:0
    ds_read_b64_tr_b16 v[208:209], v237 offset:22528
    ds_read_b64_tr_b16 v[210:211], v237 offset:23040
    s_waitcnt lgkmcnt(8)
    v_mfma_f32_32x32x16_bf16 v[0:15], v[88:91], v[192:195], v[0:15]
    ds_read_b64_tr_b16 v[212:213], v238 offset:22528
    ds_read_b64_tr_b16 v[214:215], v238 offset:23040
    s_waitcnt lgkmcnt(8)
    v_mfma_f32_32x32x16_bf16 v[16:31], v[88:91], v[196:199], v[16:31]
    ds_read_b64_tr_b16 v[216:217], v237 offset:30720
    ds_read_b64_tr_b16 v[218:219], v237 offset:31232
    s_waitcnt lgkmcnt(8)
    v_mfma_f32_32x32x16_bf16 v[32:47], v[88:91], v[200:203], v[32:47]
    ds_read_b64_tr_b16 v[220:221], v238 offset:30720
    ds_read_b64_tr_b16 v[222:223], v238 offset:31232
    s_waitcnt lgkmcnt(8)
    v_mfma_f32_32x32x16_bf16 v[48:63], v[88:91], v[204:207], v[48:63]
    ds_read_b64_tr_b16 v[192:193], v237 offset:32768
    ds_read_b64_tr_b16 v[194:195], v237 offset:33280
    s_waitcnt lgkmcnt(8)
    v_mfma_f32_32x32x16_bf16 v[0:15], v[92:95], v[208:211], v[0:15]
    ds_read_b64_tr_b16 v[196:197], v238 offset:32768
    ds_read_b64_tr_b16 v[198:199], v238 offset:33280
    s_waitcnt lgkmcnt(8)
    v_mfma_f32_32x32x16_bf16 v[16:31], v[92:95], v[212:215], v[16:31]
    s_add_u32 s37, s36, 4
    s_and_b32 s37, s37, 7
    s_mul_i32 s37, s37, 0x80000
    s_add_u32 m0, s39, 0x0
    s_nop 0
    buffer_load_dwordx4 v226, s[64:67], s37 offen offset:0 lds
    ds_read_b64_tr_b16 v[200:201], v237 offset:40960
    ds_read_b64_tr_b16 v[202:203], v237 offset:41472
    s_waitcnt lgkmcnt(8)
    v_mfma_f32_32x32x16_bf16 v[32:47], v[92:95], v[216:219], v[32:47]
    ds_read_b64_tr_b16 v[204:205], v238 offset:40960
    ds_read_b64_tr_b16 v[206:207], v238 offset:41472
    s_waitcnt lgkmcnt(8)
    v_mfma_f32_32x32x16_bf16 v[48:63], v[92:95], v[220:223], v[48:63]
    ds_read_b64_tr_b16 v[208:209], v237 offset:34816
    ds_read_b64_tr_b16 v[210:211], v237 offset:35328
    s_waitcnt lgkmcnt(8)
    v_mfma_f32_32x32x16_bf16 v[0:15], v[96:99], v[192:195], v[0:15]
    ds_read_b64_tr_b16 v[212:213], v238 offset:34816
    ds_read_b64_tr_b16 v[214:215], v238 offset:35328
    s_waitcnt lgkmcnt(8)
    v_mfma_f32_32x32x16_bf16 v[16:31], v[96:99], v[196:199], v[16:31]
    ds_read_b64_tr_b16 v[216:217], v237 offset:43008
    ds_read_b64_tr_b16 v[218:219], v237 offset:43520
    s_waitcnt lgkmcnt(8)
    v_mfma_f32_32x32x16_bf16 v[32:47], v[96:99], v[200:203], v[32:47]
    s_add_u32 m0, s39, 0x1f80
    s_nop 0
    buffer_load_dwordx4 v226, s[64:67], s37 offen offset:128 lds
    ds_read_b64_tr_b16 v[220:221], v238 offset:43008
    ds_read_b64_tr_b16 v[222:223], v238 offset:43520
    s_waitcnt lgkmcnt(8)
    v_mfma_f32_32x32x16_bf16 v[48:63], v[96:99], v[204:207], v[48:63]
    ds_read_b64_tr_b16 v[192:193], v237 offset:36864
    ds_read_b64_tr_b16 v[194:195], v237 offset:37376
    s_waitcnt lgkmcnt(8)
    v_mfma_f32_32x32x16_bf16 v[0:15], v[100:103], v[208:211], v[0:15]
    ds_read_b64_tr_b16 v[196:197], v238 offset:36864
    ds_read_b64_tr_b16 v[198:199], v238 offset:37376
    s_waitcnt lgkmcnt(8)
    v_mfma_f32_32x32x16_bf16 v[16:31], v[100:103], v[212:215], v[16:31]
    ds_read_b64_tr_b16 v[200:201], v237 offset:45056
    ds_read_b64_tr_b16 v[202:203], v237 offset:45568
    s_waitcnt lgkmcnt(8)
    v_mfma_f32_32x32x16_bf16 v[32:47], v[100:103], v[216:219], v[32:47]
    ds_read_b64_tr_b16 v[204:205], v238 offset:45056
    ds_read_b64_tr_b16 v[206:207], v238 offset:45568
    s_waitcnt lgkmcnt(8)
    v_mfma_f32_32x32x16_bf16 v[48:63], v[100:103], v[220:223], v[48:63]
    s_waitcnt vmcnt(3)
    s_barrier
    s_mov_b32 s72, s24
    s_mov_b32 s73, s25
    s_mov_b32 s74, 0x1c0000
    s_mov_b32 s75, 0x00020000
    s_min_u32 s55, s54, 1791
    s_lshl_b32 s55, s55, 10
    buffer_load_dwordx4 v[252:255], v228, s[72:75], s55 offen offset:0
    ds_read_b64_tr_b16 v[208:209], v237 offset:38912
    ds_read_b64_tr_b16 v[210:211], v237 offset:39424
    s_waitcnt lgkmcnt(8)
    v_mfma_f32_32x32x16_bf16 v[0:15], v[104:107], v[192:195], v[0:15]
    ds_read_b64_tr_b16 v[212:213], v238 offset:38912
    ds_read_b64_tr_b16 v[214:215], v238 offset:39424
    s_waitcnt lgkmcnt(8)
    v_mfma_f32_32x32x16_bf16 v[16:31], v[104:107], v[196:199], v[16:31]
    ds_read_b64_tr_b16 v[216:217], v237 offset:47104
    ds_read_b64_tr_b16 v[218:219], v237 offset:47616
    s_waitcnt lgkmcnt(8)
    v_mfma_f32_32x32x16_bf16 v[32:47], v[104:107], v[200:203], v[32:47]
    ds_read_b64_tr_b16 v[220:221], v238 offset:47104
    ds_read_b64_tr_b16 v[222:223], v238 offset:47616
    s_waitcnt lgkmcnt(8)
    v_mfma_f32_32x32x16_bf16 v[48:63], v[104:107], v[204:207], v[48:63]
    ds_read_b64_tr_b16 v[192:193], v237 offset:49152
    ds_read_b64_tr_b16 v[194:195], v237 offset:49664
    s_waitcnt lgkmcnt(8)
    v_mfma_f32_32x32x16_bf16 v[0:15], v[108:111], v[208:211], v[0:15]
    ds_read_b64_tr_b16 v[196:197], v238 offset:49152
    ds_read_b64_tr_b16 v[198:199], v238 offset:49664
    s_waitcnt lgkmcnt(8)
    v_mfma_f32_32x32x16_bf16 v[16:31], v[108:111], v[212:215], v[16:31]
    s_add_u32 s37, s36, 5
    s_and_b32 s37, s37, 7
    s_mul_i32 s37, s37, 0x80000
    s_add_u32 m0, s39, 0x4000
    s_nop 0
    buffer_load_dwordx4 v226, s[64:67], s37 offen offset:0 lds
    ds_read_b64_tr_b16 v[200:201], v237 offset:57344
    ds_read_b64_tr_b16 v[202:203], v237 offset:57856
    s_waitcnt lgkmcnt(8)
    v_mfma_f32_32x32x16_bf16 v[32:47], v[108:111], v[216:219], v[32:47]
    ds_read_b64_tr_b16 v[204:205], v238 offset:57344
    ds_read_b64_tr_b16 v[206:207], v238 offset:57856
    s_waitcnt lgkmcnt(8)
    v_mfma_f32_32x32x16_bf16 v[48:63], v[108:111], v[220:223], v[48:63]
    ds_read_b64_tr_b16 v[208:209], v237 offset:51200
    ds_read_b64_tr_b16 v[210:211], v237 offset:51712
    s_waitcnt lgkmcnt(8)
    v_mfma_f32_32x32x16_bf16 v[0:15], v[112:115], v[192:195], v[0:15]
    ds_read_b64_tr_b16 v[212:213], v238 offset:51200
    ds_read_b64_tr_b16 v[214:215], v238 offset:51712
    s_waitcnt lgkmcnt(8)
    v_mfma_f32_32x32x16_bf16 v[16:31], v[112:115], v[196:199], v[16:31]
    ds_read_b64_tr_b16 v[216:217], v237 offset:59392
    ds_read_b64_tr_b16 v[218:219], v237 offset:59904
    s_waitcnt lgkmcnt(8)
    v_mfma_f32_32x32x16_bf16 v[32:47], v[112:115], v[200:203], v[32:47]
    s_add_u32 m0, s39, 0x5f80
    s_nop 0
    buffer_load_dwordx4 v226, s[64:67], s37 offen offset:128 lds
    ds_read_b64_tr_b16 v[220:221], v238 offset:59392
    ds_read_b64_tr_b16 v[222:223], v238 offset:59904
    s_waitcnt lgkmcnt(8)
    v_mfma_f32_32x32x16_bf16 v[48:63], v[112:115], v[204:207], v[48:63]
    ds_read_b64_tr_b16 v[192:193], v237 offset:53248
    ds_read_b64_tr_b16 v[194:195], v237 offset:53760
    s_waitcnt lgkmcnt(8)
    v_mfma_f32_32x32x16_bf16 v[0:15], v[116:119], v[208:211], v[0:15]
    ds_read_b64_tr_b16 v[196:197], v238 offset:53248
    ds_read_b64_tr_b16 v[198:199], v238 offset:53760
    s_waitcnt lgkmcnt(8)
    v_mfma_f32_32x32x16_bf16 v[16:31], v[116:119], v[212:215], v[16:31]
    ds_read_b64_tr_b16 v[200:201], v237 offset:61440
    ds_read_b64_tr_b16 v[202:203], v237 offset:61952
    s_waitcnt lgkmcnt(8)
    v_mfma_f32_32x32x16_bf16 v[32:47], v[116:119], v[216:219], v[32:47]
    ds_read_b64_tr_b16 v[204:205], v238 offset:61440
    ds_read_b64_tr_b16 v[206:207], v238 offset:61952
    s_waitcnt lgkmcnt(8)
    v_mfma_f32_32x32x16_bf16 v[48:63], v[116:119], v[220:223], v[48:63]
    s_waitcnt vmcnt(3)
    s_barrier
    s_cmp_lg_u32 s34, 0
    s_cbranch_scc1 k2_w6
    v_and_b32 v248, 1, v248
    v_cmp_ne_u32 vcc, 1, v248
    s_cbranch_vccnz k2_spinx
k2_spx:
k2_w6:
    s_mov_b32 s72, s12
    s_mov_b32 s73, s13
    s_mov_b32 s74, 0x400000
    s_mov_b32 s75, 0x00020000
    s_min_u32 s55, s54, 2047
    s_lshl_b32 s55, s55, 11
    buffer_load_dwordx4 v[252:255], v228, s[72:75], s55 offen offset:0
    ds_read_b64_tr_b16 v[208:209], v237 offset:55296
    ds_read_b64_tr_b16 v[210:211], v237 offset:55808
    s_waitcnt lgkmcnt(8)
    v_mfma_f32_32x32x16_bf16 v[0:15], v[120:123], v[192:195], v[0:15]
    ds_read_b64_tr_b16 v[212:213], v238 offset:55296
    ds_read_b64_tr_b16 v[214:215], v238 offset:55808
    s_waitcnt lgkmcnt(8)
    v_mfma_f32_32x32x16_bf16 v[16:31], v[120:123], v[196:199], v[16:31]
    ds_read_b64_tr_b16 v[216:217], v237 offset:63488
    ds_read_b64_tr_b16 v[218:219], v237 offset:64000
    s_waitcnt lgkmcnt(8)
    v_mfma_f32_32x32x16_bf16 v[32:47], v[120:123], v[200:203], v[32:47]
    ds_read_b64_tr_b16 v[220:221], v238 offset:63488
    ds_read_b64_tr_b16 v[222:223], v238 offset:64000
    s_waitcnt lgkmcnt(8)
    v_mfma_f32_32x32x16_bf16 v[48:63], v[120:123], v[204:207], v[48:63]
    buffer_load_dwordx4 v[252:255], v228, s[72:75], s55 offen offset:1024
    ds_read_b64_tr_b16 v[192:193], v237 offset:0
    ds_read_b64_tr_b16 v[194:195], v237 offset:512
    s_waitcnt lgkmcnt(8)
    v_mfma_f32_32x32x16_bf16 v[0:15], v[124:127], v[208:211], v[0:15]
    ds_read_b64_tr_b16 v[196:197], v238 offset:0
    ds_read_b64_tr_b16 v[198:199], v238 offset:512
    s_waitcnt lgkmcnt(8)
    v_mfma_f32_32x32x16_bf16 v[16:31], v[124:127], v[212:215], v[16:31]
    ds_read_b64_tr_b16 v[200:201], v237 offset:8192
    ds_read_b64_tr_b16 v[202:203], v237 offset:8704
    s_waitcnt lgkmcnt(8)
    v_mfma_f32_32x32x16_bf16 v[32:47], v[124:127], v[216:219], v[32:47]
    ds_read_b64_tr_b16 v[204:205], v238 offset:8192
    ds_read_b64_tr_b16 v[206:207], v238 offset:8704
    s_waitcnt lgkmcnt(8)
    v_mfma_f32_32x32x16_bf16 v[48:63], v[124:127], v[220:223], v[48:63]
    s_add_u32 s37, s36, 6
    s_and_b32 s37, s37, 7
    s_mul_i32 s37, s37, 0x80000
    s_add_u32 m0, s39, 0x8000
    s_nop 0
    buffer_load_dwordx4 v226, s[64:67], s37 offen offset:0 lds
    ds_read_b64_tr_b16 v[208:209], v237 offset:2048
    ds_read_b64_tr_b16 v[210:211], v237 offset:2560
    s_waitcnt lgkmcnt(8)
    v_mfma_f32_32x32x16_bf16 v[0:15], v[128:131], v[192:195], v[0:15]
    ds_read_b64_tr_b16 v[212:213], v238 offset:2048
    ds_read_b64_tr_b16 v[214:215], v238 offset:2560
    s_waitcnt lgkmcnt(8)
    v_mfma_f32_32x32x16_bf16 v[16:31], v[128:131], v[196:199], v[16:31]
    ds_read_b64_tr_b16 v[216:217], v237 offset:10240
    ds_read_b64_tr_b16 v[218:219], v237 offset:10752
    s_waitcnt lgkmcnt(8)
    v_mfma_f32_32x32x16_bf16 v[32:47], v[128:131], v[200:203], v[32:47]
    ds_read_b64_tr_b16 v[220:221], v238 offset:10240
    ds_read_b64_tr_b16 v[222:223], v238 offset:10752
    s_waitcnt lgkmcnt(8)
    v_mfma_f32_32x32x16_bf16 v[48:63], v[128:131], v[204:207], v[48:63]
    s_add_u32 m0, s39, 0x9f80
    s_nop 0
    buffer_load_dwordx4 v226, s[64:67], s37 offen offset:128 lds
    ds_read_b64_tr_b16 v[192:193], v237 offset:4096
    ds_read_b64_tr_b16 v[194:195], v237 offset:4608
    s_waitcnt lgkmcnt(8)
    v_mfma_f32_32x32x16_bf16 v[0:15], v[132:135], v[208:211], v[0:15]
    ds_read_b64_tr_b16 v[196:197], v238 offset:4096
    ds_read_b64_tr_b16 v[198:199], v238 offset:4608
    s_waitcnt lgkmcnt(8)
    v_mfma_f32_32x32x16_bf16 v[16:31], v[132:135], v[212:215], v[16:31]
    ds_read_b64_tr_b16 v[200:201], v237 offset:12288
    ds_read_b64_tr_b16 v[202:203], v237 offset:12800
    s_waitcnt lgkmcnt(8)
    v_mfma_f32_32x32x16_bf16 v[32:47], v[132:135], v[216:219], v[32:47]
    ds_read_b64_tr_b16 v[204:205], v238 offset:12288
    ds_read_b64_tr_b16 v[206:207], v238 offset:12800
    s_waitcnt lgkmcnt(8)
    v_mfma_f32_32x32x16_bf16 v[48:63], v[132:135], v[220:223], v[48:63]
    s_waitcnt vmcnt(4)
    s_barrier
    s_add_u32 s59, s36, 0
    s_and_b32 s59, s59, 7
    s_lshl_b32 s59, s59, 12
    s_add_u32 s59, s59, s51
    buffer_load_dwordx4 v[64:67], v228, s[60:63], s59 offen offset:0
    ds_read_b64_tr_b16 v[208:209], v237 offset:6144
    ds_read_b64_tr_b16 v[210:211], v237 offset:6656
    s_waitcnt lgkmcnt(8)
    v_mfma_f32_32x32x16_bf16 v[0:15], v[136:139], v[192:195], v[0:15]
    buffer_load_dwordx4 v[68:71], v228, s[60:63], s59 offen offset:1024
    ds_read_b64_tr_b16 v[212:213], v238 offset:6144
    ds_read_b64_tr_b16 v[214:215], v238 offset:6656
    s_waitcnt lgkmcnt(8)
    v_mfma_f32_32x32x16_bf16 v[16:31], v[136:139], v[196:199], v[16:31]
    buffer_load_dwordx4 v[72:75], v228, s[60:63], s59 offen offset:2048
    ds_read_b64_tr_b16 v[216:217], v237 offset:14336
    ds_read_b64_tr_b16 v[218:219], v237 offset:14848
    s_waitcnt lgkmcnt(8)
    v_mfma_f32_32x32x16_bf16 v[32:47], v[136:139], v[200:203], v[32:47]
    buffer_load_dwordx4 v[76:79], v228, s[60:63], s59 offen offset:3072
    ds_read_b64_tr_b16 v[220:221], v238 offset:14336
    ds_read_b64_tr_b16 v[222:223], v238 offset:14848
    s_waitcnt lgkmcnt(8)
    v_mfma_f32_32x32x16_bf16 v[48:63], v[136:139], v[204:207], v[48:63]
    s_add_u32 s59, s36, 1
    s_and_b32 s59, s59, 7
    s_lshl_b32 s59, s59, 12
    s_add_u32 s59, s59, s51
    buffer_load_dwordx4 v[80:83], v228, s[60:63], s59 offen offset:0
    ds_read_b64_tr_b16 v[192:193], v237 offset:16384
    ds_read_b64_tr_b16 v[194:195], v237 offset:16896
    s_waitcnt lgkmcnt(8)
    v_mfma_f32_32x32x16_bf16 v[0:15], v[140:143], v[208:211], v[0:15]
    buffer_load_dwordx4 v[84:87], v228, s[60:63], s59 offen offset:1024
    ds_read_b64_tr_b16 v[196:197], v238 offset:16384
    ds_read_b64_tr_b16 v[198:199], v238 offset:16896
    s_waitcnt lgkmcnt(8)
    v_mfma_f32_32x32x16_bf16 v[16:31], v[140:143], v[212:215], v[16:31]
    buffer_load_dwordx4 v[88:91], v228, s[60:63], s59 offen offset:2048
    ds_read_b64_tr_b16 v[200:201], v237 offset:24576
    ds_read_b64_tr_b16 v[202:203], v237 offset:25088
    s_waitcnt lgkmcnt(8)
    v_mfma_f32_32x32x16_bf16 v[32:47], v[140:143], v[216:219], v[32:47]
    buffer_load_dwordx4 v[92:95], v228, s[60:63], s59 offen offset:3072
    ds_read_b64_tr_b16 v[204:205], v238 offset:24576
    ds_read_b64_tr_b16 v[206:207], v238 offset:25088
    s_waitcnt lgkmcnt(8)
    v_mfma_f32_32x32x16_bf16 v[48:63], v[140:143], v[220:223], v[48:63]
    s_add_u32 s59, s36, 2
    s_and_b32 s59, s59, 7
    s_lshl_b32 s59, s59, 12
    s_add_u32 s59, s59, s51
    buffer_load_dwordx4 v[96:99], v228, s[60:63], s59 offen offset:0
    buffer_load_dwordx4 v[100:103], v228, s[60:63], s59 offen offset:1024
    ds_read_b64_tr_b16 v[208:209], v237 offset:18432
    ds_read_b64_tr_b16 v[210:211], v237 offset:18944
    s_waitcnt lgkmcnt(8)
    v_mfma_f32_32x32x16_bf16 v[0:15], v[144:147], v[192:195], v[0:15]
    buffer_load_dwordx4 v[104:107], v228, s[60:63], s59 offen offset:2048
    ds_read_b64_tr_b16 v[212:213], v238 offset:18432
    ds_read_b64_tr_b16 v[214:215], v238 offset:18944
    s_waitcnt lgkmcnt(8)
    v_mfma_f32_32x32x16_bf16 v[16:31], v[144:147], v[196:199], v[16:31]
    buffer_load_dwordx4 v[108:111], v228, s[60:63], s59 offen offset:3072
    ds_read_b64_tr_b16 v[216:217], v237 offset:26624
    ds_read_b64_tr_b16 v[218:219], v237 offset:27136
    s_waitcnt lgkmcnt(8)
    v_mfma_f32_32x32x16_bf16 v[32:47], v[144:147], v[200:203], v[32:47]
    s_add_u32 s59, s36, 3
    s_and_b32 s59, s59, 7
    s_lshl_b32 s59, s59, 12
    s_add_u32 s59, s59, s51
    buffer_load_dwordx4 v[112:115], v228, s[60:63], s59 offen offset:0
    ds_read_b64_tr_b16 v[220:221], v238 offset:26624
    ds_read_b64_tr_b16 v[222:223], v238 offset:27136
    s_waitcnt lgkmcnt(8)
    v_mfma_f32_32x32x16_bf16 v[48:63], v[144:147], v[204:207], v[48:63]
    buffer_load_dwordx4 v[116:119], v228, s[60:63], s59 offen offset:1024
    ds_read_b64_tr_b16 v[192:193], v237 offset:20480
    ds_read_b64_tr_b16 v[194:195], v237 offset:20992
    s_waitcnt lgkmcnt(8)
    v_mfma_f32_32x32x16_bf16 v[0:15], v[148:151], v[208:211], v[0:15]
    buffer_load_dwordx4 v[120:123], v228, s[60:63], s59 offen offset:2048
    ds_read_b64_tr_b16 v[196:197], v238 offset:20480
    ds_read_b64_tr_b16 v[198:199], v238 offset:20992
    s_waitcnt lgkmcnt(8)
    v_mfma_f32_32x32x16_bf16 v[16:31], v[148:151], v[212:215], v[16:31]
    buffer_load_dwordx4 v[124:127], v228, s[60:63], s59 offen offset:3072
    ds_read_b64_tr_b16 v[200:201], v237 offset:28672
    ds_read_b64_tr_b16 v[202:203], v237 offset:29184
    s_waitcnt lgkmcnt(8)
    v_mfma_f32_32x32x16_bf16 v[32:47], v[148:151], v[216:219], v[32:47]
    s_add_u32 s37, s36, 7
    s_and_b32 s37, s37, 7
    s_mul_i32 s37, s37, 0x80000
    s_add_u32 m0, s39, 0xc000
    s_nop 0
    buffer_load_dwordx4 v226, s[64:67], s37 offen offset:0 lds
    ds_read_b64_tr_b16 v[204:205], v238 offset:28672
    ds_read_b64_tr_b16 v[206:207], v238 offset:29184
    s_waitcnt lgkmcnt(8)
    v_mfma_f32_32x32x16_bf16 v[48:63], v[148:151], v[220:223], v[48:63]
    s_add_u32 m0, s39, 0xdf80
    s_nop 0
    buffer_load_dwordx4 v226, s[64:67], s37 offen offset:128 lds
    s_waitcnt vmcnt(18)
    s_barrier
    s_mov_b32 s68, s22
    s_mov_b32 s69, s23
    s_mov_b32 s70, 0x1c0000
    s_mov_b32 s71, 0x00020000
    s_mov_b32 s72, s24
    s_mov_b32 s73, s25
    s_mov_b32 s74, 0x1c0000
    s_mov_b32 s75, 0x00020000
    s_mov_b32 s64, s12
    s_mov_b32 s65, s13
    s_mov_b32 s66, 0x400000
    s_mov_b32 s67, 0x00020000
    s_add_u32 s80, s32, 0x2400000
    s_addc_u32 s81, s33, 0
    s_mov_b32 s82, 0x700000
    s_mov_b32 s83, 0x00020000
    s_add_u32 s59, s36, 4
    s_and_b32 s59, s59, 7
    s_lshl_b32 s59, s59, 12
    s_add_u32 s59, s59, s51
    buffer_load_dwordx4 v[128:131], v228, s[60:63], s59 offen offset:0
    ds_read_b64_tr_b16 v[208:209], v237 offset:22528
    ds_read_b64_tr_b16 v[210:211], v237 offset:23040
    s_waitcnt lgkmcnt(8)
    v_mfma_f32_32x32x16_bf16 v[0:15], v[152:155], v[192:195], v[0:15]
    ds_read_b64_tr_b16 v[212:213], v238 offset:22528
    ds_read_b64_tr_b16 v[214:215], v238 offset:23040
    s_waitcnt lgkmcnt(8)
    v_mfma_f32_32x32x16_bf16 v[16:31], v[152:155], v[196:199], v[16:31]
    ds_read_b64_tr_b16 v[216:217], v237 offset:30720
    ds_read_b64_tr_b16 v[218:219], v237 offset:31232
    s_waitcnt lgkmcnt(8)
    v_mfma_f32_32x32x16_bf16 v[32:47], v[152:155], v[200:203], v[32:47]
    buffer_load_dwordx4 v[132:135], v228, s[60:63], s59 offen offset:1024
    ds_read_b64_tr_b16 v[220:221], v238 offset:30720
    ds_read_b64_tr_b16 v[222:223], v238 offset:31232
    s_waitcnt lgkmcnt(8)
    v_mfma_f32_32x32x16_bf16 v[48:63], v[152:155], v[204:207], v[48:63]
    ds_read_b64_tr_b16 v[192:193], v237 offset:32768
    ds_read_b64_tr_b16 v[194:195], v237 offset:33280
    s_waitcnt lgkmcnt(8)
    v_mfma_f32_32x32x16_bf16 v[0:15], v[156:159], v[208:211], v[0:15]
    ds_read_b64_tr_b16 v[196:197], v238 offset:32768
    ds_read_b64_tr_b16 v[198:199], v238 offset:33280
    s_waitcnt lgkmcnt(8)
    v_mfma_f32_32x32x16_bf16 v[16:31], v[156:159], v[212:215], v[16:31]
    buffer_load_dwordx4 v[136:139], v228, s[60:63], s59 offen offset:2048
    ds_read_b64_tr_b16 v[200:201], v237 offset:40960
    ds_read_b64_tr_b16 v[202:203], v237 offset:41472
    s_waitcnt lgkmcnt(8)
    v_mfma_f32_32x32x16_bf16 v[32:47], v[156:159], v[216:219], v[32:47]
    ds_read_b64_tr_b16 v[204:205], v238 offset:40960
    ds_read_b64_tr_b16 v[206:207], v238 offset:41472
    s_waitcnt lgkmcnt(8)
    v_mfma_f32_32x32x16_bf16 v[48:63], v[156:159], v[220:223], v[48:63]
    buffer_load_dwordx4 v[140:143], v228, s[60:63], s59 offen offset:3072
    ds_read_b64_tr_b16 v[208:209], v237 offset:34816
    ds_read_b64_tr_b16 v[210:211], v237 offset:35328
    s_waitcnt lgkmcnt(8)
    v_mfma_f32_32x32x16_bf16 v[0:15], v[160:163], v[192:195], v[0:15]
    ds_read_b64_tr_b16 v[212:213], v238 offset:34816
    ds_read_b64_tr_b16 v[214:215], v238 offset:35328
    s_waitcnt lgkmcnt(8)
    v_mfma_f32_32x32x16_bf16 v[16:31], v[160:163], v[196:199], v[16:31]
    ds_read_b64_tr_b16 v[216:217], v237 offset:43008
    ds_read_b64_tr_b16 v[218:219], v237 offset:43520
    s_waitcnt lgkmcnt(8)
    v_mfma_f32_32x32x16_bf16 v[32:47], v[160:163], v[200:203], v[32:47]
    s_add_u32 s37, s36, 0
    s_and_b32 s37, s37, 7
    s_mul_i32 s37, s37, 0x38000
    s_add_u32 m0, s39, 0x0
    s_nop 0
    buffer_load_dwordx4 v227, s[68:71], s37 offen offset:0 lds
    ds_read_b64_tr_b16 v[220:221], v238 offset:43008
    ds_read_b64_tr_b16 v[222:223], v238 offset:43520
    s_waitcnt lgkmcnt(8)
    v_mfma_f32_32x32x16_bf16 v[48:63], v[160:163], v[204:207], v[48:63]
    ds_read_b64_tr_b16 v[192:193], v237 offset:36864
    ds_read_b64_tr_b16 v[194:195], v237 offset:37376
    s_waitcnt lgkmcnt(8)
    v_mfma_f32_32x32x16_bf16 v[0:15], v[164:167], v[208:211], v[0:15]
    ds_read_b64_tr_b16 v[196:197], v238 offset:36864
    ds_read_b64_tr_b16 v[198:199], v238 offset:37376
    s_waitcnt lgkmcnt(8)
    v_mfma_f32_32x32x16_bf16 v[16:31], v[164:167], v[212:215], v[16:31]
    s_add_u32 m0, s39, 0x2000
    s_nop 0
    buffer_load_dwordx4 v227, s[72:75], s37 offen offset:0 lds
    ds_read_b64_tr_b16 v[200:201], v237 offset:45056
    ds_read_b64_tr_b16 v[202:203], v237 offset:45568
    s_waitcnt lgkmcnt(8)
    v_mfma_f32_32x32x16_bf16 v[32:47], v[164:167], v[216:219], v[32:47]
    ds_read_b64_tr_b16 v[204:205], v238 offset:45056
    ds_read_b64_tr_b16 v[206:207], v238 offset:45568
    s_waitcnt lgkmcnt(8)
    v_mfma_f32_32x32x16_bf16 v[48:63], v[164:167], v[220:223], v[48:63]
    s_waitcnt vmcnt(6)
    s_barrier
    s_add_u32 s59, s36, 5
    s_and_b32 s59, s59, 7
    s_lshl_b32 s59, s59, 12
    s_add_u32 s59, s59, s51
    buffer_load_dwordx4 v[144:147], v228, s[60:63], s59 offen offset:0
    ds_read_b64_tr_b16 v[208:209], v237 offset:38912
    ds_read_b64_tr_b16 v[210:211], v237 offset:39424
    s_waitcnt lgkmcnt(8)
    v_mfma_f32_32x32x16_bf16 v[0:15], v[168:171], v[192:195], v[0:15]
    ds_read_b64_tr_b16 v[212:213], v238 offset:38912
    ds_read_b64_tr_b16 v[214:215], v238 offset:39424
    s_waitcnt lgkmcnt(8)
    v_mfma_f32_32x32x16_bf16 v[16:31], v[168:171], v[196:199], v[16:31]
    ds_read_b64_tr_b16 v[216:217], v237 offset:47104
    ds_read_b64_tr_b16 v[218:219], v237 offset:47616
    s_waitcnt lgkmcnt(8)
    v_mfma_f32_32x32x16_bf16 v[32:47], v[168:171], v[200:203], v[32:47]
    buffer_load_dwordx4 v[148:151], v228, s[60:63], s59 offen offset:1024
    ds_read_b64_tr_b16 v[220:221], v238 offset:47104
    ds_read_b64_tr_b16 v[222:223], v238 offset:47616
    s_waitcnt lgkmcnt(8)
    v_mfma_f32_32x32x16_bf16 v[48:63], v[168:171], v[204:207], v[48:63]
    ds_read_b64_tr_b16 v[192:193], v237 offset:49152
    ds_read_b64_tr_b16 v[194:195], v237 offset:49664
    s_waitcnt lgkmcnt(8)
    v_mfma_f32_32x32x16_bf16 v[0:15], v[172:175], v[208:211], v[0:15]
    ds_read_b64_tr_b16 v[196:197], v238 offset:49152
    ds_read_b64_tr_b16 v[198:199], v238 offset:49664
    s_waitcnt lgkmcnt(8)
    v_mfma_f32_32x32x16_bf16 v[16:31], v[172:175], v[212:215], v[16:31]
    buffer_load_dwordx4 v[152:155], v228, s[60:63], s59 offen offset:2048
    ds_read_b64_tr_b16 v[200:201], v237 offset:57344
    ds_read_b64_tr_b16 v[202:203], v237 offset:57856
    s_waitcnt lgkmcnt(8)
    v_mfma_f32_32x32x16_bf16 v[32:47], v[172:175], v[216:219], v[32:47]
    ds_read_b64_tr_b16 v[204:205], v238 offset:57344
    ds_read_b64_tr_b16 v[206:207], v238 offset:57856
    s_waitcnt lgkmcnt(8)
    v_mfma_f32_32x32x16_bf16 v[48:63], v[172:175], v[220:223], v[48:63]
    buffer_load_dwordx4 v[156:159], v228, s[60:63], s59 offen offset:3072
    ds_read_b64_tr_b16 v[208:209], v237 offset:51200
    ds_read_b64_tr_b16 v[210:211], v237 offset:51712
    s_waitcnt lgkmcnt(8)
    v_mfma_f32_32x32x16_bf16 v[0:15], v[176:179], v[192:195], v[0:15]
    ds_read_b64_tr_b16 v[212:213], v238 offset:51200
    ds_read_b64_tr_b16 v[214:215], v238 offset:51712
    s_waitcnt lgkmcnt(8)
    v_mfma_f32_32x32x16_bf16 v[16:31], v[176:179], v[196:199], v[16:31]
    ds_read_b64_tr_b16 v[216:217], v237 offset:59392
    ds_read_b64_tr_b16 v[218:219], v237 offset:59904
    s_waitcnt lgkmcnt(8)
    v_mfma_f32_32x32x16_bf16 v[32:47], v[176:179], v[200:203], v[32:47]
    s_add_u32 s37, s36, 1
    s_and_b32 s37, s37, 7
    s_mul_i32 s37, s37, 0x38000
    s_add_u32 m0, s39, 0x4000
    s_nop 0
    buffer_load_dwordx4 v227, s[68:71], s37 offen offset:0 lds
    ds_read_b64_tr_b16 v[220:221], v238 offset:59392
    ds_read_b64_tr_b16 v[222:223], v238 offset:59904
    s_waitcnt lgkmcnt(8)
    v_mfma_f32_32x32x16_bf16 v[48:63], v[176:179], v[204:207], v[48:63]
    ds_read_b64_tr_b16 v[192:193], v237 offset:53248
    ds_read_b64_tr_b16 v[194:195], v237 offset:53760
    s_waitcnt lgkmcnt(8)
    v_mfma_f32_32x32x16_bf16 v[0:15], v[180:183], v[208:211], v[0:15]
    ds_read_b64_tr_b16 v[196:197], v238 offset:53248
    ds_read_b64_tr_b16 v[198:199], v238 offset:53760
    s_waitcnt lgkmcnt(8)
    v_mfma_f32_32x32x16_bf16 v[16:31], v[180:183], v[212:215], v[16:31]
    s_add_u32 m0, s39, 0x6000
    s_nop 0
    buffer_load_dwordx4 v227, s[72:75], s37 offen offset:0 lds
    ds_read_b64_tr_b16 v[200:201], v237 offset:61440
    ds_read_b64_tr_b16 v[202:203], v237 offset:61952
    s_waitcnt lgkmcnt(8)
    v_mfma_f32_32x32x16_bf16 v[32:47], v[180:183], v[216:219], v[32:47]
    ds_read_b64_tr_b16 v[204:205], v238 offset:61440
    ds_read_b64_tr_b16 v[206:207], v238 offset:61952
    s_waitcnt lgkmcnt(8)
    v_mfma_f32_32x32x16_bf16 v[48:63], v[180:183], v[220:223], v[48:63]
    s_waitcnt vmcnt(6)
    s_barrier
    s_add_u32 s59, s36, 6
    s_and_b32 s59, s59, 7
    s_lshl_b32 s59, s59, 12
    s_add_u32 s59, s59, s51
    buffer_load_dwordx4 v[160:163], v228, s[60:63], s59 offen offset:0
    ds_read_b64_tr_b16 v[208:209], v237 offset:55296
    ds_read_b64_tr_b16 v[210:211], v237 offset:55808
    s_waitcnt lgkmcnt(8)
    v_mfma_f32_32x32x16_bf16 v[0:15], v[184:187], v[192:195], v[0:15]
    ds_read_b64_tr_b16 v[212:213], v238 offset:55296
    ds_read_b64_tr_b16 v[214:215], v238 offset:55808
    s_waitcnt lgkmcnt(8)
    v_mfma_f32_32x32x16_bf16 v[16:31], v[184:187], v[196:199], v[16:31]
    ds_read_b64_tr_b16 v[216:217], v237 offset:63488
    ds_read_b64_tr_b16 v[218:219], v237 offset:64000
    s_waitcnt lgkmcnt(8)
    v_mfma_f32_32x32x16_bf16 v[32:47], v[184:187], v[200:203], v[32:47]
    buffer_load_dwordx4 v[164:167], v228, s[60:63], s59 offen offset:1024
    ds_read_b64_tr_b16 v[220:221], v238 offset:63488
    ds_read_b64_tr_b16 v[222:223], v238 offset:64000
    s_waitcnt lgkmcnt(8)
    v_mfma_f32_32x32x16_bf16 v[48:63], v[184:187], v[204:207], v[48:63]
    ds_read_b64_tr_b16 v[192:193], v237 offset:0
    ds_read_b64_tr_b16 v[194:195], v237 offset:512
    s_waitcnt lgkmcnt(8)
    v_mfma_f32_32x32x16_bf16 v[0:15], v[188:191], v[208:211], v[0:15]
    ds_read_b64_tr_b16 v[196:197], v238 offset:0
    ds_read_b64_tr_b16 v[198:199], v238 offset:512
    s_waitcnt lgkmcnt(8)
    v_mfma_f32_32x32x16_bf16 v[16:31], v[188:191], v[212:215], v[16:31]
    buffer_load_dwordx4 v[168:171], v228, s[60:63], s59 offen offset:2048
    ds_read_b64_tr_b16 v[200:201], v237 offset:8192
    ds_read_b64_tr_b16 v[202:203], v237 offset:8704
    s_waitcnt lgkmcnt(8)
    v_mfma_f32_32x32x16_bf16 v[32:47], v[188:191], v[216:219], v[32:47]
    ds_read_b64_tr_b16 v[204:205], v238 offset:8192
    ds_read_b64_tr_b16 v[206:207], v238 offset:8704
    s_waitcnt lgkmcnt(8)
    v_mfma_f32_32x32x16_bf16 v[48:63], v[188:191], v[220:223], v[48:63]
    buffer_load_dwordx4 v[172:175], v228, s[60:63], s59 offen offset:3072
    v_cvt_pk_bf16_f32 v240, v0, v1
    v_cvt_pk_bf16_f32 v241, v2, v3
    v_cvt_pk_bf16_f32 v242, v4, v5
    v_cvt_pk_bf16_f32 v243, v6, v7
    s_mov_b32 s38, 0x4000
    buffer_store_dwordx4 v[240:243], v233, s[76:79], s38 offen offset:0 sc1
    v_cvt_pk_bf16_f32 v244, v8, v9
    v_cvt_pk_bf16_f32 v245, v10, v11
    v_cvt_pk_bf16_f32 v246, v12, v13
    v_cvt_pk_bf16_f32 v247, v14, v15
    buffer_store_dwordx4 v[244:247], v233, s[76:79], s38 offen offset:1024 sc1
    v_cvt_pk_bf16_f32 v240, v16, v17
    v_cvt_pk_bf16_f32 v241, v18, v19
    v_cvt_pk_bf16_f32 v242, v20, v21
    v_cvt_pk_bf16_f32 v243, v22, v23
    buffer_store_dwordx4 v[240:243], v233, s[76:79], s38 offen offset:2048 sc1
    v_cvt_pk_bf16_f32 v244, v24, v25
    v_cvt_pk_bf16_f32 v245, v26, v27
    v_cvt_pk_bf16_f32 v246, v28, v29
    v_cvt_pk_bf16_f32 v247, v30, v31
    buffer_store_dwordx4 v[244:247], v233, s[76:79], s38 offen offset:3072 sc1
    v_cvt_pk_bf16_f32 v240, v32, v33
    v_cvt_pk_bf16_f32 v241, v34, v35
    v_cvt_pk_bf16_f32 v242, v36, v37
    v_cvt_pk_bf16_f32 v243, v38, v39
    s_mov_b32 s38, 0x5000
    buffer_store_dwordx4 v[240:243], v233, s[76:79], s38 offen offset:0 sc1
    v_cvt_pk_bf16_f32 v244, v40, v41
    v_cvt_pk_bf16_f32 v245, v42, v43
    v_cvt_pk_bf16_f32 v246, v44, v45
    v_cvt_pk_bf16_f32 v247, v46, v47
    buffer_store_dwordx4 v[244:247], v233, s[76:79], s38 offen offset:1024 sc1
    v_cvt_pk_bf16_f32 v240, v48, v49
    v_cvt_pk_bf16_f32 v241, v50, v51
    v_cvt_pk_bf16_f32 v242, v52, v53
    v_cvt_pk_bf16_f32 v243, v54, v55
    buffer_store_dwordx4 v[240:243], v233, s[76:79], s38 offen offset:2048 sc1
    v_cvt_pk_bf16_f32 v244, v56, v57
    v_cvt_pk_bf16_f32 v245, v58, v59
    v_cvt_pk_bf16_f32 v246, v60, v61
    v_cvt_pk_bf16_f32 v247, v62, v63
    buffer_store_dwordx4 v[244:247], v233, s[76:79], s38 offen offset:3072 sc1
    ds_read_b64_tr_b16 v[208:209], v237 offset:2048
    ds_read_b64_tr_b16 v[210:211], v237 offset:2560
    s_waitcnt lgkmcnt(8)
    v_mfma_f32_32x32x16_bf16 v[0:15], v[192:195], v[64:67], 0
    ds_read_b64_tr_b16 v[212:213], v238 offset:2048
    ds_read_b64_tr_b16 v[214:215], v238 offset:2560
    s_waitcnt lgkmcnt(8)
    v_mfma_f32_32x32x16_bf16 v[16:31], v[196:199], v[64:67], 0
    ds_read_b64_tr_b16 v[216:217], v237 offset:10240
    ds_read_b64_tr_b16 v[218:219], v237 offset:10752
    s_waitcnt lgkmcnt(8)
    v_mfma_f32_32x32x16_bf16 v[32:47], v[200:203], v[64:67], 0
    s_add_u32 s37, s36, 2
    s_and_b32 s37, s37, 7
    s_mul_i32 s37, s37, 0x38000
    s_add_u32 m0, s39, 0x8000
    s_nop 0
    buffer_load_dwordx4 v227, s[68:71], s37 offen offset:0 lds
    ds_read_b64_tr_b16 v[220:221], v238 offset:10240
    ds_read_b64_tr_b16 v[222:223], v238 offset:10752
    s_waitcnt lgkmcnt(8)
    v_mfma_f32_32x32x16_bf16 v[48:63], v[204:207], v[64:67], 0
    ds_read_b64_tr_b16 v[192:193], v237 offset:4096
    ds_read_b64_tr_b16 v[194:195], v237 offset:4608
    s_waitcnt lgkmcnt(8)
    v_mfma_f32_32x32x16_bf16 v[0:15], v[208:211], v[68:71], v[0:15]
    ds_read_b64_tr_b16 v[196:197], v238 offset:4096
    ds_read_b64_tr_b16 v[198:199], v238 offset:4608
    s_waitcnt lgkmcnt(8)
    v_mfma_f32_32x32x16_bf16 v[16:31], v[212:215], v[68:71], v[16:31]
    s_add_u32 m0, s39, 0xa000
    s_nop 0
    buffer_load_dwordx4 v227, s[72:75], s37 offen offset:0 lds
    ds_read_b64_tr_b16 v[200:201], v237 offset:12288
    ds_read_b64_tr_b16 v[202:203], v237 offset:12800
    s_waitcnt lgkmcnt(8)
    v_mfma_f32_32x32x16_bf16 v[32:47], v[216:219], v[68:71], v[32:47]
    ds_read_b64_tr_b16 v[204:205], v238 offset:12288
    ds_read_b64_tr_b16 v[206:207], v238 offset:12800
    s_waitcnt lgkmcnt(8)
    v_mfma_f32_32x32x16_bf16 v[48:63], v[220:223], v[68:71], v[48:63]
    s_waitcnt vmcnt(14)
    s_barrier
    s_add_u32 s59, s36, 7
    s_and_b32 s59, s59, 7
    s_lshl_b32 s59, s59, 12
    s_add_u32 s59, s59, s51
    buffer_load_dwordx4 v[176:179], v228, s[60:63], s59 offen offset:0
    ds_read_b64_tr_b16 v[208:209], v237 offset:6144
    ds_read_b64_tr_b16 v[210:211], v237 offset:6656
    s_waitcnt lgkmcnt(8)
    v_mfma_f32_32x32x16_bf16 v[0:15], v[192:195], v[72:75], v[0:15]
    ds_read_b64_tr_b16 v[212:213], v238 offset:6144
    ds_read_b64_tr_b16 v[214:215], v238 offset:6656
    s_waitcnt lgkmcnt(8)
    v_mfma_f32_32x32x16_bf16 v[16:31], v[196:199], v[72:75], v[16:31]
    ds_read_b64_tr_b16 v[216:217], v237 offset:14336
    ds_read_b64_tr_b16 v[218:219], v237 offset:14848
    s_waitcnt lgkmcnt(8)
    v_mfma_f32_32x32x16_bf16 v[32:47], v[200:203], v[72:75], v[32:47]
    buffer_load_dwordx4 v[180:183], v228, s[60:63], s59 offen offset:1024
    ds_read_b64_tr_b16 v[220:221], v238 offset:14336
    ds_read_b64_tr_b16 v[222:223], v238 offset:14848
    s_waitcnt lgkmcnt(8)
    v_mfma_f32_32x32x16_bf16 v[48:63], v[204:207], v[72:75], v[48:63]
    ds_read_b64_tr_b16 v[192:193], v237 offset:16384
    ds_read_b64_tr_b16 v[194:195], v237 offset:16896
    s_waitcnt lgkmcnt(8)
    v_mfma_f32_32x32x16_bf16 v[0:15], v[208:211], v[76:79], v[0:15]
    ds_read_b64_tr_b16 v[196:197], v238 offset:16384
    ds_read_b64_tr_b16 v[198:199], v238 offset:16896
    s_waitcnt lgkmcnt(8)
    v_mfma_f32_32x32x16_bf16 v[16:31], v[212:215], v[76:79], v[16:31]
    buffer_load_dwordx4 v[184:187], v228, s[60:63], s59 offen offset:2048
    ds_read_b64_tr_b16 v[200:201], v237 offset:24576
    ds_read_b64_tr_b16 v[202:203], v237 offset:25088
    s_waitcnt lgkmcnt(8)
    v_mfma_f32_32x32x16_bf16 v[32:47], v[216:219], v[76:79], v[32:47]
    ds_read_b64_tr_b16 v[204:205], v238 offset:24576
    ds_read_b64_tr_b16 v[206:207], v238 offset:25088
    s_waitcnt lgkmcnt(8)
    v_mfma_f32_32x32x16_bf16 v[48:63], v[220:223], v[76:79], v[48:63]
    buffer_load_dwordx4 v[188:191], v228, s[60:63], s59 offen offset:3072
    ds_read_b64_tr_b16 v[208:209], v237 offset:18432
    ds_read_b64_tr_b16 v[210:211], v237 offset:18944
    s_waitcnt lgkmcnt(8)
    v_mfma_f32_32x32x16_bf16 v[0:15], v[192:195], v[80:83], v[0:15]
    ds_read_b64_tr_b16 v[212:213], v238 offset:18432
    ds_read_b64_tr_b16 v[214:215], v238 offset:18944
    s_waitcnt lgkmcnt(8)
    v_mfma_f32_32x32x16_bf16 v[16:31], v[196:199], v[80:83], v[16:31]
    ds_read_b64_tr_b16 v[216:217], v237 offset:26624
    ds_read_b64_tr_b16 v[218:219], v237 offset:27136
    s_waitcnt lgkmcnt(8)
    v_mfma_f32_32x32x16_bf16 v[32:47], v[200:203], v[80:83], v[32:47]
    s_add_u32 s37, s36, 3
    s_and_b32 s37, s37, 7
    s_mul_i32 s37, s37, 0x38000
    s_add_u32 m0, s39, 0xc000
    s_nop 0
    buffer_load_dwordx4 v227, s[68:71], s37 offen offset:0 lds
    ds_read_b64_tr_b16 v[220:221], v238 offset:26624
    ds_read_b64_tr_b16 v[222:223], v238 offset:27136
    s_waitcnt lgkmcnt(8)
    v_mfma_f32_32x32x16_bf16 v[48:63], v[204:207], v[80:83], v[48:63]
    ds_read_b64_tr_b16 v[192:193], v237 offset:20480
    ds_read_b64_tr_b16 v[194:195], v237 offset:20992
    s_waitcnt lgkmcnt(8)
    v_mfma_f32_32x32x16_bf16 v[0:15], v[208:211], v[84:87], v[0:15]
    ds_read_b64_tr_b16 v[196:197], v238 offset:20480
    ds_read_b64_tr_b16 v[198:199], v238 offset:20992
    s_waitcnt lgkmcnt(8)
    v_mfma_f32_32x32x16_bf16 v[16:31], v[212:215], v[84:87], v[16:31]
    s_add_u32 m0, s39, 0xe000
    s_nop 0
    buffer_load_dwordx4 v227, s[72:75], s37 offen offset:0 lds
    ds_read_b64_tr_b16 v[200:201], v237 offset:28672
    ds_read_b64_tr_b16 v[202:203], v237 offset:29184
    s_waitcnt lgkmcnt(8)
    v_mfma_f32_32x32x16_bf16 v[32:47], v[216:219], v[84:87], v[32:47]
    ds_read_b64_tr_b16 v[204:205], v238 offset:28672
    ds_read_b64_tr_b16 v[206:207], v238 offset:29184
    s_waitcnt lgkmcnt(8)
    v_mfma_f32_32x32x16_bf16 v[48:63], v[220:223], v[84:87], v[48:63]
    s_waitcnt vmcnt(6)
    s_barrier
    s_add_u32 s37, s36, 4
    s_and_b32 s37, s37, 7
    s_mul_i32 s37, s37, 0x38000
    s_add_u32 m0, s39, 0x0
    s_nop 0
    buffer_load_dwordx4 v227, s[68:71], s37 offen offset:0 lds
    ds_read_b64_tr_b16 v[208:209], v237 offset:22528
    ds_read_b64_tr_b16 v[210:211], v237 offset:23040
    s_waitcnt lgkmcnt(8)
    v_mfma_f32_32x32x16_bf16 v[0:15], v[192:195], v[88:91], v[0:15]
    ds_read_b64_tr_b16 v[212:213], v238 offset:22528
    ds_read_b64_tr_b16 v[214:215], v238 offset:23040
    s_waitcnt lgkmcnt(8)
    v_mfma_f32_32x32x16_bf16 v[16:31], v[196:199], v[88:91], v[16:31]
    ds_read_b64_tr_b16 v[216:217], v237 offset:30720
    ds_read_b64_tr_b16 v[218:219], v237 offset:31232
    s_waitcnt lgkmcnt(8)
    v_mfma_f32_32x32x16_bf16 v[32:47], v[200:203], v[88:91], v[32:47]
    ds_read_b64_tr_b16 v[220:221], v238 offset:30720
    ds_read_b64_tr_b16 v[222:223], v238 offset:31232
    s_waitcnt lgkmcnt(8)
    v_mfma_f32_32x32x16_bf16 v[48:63], v[204:207], v[88:91], v[48:63]
    ds_read_b64_tr_b16 v[192:193], v237 offset:32768
    ds_read_b64_tr_b16 v[194:195], v237 offset:33280
    s_waitcnt lgkmcnt(8)
    v_mfma_f32_32x32x16_bf16 v[0:15], v[208:211], v[92:95], v[0:15]
    ds_read_b64_tr_b16 v[196:197], v238 offset:32768
    ds_read_b64_tr_b16 v[198:199], v238 offset:33280
    s_waitcnt lgkmcnt(8)
    v_mfma_f32_32x32x16_bf16 v[16:31], v[212:215], v[92:95], v[16:31]
    ds_read_b64_tr_b16 v[200:201], v237 offset:40960
    ds_read_b64_tr_b16 v[202:203], v237 offset:41472
    s_waitcnt lgkmcnt(8)
    v_mfma_f32_32x32x16_bf16 v[32:47], v[216:219], v[92:95], v[32:47]
    ds_read_b64_tr_b16 v[204:205], v238 offset:40960
    ds_read_b64_tr_b16 v[206:207], v238 offset:41472
    s_waitcnt lgkmcnt(8)
    v_mfma_f32_32x32x16_bf16 v[48:63], v[220:223], v[92:95], v[48:63]
    s_add_u32 m0, s39, 0x2000
    s_nop 0
    buffer_load_dwordx4 v227, s[72:75], s37 offen offset:0 lds
    ds_read_b64_tr_b16 v[208:209], v237 offset:34816
    ds_read_b64_tr_b16 v[210:211], v237 offset:35328
    s_waitcnt lgkmcnt(8)
    v_mfma_f32_32x32x16_bf16 v[0:15], v[192:195], v[96:99], v[0:15]
    ds_read_b64_tr_b16 v[212:213], v238 offset:34816
    ds_read_b64_tr_b16 v[214:215], v238 offset:35328
    s_waitcnt lgkmcnt(8)
    v_mfma_f32_32x32x16_bf16 v[16:31], v[196:199], v[96:99], v[16:31]
    ds_read_b64_tr_b16 v[216:217], v237 offset:43008
    ds_read_b64_tr_b16 v[218:219], v237 offset:43520
    s_waitcnt lgkmcnt(8)
    v_mfma_f32_32x32x16_bf16 v[32:47], v[200:203], v[96:99], v[32:47]
    ds_read_b64_tr_b16 v[220:221], v238 offset:43008
    ds_read_b64_tr_b16 v[222:223], v238 offset:43520
    s_waitcnt lgkmcnt(8)
    v_mfma_f32_32x32x16_bf16 v[48:63], v[204:207], v[96:99], v[48:63]
    ds_read_b64_tr_b16 v[192:193], v237 offset:36864
    ds_read_b64_tr_b16 v[194:195], v237 offset:37376
    s_waitcnt lgkmcnt(8)
    v_mfma_f32_32x32x16_bf16 v[0:15], v[208:211], v[100:103], v[0:15]
    ds_read_b64_tr_b16 v[196:197], v238 offset:36864
    ds_read_b64_tr_b16 v[198:199], v238 offset:37376
    s_waitcnt lgkmcnt(8)
    v_mfma_f32_32x32x16_bf16 v[16:31], v[212:215], v[100:103], v[16:31]
    ds_read_b64_tr_b16 v[200:201], v237 offset:45056
    ds_read_b64_tr_b16 v[202:203], v237 offset:45568
    s_waitcnt lgkmcnt(8)
    v_mfma_f32_32x32x16_bf16 v[32:47], v[216:219], v[100:103], v[32:47]
    ds_read_b64_tr_b16 v[204:205], v238 offset:45056
    ds_read_b64_tr_b16 v[206:207], v238 offset:45568
    s_waitcnt lgkmcnt(8)
    v_mfma_f32_32x32x16_bf16 v[48:63], v[220:223], v[100:103], v[48:63]
    s_waitcnt vmcnt(2)
    s_barrier
    s_lshl_b32 s49, s35, 8
    s_lshl_b32 s38, s36, 2
    s_add_u32 s38, s38, s49
    s_cmp_lg_u32 s34, 0
    s_cbranch_scc1 k2_w7
    v_mov_b32 v250, 1
    s_mov_b64 exec, 1
    buffer_store_dword v250, off, s[84:87], s38 sc1
    s_mov_b64 exec, -1
k2_w7:
    v_and_b32 v249, 7, v224
    v_lshl_add_u32 v249, v249, 2, s49
    s_add_u32 s37, s36, 5
    s_and_b32 s37, s37, 7
    s_mul_i32 s37, s37, 0x38000
    s_add_u32 m0, s39, 0x4000
    s_nop 0
    buffer_load_dwordx4 v227, s[68:71], s37 offen offset:0 lds
    ds_read_b64_tr_b16 v[208:209], v237 offset:38912
    ds_read_b64_tr_b16 v[210:211], v237 offset:39424
    s_waitcnt lgkmcnt(8)
    v_mfma_f32_32x32x16_bf16 v[0:15], v[192:195], v[104:107], v[0:15]
    ds_read_b64_tr_b16 v[212:213], v238 offset:38912
    ds_read_b64_tr_b16 v[214:215], v238 offset:39424
    s_waitcnt lgkmcnt(8)
    v_mfma_f32_32x32x16_bf16 v[16:31], v[196:199], v[104:107], v[16:31]
    ds_read_b64_tr_b16 v[216:217], v237 offset:47104
    ds_read_b64_tr_b16 v[218:219], v237 offset:47616
    s_waitcnt lgkmcnt(8)
    v_mfma_f32_32x32x16_bf16 v[32:47], v[200:203], v[104:107], v[32:47]
    ds_read_b64_tr_b16 v[220:221], v238 offset:47104
    ds_read_b64_tr_b16 v[222:223], v238 offset:47616
    s_waitcnt lgkmcnt(8)
    v_mfma_f32_32x32x16_bf16 v[48:63], v[204:207], v[104:107], v[48:63]
    ds_read_b64_tr_b16 v[192:193], v237 offset:49152
    ds_read_b64_tr_b16 v[194:195], v237 offset:49664
    s_waitcnt lgkmcnt(8)
    v_mfma_f32_32x32x16_bf16 v[0:15], v[208:211], v[108:111], v[0:15]
    ds_read_b64_tr_b16 v[196:197], v238 offset:49152
    ds_read_b64_tr_b16 v[198:199], v238 offset:49664
    s_waitcnt lgkmcnt(8)
    v_mfma_f32_32x32x16_bf16 v[16:31], v[212:215], v[108:111], v[16:31]
    ds_read_b64_tr_b16 v[200:201], v237 offset:57344
    ds_read_b64_tr_b16 v[202:203], v237 offset:57856
    s_waitcnt lgkmcnt(8)
    v_mfma_f32_32x32x16_bf16 v[32:47], v[216:219], v[108:111], v[32:47]
    ds_read_b64_tr_b16 v[204:205], v238 offset:57344
    ds_read_b64_tr_b16 v[206:207], v238 offset:57856
    s_waitcnt lgkmcnt(8)
    v_mfma_f32_32x32x16_bf16 v[48:63], v[220:223], v[108:111], v[48:63]
    s_add_u32 m0, s39, 0x6000
    s_nop 0
    buffer_load_dwordx4 v227, s[72:75], s37 offen offset:0 lds
    ds_read_b64_tr_b16 v[208:209], v237 offset:51200
    ds_read_b64_tr_b16 v[210:211], v237 offset:51712
    s_waitcnt lgkmcnt(8)
    v_mfma_f32_32x32x16_bf16 v[0:15], v[192:195], v[112:115], v[0:15]
    ds_read_b64_tr_b16 v[212:213], v238 offset:51200
    ds_read_b64_tr_b16 v[214:215], v238 offset:51712
    s_waitcnt lgkmcnt(8)
    v_mfma_f32_32x32x16_bf16 v[16:31], v[196:199], v[112:115], v[16:31]
    ds_read_b64_tr_b16 v[216:217], v237 offset:59392
    ds_read_b64_tr_b16 v[218:219], v237 offset:59904
    s_waitcnt lgkmcnt(8)
    v_mfma_f32_32x32x16_bf16 v[32:47], v[200:203], v[112:115], v[32:47]
    ds_read_b64_tr_b16 v[220:221], v238 offset:59392
    ds_read_b64_tr_b16 v[222:223], v238 offset:59904
    s_waitcnt lgkmcnt(8)
    v_mfma_f32_32x32x16_bf16 v[48:63], v[204:207], v[112:115], v[48:63]
    ds_read_b64_tr_b16 v[192:193], v237 offset:53248
    ds_read_b64_tr_b16 v[194:195], v237 offset:53760
    s_waitcnt lgkmcnt(8)
    v_mfma_f32_32x32x16_bf16 v[0:15], v[208:211], v[116:119], v[0:15]
    ds_read_b64_tr_b16 v[196:197], v238 offset:53248
    ds_read_b64_tr_b16 v[198:199], v238 offset:53760
    s_waitcnt lgkmcnt(8)
    v_mfma_f32_32x32x16_bf16 v[16:31], v[212:215], v[116:119], v[16:31]
    ds_read_b64_tr_b16 v[200:201], v237 offset:61440
    ds_read_b64_tr_b16 v[202:203], v237 offset:61952
    s_waitcnt lgkmcnt(8)
    v_mfma_f32_32x32x16_bf16 v[32:47], v[216:219], v[116:119], v[32:47]
    ds_read_b64_tr_b16 v[204:205], v238 offset:61440
    ds_read_b64_tr_b16 v[206:207], v238 offset:61952
    s_waitcnt lgkmcnt(8)
    v_mfma_f32_32x32x16_bf16 v[48:63], v[220:223], v[116:119], v[48:63]
    s_waitcnt vmcnt(2)
    s_barrier
    v_and_b32 v231, 31, v224
    v_lshrrev_b32 v232, 5, v224
    v_lshlrev_b32 v232, 2, v232
    v_sub_u32 v231, v231, v232
    s_lshl_b32 s49, s42, 5
    s_lshl_b32 s38, s41, 6
    s_sub_u32 s49, s49, s38
    v_add_u32 v231, s49, v231
    v_mov_b32 v232, 0xff800000
    s_add_u32 s37, s36, 6
    s_and_b32 s37, s37, 7
    s_mul_i32 s37, s37, 0x38000
    s_add_u32 m0, s39, 0x8000
    s_nop 0
    buffer_load_dwordx4 v227, s[68:71], s37 offen offset:0 lds
    ds_read_b64_tr_b16 v[208:209], v237 offset:55296
    ds_read_b64_tr_b16 v[210:211], v237 offset:55808
    s_waitcnt lgkmcnt(8)
    v_mfma_f32_32x32x16_bf16 v[0:15], v[192:195], v[120:123], v[0:15]
    ds_read_b64_tr_b16 v[212:213], v238 offset:55296
    ds_read_b64_tr_b16 v[214:215], v238 offset:55808
    s_waitcnt lgkmcnt(8)
    v_mfma_f32_32x32x16_bf16 v[16:31], v[196:199], v[120:123], v[16:31]
    ds_read_b64_tr_b16 v[216:217], v237 offset:63488
    ds_read_b64_tr_b16 v[218:219], v237 offset:64000
    s_waitcnt lgkmcnt(8)
    v_mfma_f32_32x32x16_bf16 v[32:47], v[200:203], v[120:123], v[32:47]
    ds_read_b64_tr_b16 v[220:221], v238 offset:63488
    ds_read_b64_tr_b16 v[222:223], v238 offset:64000
    s_waitcnt lgkmcnt(8)
    v_mfma_f32_32x32x16_bf16 v[48:63], v[204:207], v[120:123], v[48:63]
    ds_read_b64_tr_b16 v[192:193], v237 offset:0
    ds_read_b64_tr_b16 v[194:195], v237 offset:512
    s_waitcnt lgkmcnt(8)
    v_mfma_f32_32x32x16_bf16 v[0:15], v[208:211], v[124:127], v[0:15]
    ds_read_b64_tr_b16 v[196:197], v238 offset:0
    ds_read_b64_tr_b16 v[198:199], v238 offset:512
    s_waitcnt lgkmcnt(8)
    v_mfma_f32_32x32x16_bf16 v[16:31], v[212:215], v[124:127], v[16:31]
    ds_read_b64_tr_b16 v[200:201], v237 offset:8192
    ds_read_b64_tr_b16 v[202:203], v237 offset:8704
    s_waitcnt lgkmcnt(8)
    v_mfma_f32_32x32x16_bf16 v[32:47], v[216:219], v[124:127], v[32:47]
    ds_read_b64_tr_b16 v[204:205], v238 offset:8192
    ds_read_b64_tr_b16 v[206:207], v238 offset:8704
    s_waitcnt lgkmcnt(8)
    v_mfma_f32_32x32x16_bf16 v[48:63], v[220:223], v[124:127], v[48:63]
    s_add_u32 m0, s39, 0xa000
    s_nop 0
    buffer_load_dwordx4 v227, s[72:75], s37 offen offset:0 lds
    ds_read_b64_tr_b16 v[208:209], v237 offset:2048
    ds_read_b64_tr_b16 v[210:211], v237 offset:2560
    s_waitcnt lgkmcnt(8)
    v_mfma_f32_32x32x16_bf16 v[0:15], v[192:195], v[128:131], v[0:15]
    ds_read_b64_tr_b16 v[212:213], v238 offset:2048
    ds_read_b64_tr_b16 v[214:215], v238 offset:2560
    s_waitcnt lgkmcnt(8)
    v_mfma_f32_32x32x16_bf16 v[16:31], v[196:199], v[128:131], v[16:31]
    ds_read_b64_tr_b16 v[216:217], v237 offset:10240
    ds_read_b64_tr_b16 v[218:219], v237 offset:10752
    s_waitcnt lgkmcnt(8)
    v_mfma_f32_32x32x16_bf16 v[32:47], v[200:203], v[128:131], v[32:47]
    ds_read_b64_tr_b16 v[220:221], v238 offset:10240
    ds_read_b64_tr_b16 v[222:223], v238 offset:10752
    s_waitcnt lgkmcnt(8)
    v_mfma_f32_32x32x16_bf16 v[48:63], v[204:207], v[128:131], v[48:63]
    ds_read_b64_tr_b16 v[192:193], v237 offset:4096
    ds_read_b64_tr_b16 v[194:195], v237 offset:4608
    s_waitcnt lgkmcnt(8)
    v_mfma_f32_32x32x16_bf16 v[0:15], v[208:211], v[132:135], v[0:15]
    ds_read_b64_tr_b16 v[196:197], v238 offset:4096
    ds_read_b64_tr_b16 v[198:199], v238 offset:4608
    s_waitcnt lgkmcnt(8)
    v_mfma_f32_32x32x16_bf16 v[16:31], v[212:215], v[132:135], v[16:31]
    ds_read_b64_tr_b16 v[200:201], v237 offset:12288
    ds_read_b64_tr_b16 v[202:203], v237 offset:12800
    s_waitcnt lgkmcnt(8)
    v_mfma_f32_32x32x16_bf16 v[32:47], v[216:219], v[132:135], v[32:47]
    ds_read_b64_tr_b16 v[204:205], v238 offset:12288
    ds_read_b64_tr_b16 v[206:207], v238 offset:12800
    s_waitcnt lgkmcnt(8)
    v_mfma_f32_32x32x16_bf16 v[48:63], v[220:223], v[132:135], v[48:63]
    s_waitcnt vmcnt(2)
    s_barrier
    s_add_u32 s37, s36, 7
    s_and_b32 s37, s37, 7
    s_mul_i32 s37, s37, 0x38000
    s_add_u32 m0, s39, 0xc000
    s_nop 0
    buffer_load_dwordx4 v227, s[68:71], s37 offen offset:0 lds
    ds_read_b64_tr_b16 v[208:209], v237 offset:6144
    ds_read_b64_tr_b16 v[210:211], v237 offset:6656
    s_waitcnt lgkmcnt(8)
    v_mfma_f32_32x32x16_bf16 v[0:15], v[192:195], v[136:139], v[0:15]
    ds_read_b64_tr_b16 v[212:213], v238 offset:6144
    ds_read_b64_tr_b16 v[214:215], v238 offset:6656
    s_waitcnt lgkmcnt(8)
    v_mfma_f32_32x32x16_bf16 v[16:31], v[196:199], v[136:139], v[16:31]
    ds_read_b64_tr_b16 v[216:217], v237 offset:14336
    ds_read_b64_tr_b16 v[218:219], v237 offset:14848
    s_waitcnt lgkmcnt(8)
    v_mfma_f32_32x32x16_bf16 v[32:47], v[200:203], v[136:139], v[32:47]
    ds_read_b64_tr_b16 v[220:221], v238 offset:14336
    ds_read_b64_tr_b16 v[222:223], v238 offset:14848
    s_waitcnt lgkmcnt(8)
    v_mfma_f32_32x32x16_bf16 v[48:63], v[204:207], v[136:139], v[48:63]
    ds_read_b64_tr_b16 v[192:193], v237 offset:16384
    ds_read_b64_tr_b16 v[194:195], v237 offset:16896
    s_waitcnt lgkmcnt(8)
    v_mfma_f32_32x32x16_bf16 v[0:15], v[208:211], v[140:143], v[0:15]
    ds_read_b64_tr_b16 v[196:197], v238 offset:16384
    ds_read_b64_tr_b16 v[198:199], v238 offset:16896
    s_waitcnt lgkmcnt(8)
    v_mfma_f32_32x32x16_bf16 v[16:31], v[212:215], v[140:143], v[16:31]
    ds_read_b64_tr_b16 v[200:201], v237 offset:24576
    ds_read_b64_tr_b16 v[202:203], v237 offset:25088
    s_waitcnt lgkmcnt(8)
    v_mfma_f32_32x32x16_bf16 v[32:47], v[216:219], v[140:143], v[32:47]
    ds_read_b64_tr_b16 v[204:205], v238 offset:24576
    ds_read_b64_tr_b16 v[206:207], v238 offset:25088
    s_waitcnt lgkmcnt(8)
    v_mfma_f32_32x32x16_bf16 v[48:63], v[220:223], v[140:143], v[48:63]
    s_add_u32 m0, s39, 0xe000
    s_nop 0
    buffer_load_dwordx4 v227, s[72:75], s37 offen offset:0 lds
    ds_read_b64_tr_b16 v[208:209], v237 offset:18432
    ds_read_b64_tr_b16 v[210:211], v237 offset:18944
    s_waitcnt lgkmcnt(8)
    v_mfma_f32_32x32x16_bf16 v[0:15], v[192:195], v[144:147], v[0:15]
    ds_read_b64_tr_b16 v[212:213], v238 offset:18432
    ds_read_b64_tr_b16 v[214:215], v238 offset:18944
    s_waitcnt lgkmcnt(8)
    v_mfma_f32_32x32x16_bf16 v[16:31], v[196:199], v[144:147], v[16:31]
    ds_read_b64_tr_b16 v[216:217], v237 offset:26624
    ds_read_b64_tr_b16 v[218:219], v237 offset:27136
    s_waitcnt lgkmcnt(8)
    v_mfma_f32_32x32x16_bf16 v[32:47], v[200:203], v[144:147], v[32:47]
    ds_read_b64_tr_b16 v[220:221], v238 offset:26624
    ds_read_b64_tr_b16 v[222:223], v238 offset:27136
    s_waitcnt lgkmcnt(8)
    v_mfma_f32_32x32x16_bf16 v[48:63], v[204:207], v[144:147], v[48:63]
    ds_read_b64_tr_b16 v[192:193], v237 offset:20480
    ds_read_b64_tr_b16 v[194:195], v237 offset:20992
    s_waitcnt lgkmcnt(8)
    v_mfma_f32_32x32x16_bf16 v[0:15], v[208:211], v[148:151], v[0:15]
    ds_read_b64_tr_b16 v[196:197], v238 offset:20480
    ds_read_b64_tr_b16 v[198:199], v238 offset:20992
    s_waitcnt lgkmcnt(8)
    v_mfma_f32_32x32x16_bf16 v[16:31], v[212:215], v[148:151], v[16:31]
    ds_read_b64_tr_b16 v[200:201], v237 offset:28672
    ds_read_b64_tr_b16 v[202:203], v237 offset:29184
    s_waitcnt lgkmcnt(8)
    v_mfma_f32_32x32x16_bf16 v[32:47], v[216:219], v[148:151], v[32:47]
    ds_read_b64_tr_b16 v[204:205], v238 offset:28672
    ds_read_b64_tr_b16 v[206:207], v238 offset:29184
    s_waitcnt lgkmcnt(8)
    v_mfma_f32_32x32x16_bf16 v[48:63], v[220:223], v[148:151], v[48:63]
    s_waitcnt vmcnt(2)
    s_barrier
    s_add_u32 s37, s36, 0
    s_and_b32 s37, s37, 7
    s_mul_i32 s37, s37, 0x80000
    s_add_u32 m0, s39, 0x0
    s_nop 0
    buffer_load_dwordx4 v226, s[64:67], s37 offen offset:0 lds
    ds_read_b64_tr_b16 v[208:209], v237 offset:22528
    ds_read_b64_tr_b16 v[210:211], v237 offset:23040
    s_waitcnt lgkmcnt(8)
    v_mfma_f32_32x32x16_bf16 v[0:15], v[192:195], v[152:155], v[0:15]
    ds_read_b64_tr_b16 v[212:213], v238 offset:22528
    ds_read_b64_tr_b16 v[214:215], v238 offset:23040
    s_waitcnt lgkmcnt(8)
    v_mfma_f32_32x32x16_bf16 v[16:31], v[196:199], v[152:155], v[16:31]
    ds_read_b64_tr_b16 v[216:217], v237 offset:30720
    ds_read_b64_tr_b16 v[218:219], v237 offset:31232
    s_waitcnt lgkmcnt(8)
    v_mfma_f32_32x32x16_bf16 v[32:47], v[200:203], v[152:155], v[32:47]
    ds_read_b64_tr_b16 v[220:221], v238 offset:30720
    ds_read_b64_tr_b16 v[222:223], v238 offset:31232
    s_waitcnt lgkmcnt(8)
    v_mfma_f32_32x32x16_bf16 v[48:63], v[204:207], v[152:155], v[48:63]
    ds_read_b64_tr_b16 v[192:193], v237 offset:32768
    ds_read_b64_tr_b16 v[194:195], v237 offset:33280
    s_waitcnt lgkmcnt(8)
    v_mfma_f32_32x32x16_bf16 v[0:15], v[208:211], v[156:159], v[0:15]
    ds_read_b64_tr_b16 v[196:197], v238 offset:32768
    ds_read_b64_tr_b16 v[198:199], v238 offset:33280
    s_waitcnt lgkmcnt(8)
    v_mfma_f32_32x32x16_bf16 v[16:31], v[212:215], v[156:159], v[16:31]
    ds_read_b64_tr_b16 v[200:201], v237 offset:40960
    ds_read_b64_tr_b16 v[202:203], v237 offset:41472
    s_waitcnt lgkmcnt(8)
    v_mfma_f32_32x32x16_bf16 v[32:47], v[216:219], v[156:159], v[32:47]
    ds_read_b64_tr_b16 v[204:205], v238 offset:40960
    ds_read_b64_tr_b16 v[206:207], v238 offset:41472
    s_waitcnt lgkmcnt(8)
    v_mfma_f32_32x32x16_bf16 v[48:63], v[220:223], v[156:159], v[48:63]
    s_add_u32 m0, s39, 0x1f80
    s_nop 0
    buffer_load_dwordx4 v226, s[64:67], s37 offen offset:128 lds
    ds_read_b64_tr_b16 v[208:209], v237 offset:34816
    ds_read_b64_tr_b16 v[210:211], v237 offset:35328
    s_waitcnt lgkmcnt(8)
    v_mfma_f32_32x32x16_bf16 v[0:15], v[192:195], v[160:163], v[0:15]
    ds_read_b64_tr_b16 v[212:213], v238 offset:34816
    ds_read_b64_tr_b16 v[214:215], v238 offset:35328
    s_waitcnt lgkmcnt(8)
    v_mfma_f32_32x32x16_bf16 v[16:31], v[196:199], v[160:163], v[16:31]
    ds_read_b64_tr_b16 v[216:217], v237 offset:43008
    ds_read_b64_tr_b16 v[218:219], v237 offset:43520
    s_waitcnt lgkmcnt(8)
    v_mfma_f32_32x32x16_bf16 v[32:47], v[200:203], v[160:163], v[32:47]
    ds_read_b64_tr_b16 v[220:221], v238 offset:43008
    ds_read_b64_tr_b16 v[222:223], v238 offset:43520
    s_waitcnt lgkmcnt(8)
    v_mfma_f32_32x32x16_bf16 v[48:63], v[204:207], v[160:163], v[48:63]
    ds_read_b64_tr_b16 v[192:193], v237 offset:36864
    ds_read_b64_tr_b16 v[194:195], v237 offset:37376
    s_waitcnt lgkmcnt(8)
    v_mfma_f32_32x32x16_bf16 v[0:15], v[208:211], v[164:167], v[0:15]
    ds_read_b64_tr_b16 v[196:197], v238 offset:36864
    ds_read_b64_tr_b16 v[198:199], v238 offset:37376
    s_waitcnt lgkmcnt(8)
    v_mfma_f32_32x32x16_bf16 v[16:31], v[212:215], v[164:167], v[16:31]
    ds_read_b64_tr_b16 v[200:201], v237 offset:45056
    ds_read_b64_tr_b16 v[202:203], v237 offset:45568
    s_waitcnt lgkmcnt(8)
    v_mfma_f32_32x32x16_bf16 v[32:47], v[216:219], v[164:167], v[32:47]
    ds_read_b64_tr_b16 v[204:205], v238 offset:45056
    ds_read_b64_tr_b16 v[206:207], v238 offset:45568
    s_waitcnt lgkmcnt(8)
    v_mfma_f32_32x32x16_bf16 v[48:63], v[220:223], v[164:167], v[48:63]
    s_waitcnt vmcnt(2)
    s_barrier
    s_add_u32 s37, s36, 1
    s_and_b32 s37, s37, 7
    s_mul_i32 s37, s37, 0x80000
    s_add_u32 m0, s39, 0x4000
    s_nop 0
    buffer_load_dwordx4 v226, s[64:67], s37 offen offset:0 lds
    ds_read_b64_tr_b16 v[208:209], v237 offset:38912
    ds_read_b64_tr_b16 v[210:211], v237 offset:39424
    s_waitcnt lgkmcnt(8)
    v_mfma_f32_32x32x16_bf16 v[0:15], v[192:195], v[168:171], v[0:15]
    ds_read_b64_tr_b16 v[212:213], v238 offset:38912
    ds_read_b64_tr_b16 v[214:215], v238 offset:39424
    s_waitcnt lgkmcnt(8)
    v_mfma_f32_32x32x16_bf16 v[16:31], v[196:199], v[168:171], v[16:31]
    ds_read_b64_tr_b16 v[216:217], v237 offset:47104
    ds_read_b64_tr_b16 v[218:219], v237 offset:47616
    s_waitcnt lgkmcnt(8)
    v_mfma_f32_32x32x16_bf16 v[32:47], v[200:203], v[168:171], v[32:47]
    ds_read_b64_tr_b16 v[220:221], v238 offset:47104
    ds_read_b64_tr_b16 v[222:223], v238 offset:47616
    s_waitcnt lgkmcnt(8)
    v_mfma_f32_32x32x16_bf16 v[48:63], v[204:207], v[168:171], v[48:63]
    ds_read_b64_tr_b16 v[192:193], v237 offset:49152
    ds_read_b64_tr_b16 v[194:195], v237 offset:49664
    s_waitcnt lgkmcnt(8)
    v_mfma_f32_32x32x16_bf16 v[0:15], v[208:211], v[172:175], v[0:15]
    ds_read_b64_tr_b16 v[196:197], v238 offset:49152
    ds_read_b64_tr_b16 v[198:199], v238 offset:49664
    s_waitcnt lgkmcnt(8)
    v_mfma_f32_32x32x16_bf16 v[16:31], v[212:215], v[172:175], v[16:31]
    ds_read_b64_tr_b16 v[200:201], v237 offset:57344
    ds_read_b64_tr_b16 v[202:203], v237 offset:57856
    s_waitcnt lgkmcnt(8)
    v_mfma_f32_32x32x16_bf16 v[32:47], v[216:219], v[172:175], v[32:47]
    ds_read_b64_tr_b16 v[204:205], v238 offset:57344
    ds_read_b64_tr_b16 v[206:207], v238 offset:57856
    s_waitcnt lgkmcnt(8)
    v_mfma_f32_32x32x16_bf16 v[48:63], v[220:223], v[172:175], v[48:63]
    s_add_u32 m0, s39, 0x5f80
    s_nop 0
    buffer_load_dwordx4 v226, s[64:67], s37 offen offset:128 lds
    ds_read_b64_tr_b16 v[208:209], v237 offset:51200
    ds_read_b64_tr_b16 v[210:211], v237 offset:51712
    s_waitcnt lgkmcnt(8)
    v_mfma_f32_32x32x16_bf16 v[0:15], v[192:195], v[176:179], v[0:15]
    ds_read_b64_tr_b16 v[212:213], v238 offset:51200
    ds_read_b64_tr_b16 v[214:215], v238 offset:51712
    s_waitcnt lgkmcnt(8)
    v_mfma_f32_32x32x16_bf16 v[16:31], v[196:199], v[176:179], v[16:31]
    ds_read_b64_tr_b16 v[216:217], v237 offset:59392
    ds_read_b64_tr_b16 v[218:219], v237 offset:59904
    s_waitcnt lgkmcnt(8)
    v_mfma_f32_32x32x16_bf16 v[32:47], v[200:203], v[176:179], v[32:47]
    ds_read_b64_tr_b16 v[220:221], v238 offset:59392
    ds_read_b64_tr_b16 v[222:223], v238 offset:59904
    s_waitcnt lgkmcnt(8)
    v_mfma_f32_32x32x16_bf16 v[48:63], v[204:207], v[176:179], v[48:63]
    ds_read_b64_tr_b16 v[192:193], v237 offset:53248
    ds_read_b64_tr_b16 v[194:195], v237 offset:53760
    s_waitcnt lgkmcnt(8)
    v_mfma_f32_32x32x16_bf16 v[0:15], v[208:211], v[180:183], v[0:15]
    ds_read_b64_tr_b16 v[196:197], v238 offset:53248
    ds_read_b64_tr_b16 v[198:199], v238 offset:53760
    s_waitcnt lgkmcnt(8)
    v_mfma_f32_32x32x16_bf16 v[16:31], v[212:215], v[180:183], v[16:31]
    ds_read_b64_tr_b16 v[200:201], v237 offset:61440
    ds_read_b64_tr_b16 v[202:203], v237 offset:61952
    s_waitcnt lgkmcnt(8)
    v_mfma_f32_32x32x16_bf16 v[32:47], v[216:219], v[180:183], v[32:47]
    ds_read_b64_tr_b16 v[204:205], v238 offset:61440
    ds_read_b64_tr_b16 v[206:207], v238 offset:61952
    s_waitcnt lgkmcnt(8)
    v_mfma_f32_32x32x16_bf16 v[48:63], v[220:223], v[180:183], v[48:63]
    s_waitcnt vmcnt(2)
    s_barrier
    s_cmp_lg_u32 s34, 0
    s_cbranch_scc1 k2_w8
    buffer_load_dword v248, v249, s[84:87], 0 offen sc1
k2_w8:
    s_add_u32 s37, s36, 2
    s_and_b32 s37, s37, 7
    s_mul_i32 s37, s37, 0x80000
    s_add_u32 m0, s39, 0x8000
    s_nop 0
    buffer_load_dwordx4 v226, s[64:67], s37 offen offset:0 lds
    ds_read_b64_tr_b16 v[208:209], v237 offset:55296
    ds_read_b64_tr_b16 v[210:211], v237 offset:55808
    s_waitcnt lgkmcnt(8)
    v_mfma_f32_32x32x16_bf16 v[0:15], v[192:195], v[184:187], v[0:15]
    ds_read_b64_tr_b16 v[212:213], v238 offset:55296
    ds_read_b64_tr_b16 v[214:215], v238 offset:55808
    s_waitcnt lgkmcnt(8)
    v_mfma_f32_32x32x16_bf16 v[16:31], v[196:199], v[184:187], v[16:31]
    ds_read_b64_tr_b16 v[216:217], v237 offset:63488
    ds_read_b64_tr_b16 v[218:219], v237 offset:64000
    s_waitcnt lgkmcnt(8)
    v_mfma_f32_32x32x16_bf16 v[32:47], v[200:203], v[184:187], v[32:47]
    ds_read_b64_tr_b16 v[220:221], v238 offset:63488
    ds_read_b64_tr_b16 v[222:223], v238 offset:64000
    s_waitcnt lgkmcnt(8)
    v_mfma_f32_32x32x16_bf16 v[48:63], v[204:207], v[184:187], v[48:63]
    ds_read_b64_tr_b16 v[192:193], v237 offset:0
    ds_read_b64_tr_b16 v[194:195], v237 offset:512
    s_waitcnt lgkmcnt(8)
    v_mfma_f32_32x32x16_bf16 v[0:15], v[208:211], v[188:191], v[0:15]
    ds_read_b64_tr_b16 v[196:197], v238 offset:0
    ds_read_b64_tr_b16 v[198:199], v238 offset:512
    s_waitcnt lgkmcnt(8)
    v_mfma_f32_32x32x16_bf16 v[16:31], v[212:215], v[188:191], v[16:31]
    ds_read_b64_tr_b16 v[200:201], v237 offset:8192
    ds_read_b64_tr_b16 v[202:203], v237 offset:8704
    s_waitcnt lgkmcnt(8)
    v_mfma_f32_32x32x16_bf16 v[32:47], v[216:219], v[188:191], v[32:47]
    ds_read_b64_tr_b16 v[204:205], v238 offset:8192
    ds_read_b64_tr_b16 v[206:207], v238 offset:8704
    s_waitcnt lgkmcnt(8)
    v_mfma_f32_32x32x16_bf16 v[48:63], v[220:223], v[188:191], v[48:63]
    s_add_u32 m0, s39, 0x9f80
    s_nop 0
    buffer_load_dwordx4 v226, s[64:67], s37 offen offset:128 lds
    v_mul_f32 v0, 0xbfb8aa3b, v0
    v_exp_f32 v0, v0
    v_mul_f32 v1, 0xbfb8aa3b, v1
    v_exp_f32 v1, v1
    v_add_f32 v0, 1.0, v0
    v_rcp_f32 v0, v0
    v_mul_f32 v2, 0xbfb8aa3b, v2
    v_exp_f32 v2, v2
    v_add_f32 v1, 1.0, v1
    v_rcp_f32 v1, v1
    v_mul_f32 v0, v0, v32
    v_mul_f32 v3, 0xbfb8aa3b, v3
    v_exp_f32 v3, v3
    v_add_f32 v2, 1.0, v2
    v_rcp_f32 v2, v2
    v_mul_f32 v1, v1, v33
    v_mul_f32 v4, 0xbfb8aa3b, v4
    v_exp_f32 v4, v4
    v_add_f32 v3, 1.0, v3
    v_rcp_f32 v3, v3
    v_mul_f32 v2, v2, v34
    v_mul_f32 v5, 0xbfb8aa3b, v5
    v_exp_f32 v5, v5
    v_add_f32 v4, 1.0, v4
    v_rcp_f32 v4, v4
    v_mul_f32 v3, v3, v35
    v_mul_f32 v6, 0xbfb8aa3b, v6
    v_exp_f32 v6, v6
    v_add_f32 v5, 1.0, v5
    v_rcp_f32 v5, v5
    v_mul_f32 v4, v4, v36
    v_mul_f32 v7, 0xbfb8aa3b, v7
    v_exp_f32 v7, v7
    v_add_f32 v6, 1.0, v6
    v_rcp_f32 v6, v6
    v_mul_f32 v5, v5, v37
    v_mul_f32 v8, 0xbfb8aa3b, v8
    v_exp_f32 v8, v8
    v_add_f32 v7, 1.0, v7
    v_rcp_f32 v7, v7
    v_mul_f32 v6, v6, v38
    v_mul_f32 v9, 0xbfb8aa3b, v9
    v_exp_f32 v9, v9
    v_add_f32 v8, 1.0, v8
    v_rcp_f32 v8, v8
    v_mul_f32 v7, v7, v39
    v_mul_f32 v10, 0xbfb8aa3b, v10
    v_exp_f32 v10, v10
    v_add_f32 v9, 1.0, v9
    v_rcp_f32 v9, v9
    v_mul_f32 v8, v8, v40
    v_mul_f32 v11, 0xbfb8aa3b, v11
    v_exp_f32 v11, v11
    v_add_f32 v10, 1.0, v10
    v_rcp_f32 v10, v10
    v_mul_f32 v9, v9, v41
    v_mul_f32 v12, 0xbfb8aa3b, v12
    v_exp_f32 v12, v12
    v_add_f32 v11, 1.0, v11
    v_rcp_f32 v11, v11
    v_mul_f32 v10, v10, v42
    v_mul_f32 v13, 0xbfb8aa3b, v13
    v_exp_f32 v13, v13
    v_add_f32 v12, 1.0, v12
    v_rcp_f32 v12, v12
    v_mul_f32 v11, v11, v43
    v_mul_f32 v14, 0xbfb8aa3b, v14
    v_exp_f32 v14, v14
    v_add_f32 v13, 1.0, v13
    v_rcp_f32 v13, v13
    v_mul_f32 v12, v12, v44
    v_mul_f32 v15, 0xbfb8aa3b, v15
    v_exp_f32 v15, v15
    v_add_f32 v14, 1.0, v14
    v_rcp_f32 v14, v14
    v_mul_f32 v13, v13, v45
    v_mul_f32 v16, 0xbfb8aa3b, v16
    v_exp_f32 v16, v16
    v_add_f32 v15, 1.0, v15
    v_rcp_f32 v15, v15
    v_mul_f32 v14, v14, v46
    v_mul_f32 v17, 0xbfb8aa3b, v17
    v_exp_f32 v17, v17
    v_add_f32 v16, 1.0, v16
    v_rcp_f32 v16, v16
    v_mul_f32 v15, v15, v47
    v_mul_f32 v18, 0xbfb8aa3b, v18
    v_exp_f32 v18, v18
    v_add_f32 v17, 1.0, v17
    v_rcp_f32 v17, v17
    v_mul_f32 v16, v16, v48
    v_mul_f32 v19, 0xbfb8aa3b, v19
    v_exp_f32 v19, v19
    v_add_f32 v18, 1.0, v18
    v_rcp_f32 v18, v18
    v_mul_f32 v17, v17, v49
    v_mul_f32 v20, 0xbfb8aa3b, v20
    v_exp_f32 v20, v20
    v_add_f32 v19, 1.0, v19
    v_rcp_f32 v19, v19
    v_mul_f32 v18, v18, v50
    v_mul_f32 v21, 0xbfb8aa3b, v21
    v_exp_f32 v21, v21
    v_add_f32 v20, 1.0, v20
    v_rcp_f32 v20, v20
    v_mul_f32 v19, v19, v51
    v_mul_f32 v22, 0xbfb8aa3b, v22
    v_exp_f32 v22, v22
    v_add_f32 v21, 1.0, v21
    v_rcp_f32 v21, v21
    v_mul_f32 v20, v20, v52
    v_mul_f32 v23, 0xbfb8aa3b, v23
    v_exp_f32 v23, v23
    v_add_f32 v22, 1.0, v22
    v_rcp_f32 v22, v22
    v_mul_f32 v21, v21, v53
    v_mul_f32 v24, 0xbfb8aa3b, v24
    v_exp_f32 v24, v24
    v_add_f32 v23, 1.0, v23
    v_rcp_f32 v23, v23
    v_mul_f32 v22, v22, v54
    v_mul_f32 v25, 0xbfb8aa3b, v25
    v_exp_f32 v25, v25
    v_add_f32 v24, 1.0, v24
    v_rcp_f32 v24, v24
    v_mul_f32 v23, v23, v55
    v_mul_f32 v26, 0xbfb8aa3b, v26
    v_exp_f32 v26, v26
    v_add_f32 v25, 1.0, v25
    v_rcp_f32 v25, v25
    v_mul_f32 v24, v24, v56
    v_mul_f32 v27, 0xbfb8aa3b, v27
    v_exp_f32 v27, v27
    v_add_f32 v26, 1.0, v26
    v_rcp_f32 v26, v26
    v_mul_f32 v25, v25, v57
    v_mul_f32 v28, 0xbfb8aa3b, v28
    v_exp_f32 v28, v28
    v_add_f32 v27, 1.0, v27
    v_rcp_f32 v27, v27
    v_mul_f32 v26, v26, v58
    v_mul_f32 v29, 0xbfb8aa3b, v29
    v_exp_f32 v29, v29
    v_add_f32 v28, 1.0, v28
    v_rcp_f32 v28, v28
    v_mul_f32 v27, v27, v59
    v_mul_f32 v30, 0xbfb8aa3b, v30
    v_exp_f32 v30, v30
    v_add_f32 v29, 1.0, v29
    v_rcp_f32 v29, v29
    v_mul_f32 v28, v28, v60
    v_mul_f32 v31, 0xbfb8aa3b, v31
    v_exp_f32 v31, v31
    v_add_f32 v30, 1.0, v30
    v_rcp_f32 v30, v30
    v_mul_f32 v29, v29, v61
    v_add_f32 v31, 1.0, v31
    v_rcp_f32 v31, v31
    v_mul_f32 v30, v30, v62
    v_mul_f32 v31, v31, v63
    s_mul_i32 s38, s40, 114688
    s_lshl_b32 s44, s44, 12
    s_add_u32 s38, s38, s44
    v_add_u32 v235, s38, v228
    v_cvt_pk_bf16_f32 v240, v0, v1
    v_cvt_pk_bf16_f32 v241, v2, v3
    v_cvt_pk_bf16_f32 v242, v4, v5
    v_cvt_pk_bf16_f32 v243, v6, v7
    s_mov_b32 s38, 0x0
    buffer_store_dwordx4 v[240:243], v235, s[80:83], s38 offen offset:0 sc1
    v_cvt_pk_bf16_f32 v244, v8, v9
    v_cvt_pk_bf16_f32 v245, v10, v11
    v_cvt_pk_bf16_f32 v246, v12, v13
    v_cvt_pk_bf16_f32 v247, v14, v15
    buffer_store_dwordx4 v[244:247], v235, s[80:83], s38 offen offset:1024 sc1
    v_cvt_pk_bf16_f32 v240, v16, v17
    v_cvt_pk_bf16_f32 v241, v18, v19
    v_cvt_pk_bf16_f32 v242, v20, v21
    v_cvt_pk_bf16_f32 v243, v22, v23
    buffer_store_dwordx4 v[240:243], v235, s[80:83], s38 offen offset:2048 sc1
    v_cvt_pk_bf16_f32 v244, v24, v25
    v_cvt_pk_bf16_f32 v245, v26, v27
    v_cvt_pk_bf16_f32 v246, v28, v29
    v_cvt_pk_bf16_f32 v247, v30, v31
    buffer_store_dwordx4 v[244:247], v235, s[80:83], s38 offen offset:3072 sc1
    ds_read_b64_tr_b16 v[208:209], v237 offset:2048
    ds_read_b64_tr_b16 v[210:211], v237 offset:2560
    s_waitcnt lgkmcnt(8)
    v_mfma_f32_32x32x16_bf16 v[0:15], v[192:195], v[64:67], 0
    ds_read_b64_tr_b16 v[212:213], v238 offset:2048
    ds_read_b64_tr_b16 v[214:215], v238 offset:2560
    s_waitcnt lgkmcnt(8)
    v_mfma_f32_32x32x16_bf16 v[16:31], v[196:199], v[64:67], 0
    ds_read_b64_tr_b16 v[216:217], v237 offset:10240
    ds_read_b64_tr_b16 v[218:219], v237 offset:10752
    s_waitcnt lgkmcnt(8)
    v_mfma_f32_32x32x16_bf16 v[32:47], v[200:203], v[64:67], 0
    ds_read_b64_tr_b16 v[220:221], v238 offset:10240
    ds_read_b64_tr_b16 v[222:223], v238 offset:10752
    s_waitcnt lgkmcnt(8)
    v_mfma_f32_32x32x16_bf16 v[48:63], v[204:207], v[64:67], 0
    ds_read_b64_tr_b16 v[192:193], v237 offset:4096
    ds_read_b64_tr_b16 v[194:195], v237 offset:4608
    s_waitcnt lgkmcnt(8)
    v_mfma_f32_32x32x16_bf16 v[0:15], v[208:211], v[68:71], v[0:15]
    ds_read_b64_tr_b16 v[196:197], v238 offset:4096
    ds_read_b64_tr_b16 v[198:199], v238 offset:4608
    s_waitcnt lgkmcnt(8)
    v_mfma_f32_32x32x16_bf16 v[16:31], v[212:215], v[68:71], v[16:31]
    ds_read_b64_tr_b16 v[200:201], v237 offset:12288
    ds_read_b64_tr_b16 v[202:203], v237 offset:12800
    s_waitcnt lgkmcnt(8)
    v_mfma_f32_32x32x16_bf16 v[32:47], v[216:219], v[68:71], v[32:47]
    ds_read_b64_tr_b16 v[204:205], v238 offset:12288
    ds_read_b64_tr_b16 v[206:207], v238 offset:12800
    s_waitcnt lgkmcnt(8)
    v_mfma_f32_32x32x16_bf16 v[48:63], v[220:223], v[68:71], v[48:63]
    s_waitcnt vmcnt(6)
    s_barrier
    s_add_u32 s37, s36, 3
    s_and_b32 s37, s37, 7
    s_mul_i32 s37, s37, 0x80000
    s_add_u32 m0, s39, 0xc000
    s_nop 0
    buffer_load_dwordx4 v226, s[64:67], s37 offen offset:0 lds
    ds_read_b64_tr_b16 v[208:209], v237 offset:6144
    ds_read_b64_tr_b16 v[210:211], v237 offset:6656
    s_waitcnt lgkmcnt(8)
    v_mfma_f32_32x32x16_bf16 v[0:15], v[192:195], v[72:75], v[0:15]
    ds_read_b64_tr_b16 v[212:213], v238 offset:6144
    ds_read_b64_tr_b16 v[214:215], v238 offset:6656
    s_waitcnt lgkmcnt(8)
    v_mfma_f32_32x32x16_bf16 v[16:31], v[196:199], v[72:75], v[16:31]
    ds_read_b64_tr_b16 v[216:217], v237 offset:14336
    ds_read_b64_tr_b16 v[218:219], v237 offset:14848
    s_waitcnt lgkmcnt(8)
    v_mfma_f32_32x32x16_bf16 v[32:47], v[200:203], v[72:75], v[32:47]
    ds_read_b64_tr_b16 v[220:221], v238 offset:14336
    ds_read_b64_tr_b16 v[222:223], v238 offset:14848
    s_waitcnt lgkmcnt(8)
    v_mfma_f32_32x32x16_bf16 v[48:63], v[204:207], v[72:75], v[48:63]
    ds_read_b64_tr_b16 v[192:193], v237 offset:16384
    ds_read_b64_tr_b16 v[194:195], v237 offset:16896
    s_waitcnt lgkmcnt(8)
    v_mfma_f32_32x32x16_bf16 v[0:15], v[208:211], v[76:79], v[0:15]
    ds_read_b64_tr_b16 v[196:197], v238 offset:16384
    ds_read_b64_tr_b16 v[198:199], v238 offset:16896
    s_waitcnt lgkmcnt(8)
    v_mfma_f32_32x32x16_bf16 v[16:31], v[212:215], v[76:79], v[16:31]
    ds_read_b64_tr_b16 v[200:201], v237 offset:24576
    ds_read_b64_tr_b16 v[202:203], v237 offset:25088
    s_waitcnt lgkmcnt(8)
    v_mfma_f32_32x32x16_bf16 v[32:47], v[216:219], v[76:79], v[32:47]
    ds_read_b64_tr_b16 v[204:205], v238 offset:24576
    ds_read_b64_tr_b16 v[206:207], v238 offset:25088
    s_waitcnt lgkmcnt(8)
    v_mfma_f32_32x32x16_bf16 v[48:63], v[220:223], v[76:79], v[48:63]
    s_add_u32 m0, s39, 0xdf80
    s_nop 0
    buffer_load_dwordx4 v226, s[64:67], s37 offen offset:128 lds
    ds_read_b64_tr_b16 v[208:209], v237 offset:18432
    ds_read_b64_tr_b16 v[210:211], v237 offset:18944
    s_waitcnt lgkmcnt(8)
    v_mfma_f32_32x32x16_bf16 v[0:15], v[192:195], v[80:83], v[0:15]
    ds_read_b64_tr_b16 v[212:213], v238 offset:18432
    ds_read_b64_tr_b16 v[214:215], v238 offset:18944
    s_waitcnt lgkmcnt(8)
    v_mfma_f32_32x32x16_bf16 v[16:31], v[196:199], v[80:83], v[16:31]
    ds_read_b64_tr_b16 v[216:217], v237 offset:26624
    ds_read_b64_tr_b16 v[218:219], v237 offset:27136
    s_waitcnt lgkmcnt(8)
    v_mfma_f32_32x32x16_bf16 v[32:47], v[200:203], v[80:83], v[32:47]
    ds_read_b64_tr_b16 v[220:221], v238 offset:26624
    ds_read_b64_tr_b16 v[222:223], v238 offset:27136
    s_waitcnt lgkmcnt(8)
    v_mfma_f32_32x32x16_bf16 v[48:63], v[204:207], v[80:83], v[48:63]
    ds_read_b64_tr_b16 v[192:193], v237 offset:20480
    ds_read_b64_tr_b16 v[194:195], v237 offset:20992
    s_waitcnt lgkmcnt(8)
    v_mfma_f32_32x32x16_bf16 v[0:15], v[208:211], v[84:87], v[0:15]
    ds_read_b64_tr_b16 v[196:197], v238 offset:20480
    ds_read_b64_tr_b16 v[198:199], v238 offset:20992
    s_waitcnt lgkmcnt(8)
    v_mfma_f32_32x32x16_bf16 v[16:31], v[212:215], v[84:87], v[16:31]
    ds_read_b64_tr_b16 v[200:201], v237 offset:28672
    ds_read_b64_tr_b16 v[202:203], v237 offset:29184
    s_waitcnt lgkmcnt(8)
    v_mfma_f32_32x32x16_bf16 v[32:47], v[216:219], v[84:87], v[32:47]
    ds_read_b64_tr_b16 v[204:205], v238 offset:28672
    ds_read_b64_tr_b16 v[206:207], v238 offset:29184
    s_waitcnt lgkmcnt(8)
    v_mfma_f32_32x32x16_bf16 v[48:63], v[220:223], v[84:87], v[48:63]
    s_waitcnt vmcnt(6)
    s_barrier
    s_cmp_lg_u32 s34, 0
    s_cbranch_scc1 k2_w9
    v_and_b32 v248, 1, v248
    v_cmp_ne_u32 vcc, 1, v248
    s_cbranch_vccnz k2_spink
k2_spk:
k2_w9:
    s_add_u32 s37, s36, 4
    s_and_b32 s37, s37, 7
    s_mul_i32 s37, s37, 0x80000
    s_add_u32 m0, s39, 0x0
    s_nop 0
    buffer_load_dwordx4 v226, s[64:67], s37 offen offset:0 lds
    ds_read_b64_tr_b16 v[208:209], v237 offset:22528
    ds_read_b64_tr_b16 v[210:211], v237 offset:23040
    s_waitcnt lgkmcnt(8)
    v_mfma_f32_32x32x16_bf16 v[0:15], v[192:195], v[88:91], v[0:15]
    ds_read_b64_tr_b16 v[212:213], v238 offset:22528
    ds_read_b64_tr_b16 v[214:215], v238 offset:23040
    s_waitcnt lgkmcnt(8)
    v_mfma_f32_32x32x16_bf16 v[16:31], v[196:199], v[88:91], v[16:31]
    ds_read_b64_tr_b16 v[216:217], v237 offset:30720
    ds_read_b64_tr_b16 v[218:219], v237 offset:31232
    s_waitcnt lgkmcnt(8)
    v_mfma_f32_32x32x16_bf16 v[32:47], v[200:203], v[88:91], v[32:47]
    ds_read_b64_tr_b16 v[220:221], v238 offset:30720
    ds_read_b64_tr_b16 v[222:223], v238 offset:31232
    s_waitcnt lgkmcnt(8)
    v_mfma_f32_32x32x16_bf16 v[48:63], v[204:207], v[88:91], v[48:63]
    ds_read_b64_tr_b16 v[192:193], v237 offset:32768
    ds_read_b64_tr_b16 v[194:195], v237 offset:33280
    s_waitcnt lgkmcnt(8)
    v_mfma_f32_32x32x16_bf16 v[0:15], v[208:211], v[92:95], v[0:15]
    ds_read_b64_tr_b16 v[196:197], v238 offset:32768
    ds_read_b64_tr_b16 v[198:199], v238 offset:33280
    s_waitcnt lgkmcnt(8)
    v_mfma_f32_32x32x16_bf16 v[16:31], v[212:215], v[92:95], v[16:31]
    ds_read_b64_tr_b16 v[200:201], v237 offset:40960
    ds_read_b64_tr_b16 v[202:203], v237 offset:41472
    s_waitcnt lgkmcnt(8)
    v_mfma_f32_32x32x16_bf16 v[32:47], v[216:219], v[92:95], v[32:47]
    ds_read_b64_tr_b16 v[204:205], v238 offset:40960
    ds_read_b64_tr_b16 v[206:207], v238 offset:41472
    s_waitcnt lgkmcnt(8)
    v_mfma_f32_32x32x16_bf16 v[48:63], v[220:223], v[92:95], v[48:63]
    s_add_u32 m0, s39, 0x1f80
    s_nop 0
    buffer_load_dwordx4 v226, s[64:67], s37 offen offset:128 lds
    ds_read_b64_tr_b16 v[208:209], v237 offset:34816
    ds_read_b64_tr_b16 v[210:211], v237 offset:35328
    s_waitcnt lgkmcnt(8)
    v_mfma_f32_32x32x16_bf16 v[0:15], v[192:195], v[96:99], v[0:15]
    ds_read_b64_tr_b16 v[212:213], v238 offset:34816
    ds_read_b64_tr_b16 v[214:215], v238 offset:35328
    s_waitcnt lgkmcnt(8)
    v_mfma_f32_32x32x16_bf16 v[16:31], v[196:199], v[96:99], v[16:31]
    ds_read_b64_tr_b16 v[216:217], v237 offset:43008
    ds_read_b64_tr_b16 v[218:219], v237 offset:43520
    s_waitcnt lgkmcnt(8)
    v_mfma_f32_32x32x16_bf16 v[32:47], v[200:203], v[96:99], v[32:47]
    ds_read_b64_tr_b16 v[220:221], v238 offset:43008
    ds_read_b64_tr_b16 v[222:223], v238 offset:43520
    s_waitcnt lgkmcnt(8)
    v_mfma_f32_32x32x16_bf16 v[48:63], v[204:207], v[96:99], v[48:63]
    ds_read_b64_tr_b16 v[192:193], v237 offset:36864
    ds_read_b64_tr_b16 v[194:195], v237 offset:37376
    s_waitcnt lgkmcnt(8)
    v_mfma_f32_32x32x16_bf16 v[0:15], v[208:211], v[100:103], v[0:15]
    ds_read_b64_tr_b16 v[196:197], v238 offset:36864
    ds_read_b64_tr_b16 v[198:199], v238 offset:37376
    s_waitcnt lgkmcnt(8)
    v_mfma_f32_32x32x16_bf16 v[16:31], v[212:215], v[100:103], v[16:31]
    ds_read_b64_tr_b16 v[200:201], v237 offset:45056
    ds_read_b64_tr_b16 v[202:203], v237 offset:45568
    s_waitcnt lgkmcnt(8)
    v_mfma_f32_32x32x16_bf16 v[32:47], v[216:219], v[100:103], v[32:47]
    ds_read_b64_tr_b16 v[204:205], v238 offset:45056
    ds_read_b64_tr_b16 v[206:207], v238 offset:45568
    s_waitcnt lgkmcnt(8)
    v_mfma_f32_32x32x16_bf16 v[48:63], v[220:223], v[100:103], v[48:63]
    s_waitcnt vmcnt(2)
    s_barrier
    s_mov_b32 s59, s48
    s_add_u32 m0, s46, 0
    s_nop 0
    buffer_load_dwordx4 v228, s[76:79], s59 offen offset:0 lds
    ds_read_b64_tr_b16 v[208:209], v237 offset:38912
    ds_read_b64_tr_b16 v[210:211], v237 offset:39424
    s_waitcnt lgkmcnt(8)
    v_mfma_f32_32x32x16_bf16 v[0:15], v[192:195], v[104:107], v[0:15]
    ds_read_b64_tr_b16 v[212:213], v238 offset:38912
    ds_read_b64_tr_b16 v[214:215], v238 offset:39424
    s_waitcnt lgkmcnt(8)
    v_mfma_f32_32x32x16_bf16 v[16:31], v[196:199], v[104:107], v[16:31]
    ds_read_b64_tr_b16 v[216:217], v237 offset:47104
    ds_read_b64_tr_b16 v[218:219], v237 offset:47616
    s_waitcnt lgkmcnt(8)
    v_mfma_f32_32x32x16_bf16 v[32:47], v[200:203], v[104:107], v[32:47]
    buffer_load_dwordx4 v228, s[76:79], s59 offen offset:1024 lds
    ds_read_b64_tr_b16 v[220:221], v238 offset:47104
    ds_read_b64_tr_b16 v[222:223], v238 offset:47616
    s_waitcnt lgkmcnt(8)
    v_mfma_f32_32x32x16_bf16 v[48:63], v[204:207], v[104:107], v[48:63]
    ds_read_b64_tr_b16 v[192:193], v237 offset:49152
    ds_read_b64_tr_b16 v[194:195], v237 offset:49664
    s_waitcnt lgkmcnt(8)
    v_mfma_f32_32x32x16_bf16 v[0:15], v[208:211], v[108:111], v[0:15]
    ds_read_b64_tr_b16 v[196:197], v238 offset:49152
    ds_read_b64_tr_b16 v[198:199], v238 offset:49664
    s_waitcnt lgkmcnt(8)
    v_mfma_f32_32x32x16_bf16 v[16:31], v[212:215], v[108:111], v[16:31]
    s_add_u32 m0, s46, 8192
    s_add_u32 s59, s59, 8192
    buffer_load_dwordx4 v228, s[76:79], s59 offen offset:0 lds
    ds_read_b64_tr_b16 v[200:201], v237 offset:57344
    ds_read_b64_tr_b16 v[202:203], v237 offset:57856
    s_waitcnt lgkmcnt(8)
    v_mfma_f32_32x32x16_bf16 v[32:47], v[216:219], v[108:111], v[32:47]
    ds_read_b64_tr_b16 v[204:205], v238 offset:57344
    ds_read_b64_tr_b16 v[206:207], v238 offset:57856
    s_waitcnt lgkmcnt(8)
    v_mfma_f32_32x32x16_bf16 v[48:63], v[220:223], v[108:111], v[48:63]
    buffer_load_dwordx4 v228, s[76:79], s59 offen offset:1024 lds
    s_xor_b32 s46, s46, 32768
    ds_read_b64_tr_b16 v[208:209], v237 offset:51200
    ds_read_b64_tr_b16 v[210:211], v237 offset:51712
    s_waitcnt lgkmcnt(8)
    v_mfma_f32_32x32x16_bf16 v[0:15], v[192:195], v[112:115], v[0:15]
    ds_read_b64_tr_b16 v[212:213], v238 offset:51200
    ds_read_b64_tr_b16 v[214:215], v238 offset:51712
    s_waitcnt lgkmcnt(8)
    v_mfma_f32_32x32x16_bf16 v[16:31], v[196:199], v[112:115], v[16:31]
    ds_read_b64_tr_b16 v[216:217], v237 offset:59392
    ds_read_b64_tr_b16 v[218:219], v237 offset:59904
    s_waitcnt lgkmcnt(8)
    v_mfma_f32_32x32x16_bf16 v[32:47], v[200:203], v[112:115], v[32:47]
    s_add_u32 s37, s36, 5
    s_and_b32 s37, s37, 7
    s_mul_i32 s37, s37, 0x80000
    s_add_u32 m0, s39, 0x4000
    s_nop 0
    buffer_load_dwordx4 v226, s[64:67], s37 offen offset:0 lds
    ds_read_b64_tr_b16 v[220:221], v238 offset:59392
    ds_read_b64_tr_b16 v[222:223], v238 offset:59904
    s_waitcnt lgkmcnt(8)
    v_mfma_f32_32x32x16_bf16 v[48:63], v[204:207], v[112:115], v[48:63]
    ds_read_b64_tr_b16 v[192:193], v237 offset:53248
    ds_read_b64_tr_b16 v[194:195], v237 offset:53760
    s_waitcnt lgkmcnt(8)
    v_mfma_f32_32x32x16_bf16 v[0:15], v[208:211], v[116:119], v[0:15]
    ds_read_b64_tr_b16 v[196:197], v238 offset:53248
    ds_read_b64_tr_b16 v[198:199], v238 offset:53760
    s_waitcnt lgkmcnt(8)
    v_mfma_f32_32x32x16_bf16 v[16:31], v[212:215], v[116:119], v[16:31]
    s_add_u32 m0, s39, 0x5f80
    s_nop 0
    buffer_load_dwordx4 v226, s[64:67], s37 offen offset:128 lds
    ds_read_b64_tr_b16 v[200:201], v237 offset:61440
    ds_read_b64_tr_b16 v[202:203], v237 offset:61952
    s_waitcnt lgkmcnt(8)
    v_mfma_f32_32x32x16_bf16 v[32:47], v[216:219], v[116:119], v[32:47]
    ds_read_b64_tr_b16 v[204:205], v238 offset:61440
    ds_read_b64_tr_b16 v[206:207], v238 offset:61952
    s_waitcnt lgkmcnt(8)
    v_mfma_f32_32x32x16_bf16 v[48:63], v[220:223], v[116:119], v[48:63]
    s_waitcnt vmcnt(6)
    s_barrier
    s_add_u32 s37, s36, 6
    s_and_b32 s37, s37, 7
    s_mul_i32 s37, s37, 0x80000
    s_add_u32 m0, s39, 0x8000
    s_nop 0
    buffer_load_dwordx4 v226, s[64:67], s37 offen offset:0 lds
    ds_read_b64_tr_b16 v[208:209], v237 offset:55296
    ds_read_b64_tr_b16 v[210:211], v237 offset:55808
    s_waitcnt lgkmcnt(8)
    v_mfma_f32_32x32x16_bf16 v[0:15], v[192:195], v[120:123], v[0:15]
    ds_read_b64_tr_b16 v[212:213], v238 offset:55296
    ds_read_b64_tr_b16 v[214:215], v238 offset:55808
    s_waitcnt lgkmcnt(8)
    v_mfma_f32_32x32x16_bf16 v[16:31], v[196:199], v[120:123], v[16:31]
    ds_read_b64_tr_b16 v[216:217], v237 offset:63488
    ds_read_b64_tr_b16 v[218:219], v237 offset:64000
    s_waitcnt lgkmcnt(8)
    v_mfma_f32_32x32x16_bf16 v[32:47], v[200:203], v[120:123], v[32:47]
    ds_read_b64_tr_b16 v[220:221], v238 offset:63488
    ds_read_b64_tr_b16 v[222:223], v238 offset:64000
    s_waitcnt lgkmcnt(8)
    v_mfma_f32_32x32x16_bf16 v[48:63], v[204:207], v[120:123], v[48:63]
    ds_read_b64_tr_b16 v[192:193], v237 offset:0
    ds_read_b64_tr_b16 v[194:195], v237 offset:512
    s_waitcnt lgkmcnt(8)
    v_mfma_f32_32x32x16_bf16 v[0:15], v[208:211], v[124:127], v[0:15]
    ds_read_b64_tr_b16 v[196:197], v238 offset:0
    ds_read_b64_tr_b16 v[198:199], v238 offset:512
    s_waitcnt lgkmcnt(8)
    v_mfma_f32_32x32x16_bf16 v[16:31], v[212:215], v[124:127], v[16:31]
    ds_read_b64_tr_b16 v[200:201], v237 offset:8192
    ds_read_b64_tr_b16 v[202:203], v237 offset:8704
    s_waitcnt lgkmcnt(8)
    v_mfma_f32_32x32x16_bf16 v[32:47], v[216:219], v[124:127], v[32:47]
    ds_read_b64_tr_b16 v[204:205], v238 offset:8192
    ds_read_b64_tr_b16 v[206:207], v238 offset:8704
    s_waitcnt lgkmcnt(8)
    v_mfma_f32_32x32x16_bf16 v[48:63], v[220:223], v[124:127], v[48:63]
    s_add_u32 m0, s39, 0x9f80
    s_nop 0
    buffer_load_dwordx4 v226, s[64:67], s37 offen offset:128 lds
    ds_read_b64_tr_b16 v[208:209], v237 offset:2048
    ds_read_b64_tr_b16 v[210:211], v237 offset:2560
    s_waitcnt lgkmcnt(8)
    v_mfma_f32_32x32x16_bf16 v[0:15], v[192:195], v[128:131], v[0:15]
    ds_read_b64_tr_b16 v[212:213], v238 offset:2048
    ds_read_b64_tr_b16 v[214:215], v238 offset:2560
    s_waitcnt lgkmcnt(8)
    v_mfma_f32_32x32x16_bf16 v[16:31], v[196:199], v[128:131], v[16:31]
    ds_read_b64_tr_b16 v[216:217], v237 offset:10240
    ds_read_b64_tr_b16 v[218:219], v237 offset:10752
    s_waitcnt lgkmcnt(8)
    v_mfma_f32_32x32x16_bf16 v[32:47], v[200:203], v[128:131], v[32:47]
    ds_read_b64_tr_b16 v[220:221], v238 offset:10240
    ds_read_b64_tr_b16 v[222:223], v238 offset:10752
    s_waitcnt lgkmcnt(8)
    v_mfma_f32_32x32x16_bf16 v[48:63], v[204:207], v[128:131], v[48:63]
    ds_read_b64_tr_b16 v[192:193], v237 offset:4096
    ds_read_b64_tr_b16 v[194:195], v237 offset:4608
    s_waitcnt lgkmcnt(8)
    v_mfma_f32_32x32x16_bf16 v[0:15], v[208:211], v[132:135], v[0:15]
    ds_read_b64_tr_b16 v[196:197], v238 offset:4096
    ds_read_b64_tr_b16 v[198:199], v238 offset:4608
    s_waitcnt lgkmcnt(8)
    v_mfma_f32_32x32x16_bf16 v[16:31], v[212:215], v[132:135], v[16:31]
    ds_read_b64_tr_b16 v[200:201], v237 offset:12288
    ds_read_b64_tr_b16 v[202:203], v237 offset:12800
    s_waitcnt lgkmcnt(8)
    v_mfma_f32_32x32x16_bf16 v[32:47], v[216:219], v[132:135], v[32:47]
    ds_read_b64_tr_b16 v[204:205], v238 offset:12288
    ds_read_b64_tr_b16 v[206:207], v238 offset:12800
    s_waitcnt lgkmcnt(8)
    v_mfma_f32_32x32x16_bf16 v[48:63], v[220:223], v[132:135], v[48:63]
    s_waitcnt vmcnt(2)
    s_barrier
    s_add_u32 s59, s48, 65536
    s_add_u32 m0, s46, 0
    s_nop 0
    buffer_load_dwordx4 v228, s[76:79], s59 offen offset:0 lds
    ds_read_b64_tr_b16 v[208:209], v237 offset:6144
    ds_read_b64_tr_b16 v[210:211], v237 offset:6656
    s_waitcnt lgkmcnt(8)
    v_mfma_f32_32x32x16_bf16 v[0:15], v[192:195], v[136:139], v[0:15]
    ds_read_b64_tr_b16 v[212:213], v238 offset:6144
    ds_read_b64_tr_b16 v[214:215], v238 offset:6656
    s_waitcnt lgkmcnt(8)
    v_mfma_f32_32x32x16_bf16 v[16:31], v[196:199], v[136:139], v[16:31]
    ds_read_b64_tr_b16 v[216:217], v237 offset:14336
    ds_read_b64_tr_b16 v[218:219], v237 offset:14848
    s_waitcnt lgkmcnt(8)
    v_mfma_f32_32x32x16_bf16 v[32:47], v[200:203], v[136:139], v[32:47]
    buffer_load_dwordx4 v228, s[76:79], s59 offen offset:1024 lds
    ds_read_b64_tr_b16 v[220:221], v238 offset:14336
    ds_read_b64_tr_b16 v[222:223], v238 offset:14848
    s_waitcnt lgkmcnt(8)
    v_mfma_f32_32x32x16_bf16 v[48:63], v[204:207], v[136:139], v[48:63]
    ds_read_b64_tr_b16 v[192:193], v237 offset:16384
    ds_read_b64_tr_b16 v[194:195], v237 offset:16896
    s_waitcnt lgkmcnt(8)
    v_mfma_f32_32x32x16_bf16 v[0:15], v[208:211], v[140:143], v[0:15]
    ds_read_b64_tr_b16 v[196:197], v238 offset:16384
    ds_read_b64_tr_b16 v[198:199], v238 offset:16896
    s_waitcnt lgkmcnt(8)
    v_mfma_f32_32x32x16_bf16 v[16:31], v[212:215], v[140:143], v[16:31]
    s_add_u32 m0, s46, 8192
    s_add_u32 s59, s59, 8192
    buffer_load_dwordx4 v228, s[76:79], s59 offen offset:0 lds
    ds_read_b64_tr_b16 v[200:201], v237 offset:24576
    ds_read_b64_tr_b16 v[202:203], v237 offset:25088
    s_waitcnt lgkmcnt(8)
    v_mfma_f32_32x32x16_bf16 v[32:47], v[216:219], v[140:143], v[32:47]
    ds_read_b64_tr_b16 v[204:205], v238 offset:24576
    ds_read_b64_tr_b16 v[206:207], v238 offset:25088
    s_waitcnt lgkmcnt(8)
    v_mfma_f32_32x32x16_bf16 v[48:63], v[220:223], v[140:143], v[48:63]
    buffer_load_dwordx4 v228, s[76:79], s59 offen offset:1024 lds
    s_xor_b32 s46, s46, 32768
    ds_read_b64_tr_b16 v[208:209], v237 offset:18432
    ds_read_b64_tr_b16 v[210:211], v237 offset:18944
    s_waitcnt lgkmcnt(8)
    v_mfma_f32_32x32x16_bf16 v[0:15], v[192:195], v[144:147], v[0:15]
    ds_read_b64_tr_b16 v[212:213], v238 offset:18432
    ds_read_b64_tr_b16 v[214:215], v238 offset:18944
    s_waitcnt lgkmcnt(8)
    v_mfma_f32_32x32x16_bf16 v[16:31], v[196:199], v[144:147], v[16:31]
    ds_read_b64_tr_b16 v[216:217], v237 offset:26624
    ds_read_b64_tr_b16 v[218:219], v237 offset:27136
    s_waitcnt lgkmcnt(8)
    v_mfma_f32_32x32x16_bf16 v[32:47], v[200:203], v[144:147], v[32:47]
    s_add_u32 s37, s36, 7
    s_and_b32 s37, s37, 7
    s_mul_i32 s37, s37, 0x80000
    s_add_u32 m0, s39, 0xc000
    s_nop 0
    buffer_load_dwordx4 v226, s[64:67], s37 offen offset:0 lds
    ds_read_b64_tr_b16 v[220:221], v238 offset:26624
    ds_read_b64_tr_b16 v[222:223], v238 offset:27136
    s_waitcnt lgkmcnt(8)
    v_mfma_f32_32x32x16_bf16 v[48:63], v[204:207], v[144:147], v[48:63]
    ds_read_b64_tr_b16 v[192:193], v237 offset:20480
    ds_read_b64_tr_b16 v[194:195], v237 offset:20992
    s_waitcnt lgkmcnt(8)
    v_mfma_f32_32x32x16_bf16 v[0:15], v[208:211], v[148:151], v[0:15]
    ds_read_b64_tr_b16 v[196:197], v238 offset:20480
    ds_read_b64_tr_b16 v[198:199], v238 offset:20992
    s_waitcnt lgkmcnt(8)
    v_mfma_f32_32x32x16_bf16 v[16:31], v[212:215], v[148:151], v[16:31]
    s_add_u32 m0, s39, 0xdf80
    s_nop 0
    buffer_load_dwordx4 v226, s[64:67], s37 offen offset:128 lds
    ds_read_b64_tr_b16 v[200:201], v237 offset:28672
    ds_read_b64_tr_b16 v[202:203], v237 offset:29184
    s_waitcnt lgkmcnt(8)
    v_mfma_f32_32x32x16_bf16 v[32:47], v[216:219], v[148:151], v[32:47]
    ds_read_b64_tr_b16 v[204:205], v238 offset:28672
    ds_read_b64_tr_b16 v[206:207], v238 offset:29184
    s_waitcnt lgkmcnt(8)
    v_mfma_f32_32x32x16_bf16 v[48:63], v[220:223], v[148:151], v[48:63]
    s_waitcnt vmcnt(6)
    s_barrier
    s_mov_b32 s68, s18
    s_mov_b32 s69, s19
    s_mov_b32 s70, 0x400000
    s_mov_b32 s71, 0x00020000
    s_mov_b32 s72, s26
    s_mov_b32 s73, s27
    s_mov_b32 s74, 0x1c0000
    s_mov_b32 s75, 0x00020000
    v_lshrrev_b32 v248, 3, v224
    v_lshlrev_b32 v236, 10, v248
    v_and_b32 v248, 7, v224
    v_lshl_add_u32 v236, v248, 4, v236
    v_bfe_u32 v248, v224, 4, 1
    v_lshlrev_b32 v248, 6, v248
    v_xor_b32 v236, v236, v248
    s_lshl_b32 s49, s34, 7
    s_lshl_b32 s54, s2, 14
    s_add_u32 s54, s54, s49
    s_min_u32 s55, s2, 111
    s_lshl_b32 s55, s55, 14
    s_add_u32 s55, s55, s49
    s_lshl_b32 s50, s34, 12
    s_add_u32 s50, s50, 65536
    s_add_u32 m0, s50, 0
    s_nop 0
    buffer_load_dwordx4 v236, s[68:71], s54 offen lds
    ds_read_b64_tr_b16 v[208:209], v237 offset:22528
    ds_read_b64_tr_b16 v[210:211], v237 offset:23040
    s_waitcnt lgkmcnt(8)
    v_mfma_f32_32x32x16_bf16 v[0:15], v[192:195], v[152:155], v[0:15]
    ds_read_b64_tr_b16 v[212:213], v238 offset:22528
    ds_read_b64_tr_b16 v[214:215], v238 offset:23040
    s_waitcnt lgkmcnt(8)
    v_mfma_f32_32x32x16_bf16 v[16:31], v[196:199], v[152:155], v[16:31]
    ds_read_b64_tr_b16 v[216:217], v237 offset:30720
    ds_read_b64_tr_b16 v[218:219], v237 offset:31232
    s_waitcnt lgkmcnt(8)
    v_mfma_f32_32x32x16_bf16 v[32:47], v[200:203], v[152:155], v[32:47]
    ds_read_b64_tr_b16 v[220:221], v238 offset:30720
    ds_read_b64_tr_b16 v[222:223], v238 offset:31232
    s_waitcnt lgkmcnt(8)
    v_mfma_f32_32x32x16_bf16 v[48:63], v[204:207], v[152:155], v[48:63]
    s_add_u32 s54, s54, 8192
    s_add_u32 m0, s50, 1024
    s_nop 0
    buffer_load_dwordx4 v236, s[68:71], s54 offen lds
    ds_read_b64_tr_b16 v[192:193], v237 offset:32768
    ds_read_b64_tr_b16 v[194:195], v237 offset:33280
    s_waitcnt lgkmcnt(8)
    v_mfma_f32_32x32x16_bf16 v[0:15], v[208:211], v[156:159], v[0:15]
    ds_read_b64_tr_b16 v[196:197], v238 offset:32768
    ds_read_b64_tr_b16 v[198:199], v238 offset:33280
    s_waitcnt lgkmcnt(8)
    v_mfma_f32_32x32x16_bf16 v[16:31], v[212:215], v[156:159], v[16:31]
    ds_read_b64_tr_b16 v[200:201], v237 offset:40960
    ds_read_b64_tr_b16 v[202:203], v237 offset:41472
    s_waitcnt lgkmcnt(8)
    v_mfma_f32_32x32x16_bf16 v[32:47], v[216:219], v[156:159], v[32:47]
    ds_read_b64_tr_b16 v[204:205], v238 offset:40960
    ds_read_b64_tr_b16 v[206:207], v238 offset:41472
    s_waitcnt lgkmcnt(8)
    v_mfma_f32_32x32x16_bf16 v[48:63], v[220:223], v[156:159], v[48:63]
    s_add_u32 m0, s50, 2048
    s_nop 0
    buffer_load_dwordx4 v236, s[72:75], s55 offen lds
    ds_read_b64_tr_b16 v[208:209], v237 offset:34816
    ds_read_b64_tr_b16 v[210:211], v237 offset:35328
    s_waitcnt lgkmcnt(8)
    v_mfma_f32_32x32x16_bf16 v[0:15], v[192:195], v[160:163], v[0:15]
    ds_read_b64_tr_b16 v[212:213], v238 offset:34816
    ds_read_b64_tr_b16 v[214:215], v238 offset:35328
    s_waitcnt lgkmcnt(8)
    v_mfma_f32_32x32x16_bf16 v[16:31], v[196:199], v[160:163], v[16:31]
    ds_read_b64_tr_b16 v[216:217], v237 offset:43008
    ds_read_b64_tr_b16 v[218:219], v237 offset:43520
    s_waitcnt lgkmcnt(8)
    v_mfma_f32_32x32x16_bf16 v[32:47], v[200:203], v[160:163], v[32:47]
    ds_read_b64_tr_b16 v[220:221], v238 offset:43008
    ds_read_b64_tr_b16 v[222:223], v238 offset:43520
    s_waitcnt lgkmcnt(8)
    v_mfma_f32_32x32x16_bf16 v[48:63], v[204:207], v[160:163], v[48:63]
    s_add_u32 s55, s55, 8192
    s_add_u32 m0, s50, 3072
    s_nop 0
    buffer_load_dwordx4 v236, s[72:75], s55 offen lds
    ds_read_b64_tr_b16 v[192:193], v237 offset:36864
    ds_read_b64_tr_b16 v[194:195], v237 offset:37376
    s_waitcnt lgkmcnt(8)
    v_mfma_f32_32x32x16_bf16 v[0:15], v[208:211], v[164:167], v[0:15]
    ds_read_b64_tr_b16 v[196:197], v238 offset:36864
    ds_read_b64_tr_b16 v[198:199], v238 offset:37376
    s_waitcnt lgkmcnt(8)
    v_mfma_f32_32x32x16_bf16 v[16:31], v[212:215], v[164:167], v[16:31]
    ds_read_b64_tr_b16 v[200:201], v237 offset:45056
    ds_read_b64_tr_b16 v[202:203], v237 offset:45568
    s_waitcnt lgkmcnt(8)
    v_mfma_f32_32x32x16_bf16 v[32:47], v[216:219], v[164:167], v[32:47]
    ds_read_b64_tr_b16 v[204:205], v238 offset:45056
    ds_read_b64_tr_b16 v[206:207], v238 offset:45568
    s_waitcnt lgkmcnt(8)
    v_mfma_f32_32x32x16_bf16 v[48:63], v[220:223], v[164:167], v[48:63]
    s_waitcnt vmcnt(4)
    s_barrier
    ds_read_b64_tr_b16 v[208:209], v237 offset:38912
    ds_read_b64_tr_b16 v[210:211], v237 offset:39424
    s_waitcnt lgkmcnt(8)
    v_mfma_f32_32x32x16_bf16 v[0:15], v[192:195], v[168:171], v[0:15]
    ds_read_b64_tr_b16 v[212:213], v238 offset:38912
    ds_read_b64_tr_b16 v[214:215], v238 offset:39424
    s_waitcnt lgkmcnt(8)
    v_mfma_f32_32x32x16_bf16 v[16:31], v[196:199], v[168:171], v[16:31]
    ds_read_b64_tr_b16 v[216:217], v237 offset:47104
    ds_read_b64_tr_b16 v[218:219], v237 offset:47616
    s_waitcnt lgkmcnt(8)
    v_mfma_f32_32x32x16_bf16 v[32:47], v[200:203], v[168:171], v[32:47]
    ds_read_b64_tr_b16 v[220:221], v238 offset:47104
    ds_read_b64_tr_b16 v[222:223], v238 offset:47616
    s_waitcnt lgkmcnt(8)
    v_mfma_f32_32x32x16_bf16 v[48:63], v[204:207], v[168:171], v[48:63]
    ds_read_b64_tr_b16 v[192:193], v237 offset:49152
    ds_read_b64_tr_b16 v[194:195], v237 offset:49664
    s_waitcnt lgkmcnt(8)
    v_mfma_f32_32x32x16_bf16 v[0:15], v[208:211], v[172:175], v[0:15]
    ds_read_b64_tr_b16 v[196:197], v238 offset:49152
    ds_read_b64_tr_b16 v[198:199], v238 offset:49664
    s_waitcnt lgkmcnt(8)
    v_mfma_f32_32x32x16_bf16 v[16:31], v[212:215], v[172:175], v[16:31]
    ds_read_b64_tr_b16 v[200:201], v237 offset:57344
    ds_read_b64_tr_b16 v[202:203], v237 offset:57856
    s_waitcnt lgkmcnt(8)
    v_mfma_f32_32x32x16_bf16 v[32:47], v[216:219], v[172:175], v[32:47]
    ds_read_b64_tr_b16 v[204:205], v238 offset:57344
    ds_read_b64_tr_b16 v[206:207], v238 offset:57856
    s_waitcnt lgkmcnt(8)
    v_mfma_f32_32x32x16_bf16 v[48:63], v[220:223], v[172:175], v[48:63]
    ds_read_b64_tr_b16 v[208:209], v237 offset:51200
    ds_read_b64_tr_b16 v[210:211], v237 offset:51712
    s_waitcnt lgkmcnt(8)
    v_mfma_f32_32x32x16_bf16 v[0:15], v[192:195], v[176:179], v[0:15]
    ds_read_b64_tr_b16 v[212:213], v238 offset:51200
    ds_read_b64_tr_b16 v[214:215], v238 offset:51712
    s_waitcnt lgkmcnt(8)
    v_mfma_f32_32x32x16_bf16 v[16:31], v[196:199], v[176:179], v[16:31]
    ds_read_b64_tr_b16 v[216:217], v237 offset:59392
    ds_read_b64_tr_b16 v[218:219], v237 offset:59904
    s_waitcnt lgkmcnt(8)
    v_mfma_f32_32x32x16_bf16 v[32:47], v[200:203], v[176:179], v[32:47]
    ds_read_b64_tr_b16 v[220:221], v238 offset:59392
    ds_read_b64_tr_b16 v[222:223], v238 offset:59904
    s_waitcnt lgkmcnt(8)
    v_mfma_f32_32x32x16_bf16 v[48:63], v[204:207], v[176:179], v[48:63]
    ds_read_b64_tr_b16 v[192:193], v237 offset:53248
    ds_read_b64_tr_b16 v[194:195], v237 offset:53760
    s_waitcnt lgkmcnt(8)
    v_mfma_f32_32x32x16_bf16 v[0:15], v[208:211], v[180:183], v[0:15]
    ds_read_b64_tr_b16 v[196:197], v238 offset:53248
    ds_read_b64_tr_b16 v[198:199], v238 offset:53760
    s_waitcnt lgkmcnt(8)
    v_mfma_f32_32x32x16_bf16 v[16:31], v[212:215], v[180:183], v[16:31]
    ds_read_b64_tr_b16 v[200:201], v237 offset:61440
    ds_read_b64_tr_b16 v[202:203], v237 offset:61952
    s_waitcnt lgkmcnt(8)
    v_mfma_f32_32x32x16_bf16 v[32:47], v[216:219], v[180:183], v[32:47]
    ds_read_b64_tr_b16 v[204:205], v238 offset:61440
    ds_read_b64_tr_b16 v[206:207], v238 offset:61952
    s_waitcnt lgkmcnt(8)
    v_mfma_f32_32x32x16_bf16 v[48:63], v[220:223], v[180:183], v[48:63]
    ds_read_b64_tr_b16 v[208:209], v237 offset:55296
    ds_read_b64_tr_b16 v[210:211], v237 offset:55808
    s_waitcnt lgkmcnt(8)
    v_mfma_f32_32x32x16_bf16 v[0:15], v[192:195], v[184:187], v[0:15]
    ds_read_b64_tr_b16 v[212:213], v238 offset:55296
    ds_read_b64_tr_b16 v[214:215], v238 offset:55808
    s_waitcnt lgkmcnt(8)
    v_mfma_f32_32x32x16_bf16 v[16:31], v[196:199], v[184:187], v[16:31]
    ds_read_b64_tr_b16 v[216:217], v237 offset:63488
    ds_read_b64_tr_b16 v[218:219], v237 offset:64000
    s_waitcnt lgkmcnt(8)
    v_mfma_f32_32x32x16_bf16 v[32:47], v[200:203], v[184:187], v[32:47]
    ds_read_b64_tr_b16 v[220:221], v238 offset:63488
    ds_read_b64_tr_b16 v[222:223], v238 offset:64000
    s_waitcnt lgkmcnt(8)
    v_mfma_f32_32x32x16_bf16 v[48:63], v[204:207], v[184:187], v[48:63]
    s_waitcnt lgkmcnt(6)
    v_mfma_f32_32x32x16_bf16 v[0:15], v[208:211], v[188:191], v[0:15]
    s_waitcnt lgkmcnt(4)
    v_mfma_f32_32x32x16_bf16 v[16:31], v[212:215], v[188:191], v[16:31]
    s_waitcnt lgkmcnt(2)
    v_mfma_f32_32x32x16_bf16 v[32:47], v[216:219], v[188:191], v[32:47]
    s_waitcnt lgkmcnt(0)
    v_mfma_f32_32x32x16_bf16 v[48:63], v[220:223], v[188:191], v[48:63]
    v_lshrrev_b32 v240, 5, v224
    v_lshlrev_b32 v241, 9, v240
    v_bfe_u32 v240, v224, 2, 2
    v_lshl_add_u32 v241, v240, 7, v241
    v_bfe_u32 v240, v224, 3, 1
    v_lshl_add_u32 v241, v240, 6, v241
    v_bfe_u32 v240, v224, 4, 1
    v_lshl_add_u32 v241, v240, 5, v241
    v_and_b32 v240, 3, v224
    v_lshl_add_u32 v241, v240, 3, v241
    v_xor_b32 v242, 64, v241
    v_add_u32 v241, s50, v241
    v_add_u32 v242, s50, v242
    s_waitcnt vmcnt(0)
    ds_read_b64_tr_b16 v[208:209], v241 offset:0
    ds_read_b64_tr_b16 v[210:211], v241 offset:1024
    ds_read_b64_tr_b16 v[212:213], v242 offset:0
    ds_read_b64_tr_b16 v[214:215], v242 offset:1024
    ds_read_b64_tr_b16 v[216:217], v241 offset:2048
    ds_read_b64_tr_b16 v[218:219], v241 offset:3072
    ds_read_b64_tr_b16 v[220:221], v242 offset:2048
    ds_read_b64_tr_b16 v[222:223], v242 offset:3072
    s_waitcnt lgkmcnt(0)
    s_barrier
    s_add_u32 s38, s48, 16384
    s_add_u32 m0, s47, 0
    s_nop 0
    buffer_load_dwordx4 v228, s[76:79], s38 offen offset:0 lds
    buffer_load_dwordx4 v228, s[76:79], s38 offen offset:1024 lds
    s_add_u32 m0, s47, 8192
    s_add_u32 s38, s38, 8192
    buffer_load_dwordx4 v228, s[76:79], s38 offen offset:0 lds
    buffer_load_dwordx4 v228, s[76:79], s38 offen offset:1024 lds
    s_xor_b32 s47, s47, 32768
    s_add_u32 s38, s48, 81920
    s_add_u32 m0, s47, 0
    s_nop 0
    buffer_load_dwordx4 v228, s[76:79], s38 offen offset:0 lds
    buffer_load_dwordx4 v228, s[76:79], s38 offen offset:1024 lds
    s_add_u32 m0, s47, 8192
    s_add_u32 s38, s38, 8192
    buffer_load_dwordx4 v228, s[76:79], s38 offen offset:0 lds
    buffer_load_dwordx4 v228, s[76:79], s38 offen offset:1024 lds
    s_xor_b32 s47, s47, 32768
    s_add_u32 s68, s32, 0x3c00000
    s_addc_u32 s69, s33, 0
    s_mov_b32 s70, 0x5c0000
    s_mov_b32 s71, 0x00020000
    s_add_u32 s64, s32, 0x2c00000
    s_addc_u32 s65, s33, 0
    s_mov_b32 s66, 0x1000000
    s_mov_b32 s67, 0x00020000
    s_min_u32 s55, s2, 111
    s_add_u32 s55, s55, 256
    s_mul_i32 s37, s34, 753664
    s_mov_b32 s49, 0x3e0293ee
    v_mul_f32 v0, s49, v0
    v_mul_f32 v1, s49, v1
    v_mul_f32 v2, s49, v2
    v_mul_f32 v3, s49, v3
    v_mul_f32 v4, s49, v4
    v_mul_f32 v5, s49, v5
    v_mul_f32 v6, s49, v6
    v_mul_f32 v7, s49, v7
    v_cvt_pk_bf16_f32 v128, v0, v1
    v_cvt_pk_bf16_f32 v129, v2, v3
    v_cvt_pk_bf16_f32 v130, v4, v5
    v_cvt_pk_bf16_f32 v131, v6, v7
    v_mul_f32 v8, s49, v8
    v_mul_f32 v9, s49, v9
    v_mul_f32 v10, s49, v10
    v_mul_f32 v11, s49, v11
    v_mul_f32 v12, s49, v12
    v_mul_f32 v13, s49, v13
    v_mul_f32 v14, s49, v14
    v_mul_f32 v15, s49, v15
    v_cvt_pk_bf16_f32 v132, v8, v9
    v_cvt_pk_bf16_f32 v133, v10, v11
    v_cvt_pk_bf16_f32 v134, v12, v13
    v_cvt_pk_bf16_f32 v135, v14, v15
    v_mul_f32 v16, s49, v16
    v_mul_f32 v17, s49, v17
    v_mul_f32 v18, s49, v18
    v_mul_f32 v19, s49, v19
    v_mul_f32 v20, s49, v20
    v_mul_f32 v21, s49, v21
    v_mul_f32 v22, s49, v22
    v_mul_f32 v23, s49, v23
    v_cvt_pk_bf16_f32 v136, v16, v17
    v_cvt_pk_bf16_f32 v137, v18, v19
    v_cvt_pk_bf16_f32 v138, v20, v21
    v_cvt_pk_bf16_f32 v139, v22, v23
    s_lshr_b32 s38, s2, 1
    s_lshl_b32 s38, s38, 12
    s_add_u32 s38, s38, s37
    s_and_b32 s54, s2, 1
    s_lshl_b32 s54, s54, 10
    s_add_u32 s38, s38, s54
    buffer_store_dwordx4 v[208:211], v228, s[68:71], s38 offen offset:0 sc1
    buffer_store_dwordx4 v[212:215], v228, s[68:71], s38 offen offset:2048 sc1
    v_mul_f32 v24, s49, v24
    v_mul_f32 v25, s49, v25
    v_mul_f32 v26, s49, v26
    v_mul_f32 v27, s49, v27
    v_mul_f32 v28, s49, v28
    v_mul_f32 v29, s49, v29
    v_mul_f32 v30, s49, v30
    v_mul_f32 v31, s49, v31
    v_cvt_pk_bf16_f32 v140, v24, v25
    v_cvt_pk_bf16_f32 v141, v26, v27
    v_cvt_pk_bf16_f32 v142, v28, v29
    v_cvt_pk_bf16_f32 v143, v30, v31
    v_mul_f32 v32, s49, v32
    v_mul_f32 v33, s49, v33
    v_mul_f32 v34, s49, v34
    v_mul_f32 v35, s49, v35
    v_mul_f32 v36, s49, v36
    v_mul_f32 v37, s49, v37
    v_mul_f32 v38, s49, v38
    v_mul_f32 v39, s49, v39
    v_cvt_pk_bf16_f32 v144, v32, v33
    v_cvt_pk_bf16_f32 v145, v34, v35
    v_cvt_pk_bf16_f32 v146, v36, v37
    v_cvt_pk_bf16_f32 v147, v38, v39
    v_mul_f32 v40, s49, v40
    v_mul_f32 v41, s49, v41
    v_mul_f32 v42, s49, v42
    v_mul_f32 v43, s49, v43
    v_mul_f32 v44, s49, v44
    v_mul_f32 v45, s49, v45
    v_mul_f32 v46, s49, v46
    v_mul_f32 v47, s49, v47
    v_cvt_pk_bf16_f32 v148, v40, v41
    v_cvt_pk_bf16_f32 v149, v42, v43
    v_cvt_pk_bf16_f32 v150, v44, v45
    v_cvt_pk_bf16_f32 v151, v46, v47
    s_lshr_b32 s38, s55, 1
    s_lshl_b32 s38, s38, 12
    s_add_u32 s38, s38, s37
    s_and_b32 s54, s55, 1
    s_lshl_b32 s54, s54, 10
    s_add_u32 s38, s38, s54
    buffer_store_dwordx4 v[216:219], v228, s[68:71], s38 offen offset:0 sc1
    buffer_store_dwordx4 v[220:223], v228, s[68:71], s38 offen offset:2048 sc1
    v_mul_f32 v48, s49, v48
    v_mul_f32 v49, s49, v49
    v_mul_f32 v50, s49, v50
    v_mul_f32 v51, s49, v51
    v_mul_f32 v52, s49, v52
    v_mul_f32 v53, s49, v53
    v_mul_f32 v54, s49, v54
    v_mul_f32 v55, s49, v55
    v_cvt_pk_bf16_f32 v152, v48, v49
    v_cvt_pk_bf16_f32 v153, v50, v51
    v_cvt_pk_bf16_f32 v154, v52, v53
    v_cvt_pk_bf16_f32 v155, v54, v55
    v_mul_f32 v56, s49, v56
    v_mul_f32 v57, s49, v57
    v_mul_f32 v58, s49, v58
    v_mul_f32 v59, s49, v59
    v_mul_f32 v60, s49, v60
    v_mul_f32 v61, s49, v61
    v_mul_f32 v62, s49, v62
    v_mul_f32 v63, s49, v63
    v_cvt_pk_bf16_f32 v156, v56, v57
    v_cvt_pk_bf16_f32 v157, v58, v59
    v_cvt_pk_bf16_f32 v158, v60, v61
    v_cvt_pk_bf16_f32 v159, v62, v63
    s_lshl_b32 s37, s42, 13
    s_add_u32 s37, s37, 131072
    v_add_u32 v225, s37, v228
    s_cmp_lg_u32 s41, 0
    s_nop 0
    s_cbranch_scc1 k2_nost
    ds_write_b128 v225, v[128:131] offset:0
    ds_write_b128 v225, v[132:135] offset:1024
    ds_write_b128 v225, v[136:139] offset:2048
    ds_write_b128 v225, v[140:143] offset:3072
    ds_write_b128 v225, v[144:147] offset:4096
    ds_write_b128 v225, v[148:151] offset:5120
    ds_write_b128 v225, v[152:155] offset:6144
    ds_write_b128 v225, v[156:159] offset:7168
    s_waitcnt lgkmcnt(0)
k2_nost:
    v_mov_b32 v160, 0
    v_mov_b32 v161, 0
    v_mov_b32 v162, 0
    v_mov_b32 v163, 0
    v_mov_b32 v164, 0
    v_mov_b32 v165, 0
    v_mov_b32 v166, 0
    v_mov_b32 v167, 0
    v_mov_b32 v168, 0
    v_mov_b32 v169, 0
    v_mov_b32 v170, 0
    v_mov_b32 v171, 0
    v_mov_b32 v172, 0
    v_mov_b32 v173, 0
    v_mov_b32 v174, 0
    v_mov_b32 v175, 0
    v_add_u32 v239, 65536, v228
    s_mov_b32 s49, 0x53800000
    s_lshl_b32 s45, s36, 1
    s_add_u32 s45, s45, 1
    s_lshl_b32 s43, s41, 1
    s_lshl_b32 s6, s34, 6
    s_add_u32 s6, s6, s45
    s_sub_u32 s6, s6, 1
    s_mov_b32 s51, 49152
    s_mov_b32 s53, 49152
    s_add_u32 s39, s41, 1
    s_lshl_b32 s39, s39, 14
    s_lshl_b32 s50, s34, 10
    s_lshl_b32 s4, s35, 20
    s_add_u32 s4, s4, s50
    s_add_u32 s4, s4, 131072
    s_and_b32 s37, s36, 1
    s_lshl_b32 s37, s37, 15
    s_xor_b32 s47, s47, s37
    s_xor_b32 s37, s37, 32768
    s_xor_b32 s46, s46, s37
    s_add_u32 s44, s36, 3
    s_lshl_b32 s58, s44, 16
    s_add_u32 s58, s58, s48
    s_add_u32 s51, s51, 16384
    s_and_b32 s51, s51, 65535
    v_add_u32 v229, s51, v228
    ds_read_b128 v[176:179], v229 offset:0
    ds_read_b128 v[180:183], v229 offset:1024
    ds_read_b128 v[184:187], v229 offset:2048
    ds_read_b128 v[188:191], v229 offset:3072
    ds_read_b128 v[192:195], v229 offset:4096
    ds_read_b128 v[196:199], v229 offset:5120
    ds_read_b128 v[200:203], v229 offset:6144
    s_waitcnt lgkmcnt(6)
    s_cmp_lt_u32 s45, s43
    s_cbranch_scc1 k2_mask1
    v_mfma_f32_32x32x16_bf16 v[64:79], v[176:179], v[128:131], v[160:175]
k2_mback1:
    v_mov_b32 v0, 0
    v_mov_b32 v1, 0
    v_mov_b32 v2, 0
    v_mov_b32 v3, 0
    v_mov_b32 v4, 0
    v_mov_b32 v5, 0
    v_mov_b32 v6, 0
    v_mov_b32 v7, 0
    ds_read_b128 v[204:207], v229 offset:7168
    s_waitcnt lgkmcnt(6)
    v_mfma_f32_32x32x16_bf16 v[64:79], v[180:183], v[132:135], v[64:79]
    v_mov_b32 v8, 0
    v_mov_b32 v9, 0
    v_mov_b32 v10, 0
    v_mov_b32 v11, 0
    v_mov_b32 v12, 0
    v_mov_b32 v13, 0
    v_mov_b32 v14, 0
    v_mov_b32 v15, 0
    ds_read_b128 v[176:179], v229 offset:8192
    s_waitcnt lgkmcnt(6)
    v_mfma_f32_32x32x16_bf16 v[64:79], v[184:187], v[136:139], v[64:79]
    v_mov_b32 v16, 0
    v_mov_b32 v17, 0
    v_mov_b32 v18, 0
    v_mov_b32 v19, 0
    v_mov_b32 v20, 0
    v_mov_b32 v21, 0
    v_mov_b32 v22, 0
    v_mov_b32 v23, 0
    ds_read_b128 v[180:183], v229 offset:9216
    s_waitcnt lgkmcnt(6)
    v_mfma_f32_32x32x16_bf16 v[64:79], v[188:191], v[140:143], v[64:79]
    v_mov_b32 v24, 0
    v_mov_b32 v25, 0
    v_mov_b32 v26, 0
    v_mov_b32 v27, 0
    v_mov_b32 v28, 0
    v_mov_b32 v29, 0
    v_mov_b32 v30, 0
    v_mov_b32 v31, 0
    ds_read_b128 v[184:187], v229 offset:10240
    s_waitcnt lgkmcnt(6)
    v_mfma_f32_32x32x16_bf16 v[64:79], v[192:195], v[144:147], v[64:79]
    s_waitcnt lgkmcnt(3)
    s_barrier
    s_add_u32 m0, s50, 0
    s_add_u32 s37, s4, 0
    buffer_load_dwordx4 v228, s[76:79], s37 offen lds
    v_mov_b32 v32, 0
    v_mov_b32 v33, 0
    v_mov_b32 v34, 0
    v_mov_b32 v35, 0
    v_mov_b32 v36, 0
    v_mov_b32 v37, 0
    v_mov_b32 v38, 0
    v_mov_b32 v39, 0
    ds_read_b128 v[188:191], v229 offset:11264
    v_mfma_f32_32x32x16_bf16 v[64:79], v[196:199], v[148:151], v[64:79]
    v_mov_b32 v40, 0
    v_mov_b32 v41, 0
    v_mov_b32 v42, 0
    v_mov_b32 v43, 0
    v_mov_b32 v44, 0
    v_mov_b32 v45, 0
    v_mov_b32 v46, 0
    v_mov_b32 v47, 0
    ds_read_b128 v[192:195], v229 offset:12288
    v_mfma_f32_32x32x16_bf16 v[64:79], v[200:203], v[152:155], v[64:79]
    v_mov_b32 v48, 0
    v_mov_b32 v49, 0
    v_mov_b32 v50, 0
    v_mov_b32 v51, 0
    v_mov_b32 v52, 0
    v_mov_b32 v53, 0
    v_mov_b32 v54, 0
    v_mov_b32 v55, 0
    ds_read_b128 v[196:199], v229 offset:13312
    v_mfma_f32_32x32x16_bf16 v[64:79], v[204:207], v[156:159], v[64:79]
    v_mov_b32 v56, 0
    v_mov_b32 v57, 0
    v_mov_b32 v58, 0
    v_mov_b32 v59, 0
    v_mov_b32 v60, 0
    v_mov_b32 v61, 0
    v_mov_b32 v62, 0
    v_mov_b32 v63, 0
    ds_read_b128 v[200:203], v229 offset:14336
    s_waitcnt lgkmcnt(6)
    s_cmp_lt_u32 s45, s43
    s_cbranch_scc1 k2_mask2
    v_mfma_f32_32x32x16_bf16 v[80:95], v[176:179], v[128:131], v[160:175]
k2_mback2:
    v_max3_f32 v235, v64, v65, v66
    v_max3_f32 v235, v235, v67, v68
    v_max3_f32 v235, v235, v69, v70
    v_max3_f32 v235, v235, v71, v72
    v_max3_f32 v235, v235, v73, v74
    v_max3_f32 v235, v235, v75, v76
    v_max3_f32 v235, v235, v77, v78
    v_max_f32 v235, v235, v79
    v_mov_b32 v236, v235
    s_nop 1
    v_permlane32_swap_b32 v236, v235
    v_max_f32 v235, v235, v236
    v_max_f32 v235, 0xf149f2ca, v235
    v_sub_f32 v96, v64, v235
    ds_read_b128 v[204:207], v229 offset:15360
    s_waitcnt lgkmcnt(6)
    v_mfma_f32_32x32x16_bf16 v[80:95], v[180:183], v[132:135], v[80:95]
    v_sub_f32 v97, v65, v235
    v_sub_f32 v98, v66, v235
    v_sub_f32 v99, v67, v235
    v_sub_f32 v100, v68, v235
    v_sub_f32 v101, v69, v235
    v_sub_f32 v102, v70, v235
    v_sub_f32 v103, v71, v235
    v_sub_f32 v104, v72, v235
    v_sub_f32 v105, v73, v235
    v_sub_f32 v106, v74, v235
    v_sub_f32 v107, v75, v235
    v_sub_f32 v108, v76, v235
    s_add_u32 s53, s53, 16384
    s_and_b32 s53, s53, 65535
    v_add_u32 v230, s53, v239
    ds_read_b128 v[176:179], v230 offset:0
    s_waitcnt lgkmcnt(6)
    v_mfma_f32_32x32x16_bf16 v[80:95], v[184:187], v[136:139], v[80:95]
    v_sub_f32 v109, v77, v235
    v_sub_f32 v110, v78, v235
    v_sub_f32 v111, v79, v235
    v_exp_f32 v96, v96
    v_exp_f32 v97, v97
    v_exp_f32 v98, v98
    v_exp_f32 v99, v99
    v_cvt_pk_bf16_f32 v112, v96, v97
    v_add_f32 v234, v96, v97
    ds_read_b128 v[180:183], v230 offset:1024
    s_waitcnt lgkmcnt(6)
    v_mfma_f32_32x32x16_bf16 v[80:95], v[188:191], v[140:143], v[80:95]
    v_exp_f32 v100, v100
    v_exp_f32 v101, v101
    v_cvt_pk_bf16_f32 v113, v98, v99
    v_add_f32 v98, v98, v99
    v_add_f32 v234, v234, v98
    v_exp_f32 v102, v102
    v_exp_f32 v103, v103
    v_cvt_pk_bf16_f32 v114, v100, v101
    ds_read_b128 v[184:187], v230 offset:2048
    s_waitcnt lgkmcnt(6)
    v_mfma_f32_32x32x16_bf16 v[80:95], v[192:195], v[144:147], v[80:95]
    s_waitcnt lgkmcnt(3)
    s_waitcnt vmcnt(5)
    s_barrier
    v_add_f32 v100, v100, v101
    v_add_f32 v234, v234, v100
    v_exp_f32 v104, v104
    v_exp_f32 v105, v105
    v_cvt_pk_bf16_f32 v115, v102, v103
    v_add_f32 v102, v102, v103
    v_add_f32 v234, v234, v102
    v_exp_f32 v106, v106
    v_exp_f32 v107, v107
    ds_read_b128 v[188:191], v230 offset:3072
    v_mfma_f32_32x32x16_bf16 v[80:95], v[196:199], v[148:151], v[80:95]
    v_cvt_pk_bf16_f32 v116, v104, v105
    v_add_f32 v104, v104, v105
    v_add_f32 v234, v234, v104
    v_exp_f32 v108, v108
    v_exp_f32 v109, v109
    v_cvt_pk_bf16_f32 v117, v106, v107
    v_add_f32 v106, v106, v107
    v_add_f32 v234, v234, v106
    v_exp_f32 v110, v110
    ds_read_b128 v[192:195], v230 offset:4096
    v_mfma_f32_32x32x16_bf16 v[80:95], v[200:203], v[152:155], v[80:95]
    v_exp_f32 v111, v111
    v_cvt_pk_bf16_f32 v118, v108, v109
    v_add_f32 v108, v108, v109
    v_add_f32 v234, v234, v108
    v_cvt_pk_bf16_f32 v119, v110, v111
    v_add_f32 v110, v110, v111
    v_add_f32 v234, v234, v110
    v_sub_f32 v160, 0, v235
    v_sub_f32 v161, 0, v235
    v_sub_f32 v162, 0, v235
    v_sub_f32 v163, 0, v235
    ds_read_b128 v[196:199], v230 offset:5120
    v_mfma_f32_32x32x16_bf16 v[80:95], v[204:207], v[156:159], v[80:95]
    v_sub_f32 v164, 0, v235
    v_sub_f32 v165, 0, v235
    v_sub_f32 v166, 0, v235
    v_sub_f32 v167, 0, v235
    v_sub_f32 v168, 0, v235
    v_sub_f32 v169, 0, v235
    v_sub_f32 v170, 0, v235
    v_sub_f32 v171, 0, v235
    v_sub_f32 v172, 0, v235
    v_sub_f32 v173, 0, v235
    v_sub_f32 v174, 0, v235
    v_sub_f32 v175, 0, v235
    v_sub_f32 v80, v80, v235
    v_sub_f32 v81, v81, v235
    v_sub_f32 v82, v82, v235
    v_sub_f32 v83, v83, v235
    v_sub_f32 v84, v84, v235
    v_sub_f32 v85, v85, v235
    v_sub_f32 v86, v86, v235
    v_sub_f32 v87, v87, v235
    v_sub_f32 v88, v88, v235
    v_sub_f32 v89, v89, v235
    v_sub_f32 v90, v90, v235
    v_sub_f32 v91, v91, v235
    v_sub_f32 v92, v92, v235
    v_sub_f32 v93, v93, v235
    v_sub_f32 v94, v94, v235
    v_sub_f32 v95, v95, v235
    v_mov_b32 v233, v234
k2_loop1:
    s_sub_u32 s45, s45, 1
    ds_read_b128 v[200:203], v230 offset:6144
    s_waitcnt lgkmcnt(6)
    v_mfma_f32_32x32x16_bf16 v[0:15], v[176:179], v[112:115], v[0:15]
    s_add_u32 m0, s50, 8192
    s_add_u32 s37, s4, 8192
    buffer_load_dwordx4 v228, s[76:79], s37 offen lds
    s_add_u32 s5, s50, 65536
    s_add_u32 s50, s50, 16384
    s_and_b32 s50, s50, 65535
    s_add_u32 s4, s4, 32768
    v_exp_f32 v96, v80
    v_exp_f32 v97, v81
    ds_read_b128 v[204:207], v230 offset:7168
    s_waitcnt lgkmcnt(6)
    v_mfma_f32_32x32x16_bf16 v[0:15], v[180:183], v[116:119], v[0:15]
    v_exp_f32 v98, v82
    v_exp_f32 v99, v83
    s_add_u32 s51, s51, 16384
    s_and_b32 s51, s51, 65535
    v_add_u32 v229, s51, v228
    ds_read_b128 v[176:179], v229 offset:0
    s_waitcnt lgkmcnt(6)
    v_mfma_f32_32x32x16_bf16 v[16:31], v[184:187], v[112:115], v[16:31]
    v_cvt_pk_bf16_f32 v120, v96, v97
    v_add_f32 v234, v96, v97
    v_exp_f32 v100, v84
    ds_read_b128 v[180:183], v229 offset:1024
    s_waitcnt lgkmcnt(6)
    v_mfma_f32_32x32x16_bf16 v[16:31], v[188:191], v[116:119], v[16:31]
    v_exp_f32 v101, v85
    ds_read_b128 v[184:187], v229 offset:2048
    s_waitcnt lgkmcnt(6)
    v_mfma_f32_32x32x16_bf16 v[32:47], v[192:195], v[112:115], v[32:47]
    v_cvt_pk_bf16_f32 v121, v98, v99
    v_add_f32 v98, v98, v99
    v_add_f32 v234, v234, v98
    v_exp_f32 v102, v86
    ds_read_b128 v[188:191], v229 offset:3072
    s_waitcnt lgkmcnt(6)
    v_mfma_f32_32x32x16_bf16 v[32:47], v[196:199], v[116:119], v[32:47]
    v_exp_f32 v103, v87
    ds_read_b128 v[192:195], v229 offset:4096
    s_waitcnt lgkmcnt(6)
    v_mfma_f32_32x32x16_bf16 v[48:63], v[200:203], v[112:115], v[48:63]
    v_cvt_pk_bf16_f32 v122, v100, v101
    v_add_f32 v100, v100, v101
    v_add_f32 v234, v234, v100
    v_exp_f32 v104, v88
    ds_read_b128 v[196:199], v229 offset:5120
    s_waitcnt lgkmcnt(6)
    v_mfma_f32_32x32x16_bf16 v[48:63], v[204:207], v[116:119], v[48:63]
    v_exp_f32 v105, v89
    ds_read_b128 v[200:203], v229 offset:6144
    s_waitcnt lgkmcnt(6)
    s_cmp_lt_u32 s45, s43
    s_cbranch_scc1 k2_mask3
    v_mfma_f32_32x32x16_bf16 v[64:79], v[176:179], v[128:131], v[160:175]
k2_mback3:
    v_cvt_pk_bf16_f32 v123, v102, v103
    v_add_f32 v102, v102, v103
    v_add_f32 v234, v234, v102
    v_exp_f32 v106, v90
    ds_read_b128 v[204:207], v229 offset:7168
    s_waitcnt lgkmcnt(6)
    v_mfma_f32_32x32x16_bf16 v[64:79], v[180:183], v[132:135], v[64:79]
    v_exp_f32 v107, v91
    ds_read_b128 v[176:179], v230 offset:8192
    s_waitcnt lgkmcnt(6)
    v_mfma_f32_32x32x16_bf16 v[64:79], v[184:187], v[136:139], v[64:79]
    v_cvt_pk_bf16_f32 v124, v104, v105
    v_add_f32 v104, v104, v105
    v_add_f32 v234, v234, v104
    v_exp_f32 v108, v92
    ds_read_b128 v[180:183], v230 offset:9216
    s_waitcnt lgkmcnt(6)
    v_mfma_f32_32x32x16_bf16 v[64:79], v[188:191], v[140:143], v[64:79]
    v_exp_f32 v109, v93
    ds_read_b128 v[184:187], v230 offset:10240
    s_waitcnt lgkmcnt(6)
    v_mfma_f32_32x32x16_bf16 v[64:79], v[192:195], v[144:147], v[64:79]
    s_waitcnt lgkmcnt(3)
    s_waitcnt vmcnt(4)
    s_barrier
    s_add_u32 m0, s5, 0
    s_sub_u32 s37, s4, 16384
    buffer_load_dwordx4 v228, s[76:79], s37 offen lds
    v_cvt_pk_bf16_f32 v125, v106, v107
    v_add_f32 v106, v106, v107
    v_add_f32 v234, v234, v106
    v_exp_f32 v110, v94
    ds_read_b128 v[188:191], v230 offset:11264
    v_mfma_f32_32x32x16_bf16 v[64:79], v[196:199], v[148:151], v[64:79]
    v_exp_f32 v111, v95
    ds_read_b128 v[192:195], v230 offset:12288
    v_mfma_f32_32x32x16_bf16 v[64:79], v[200:203], v[152:155], v[64:79]
    v_cvt_pk_bf16_f32 v126, v108, v109
    v_add_f32 v108, v108, v109
    v_add_f32 v234, v234, v108
    v_cvt_pk_bf16_f32 v127, v110, v111
    ds_read_b128 v[196:199], v230 offset:13312
    v_mfma_f32_32x32x16_bf16 v[64:79], v[204:207], v[156:159], v[64:79]
    v_add_f32 v110, v110, v111
    v_add_f32 v234, v234, v110
    v_cmp_lt_f32 vcc, s49, v234
    s_cbranch_vccnz k2_slow4
k2_sback4:
    v_add_f32 v233, v233, v234
    ds_read_b128 v[200:203], v230 offset:14336
    s_waitcnt lgkmcnt(6)
    v_mfma_f32_32x32x16_bf16 v[0:15], v[176:179], v[120:123], v[0:15]
    s_add_u32 m0, s50, 0
    s_add_u32 s37, s4, 0
    buffer_load_dwordx4 v228, s[76:79], s37 offen lds
    s_nop 0
    v_exp_f32 v96, v64
    v_exp_f32 v97, v65
    ds_read_b128 v[204:207], v230 offset:15360
    s_waitcnt lgkmcnt(6)
    v_mfma_f32_32x32x16_bf16 v[0:15], v[180:183], v[124:127], v[0:15]
    v_exp_f32 v98, v66
    v_exp_f32 v99, v67
    ds_read_b128 v[176:179], v229 offset:8192
    s_waitcnt lgkmcnt(6)
    v_mfma_f32_32x32x16_bf16 v[16:31], v[184:187], v[120:123], v[16:31]
    v_cvt_pk_bf16_f32 v112, v96, v97
    v_add_f32 v234, v96, v97
    v_exp_f32 v100, v68
    ds_read_b128 v[180:183], v229 offset:9216
    s_waitcnt lgkmcnt(6)
    v_mfma_f32_32x32x16_bf16 v[16:31], v[188:191], v[124:127], v[16:31]
    v_exp_f32 v101, v69
    ds_read_b128 v[184:187], v229 offset:10240
    s_waitcnt lgkmcnt(6)
    v_mfma_f32_32x32x16_bf16 v[32:47], v[192:195], v[120:123], v[32:47]
    v_cvt_pk_bf16_f32 v113, v98, v99
    v_add_f32 v98, v98, v99
    v_add_f32 v234, v234, v98
    v_exp_f32 v102, v70
    ds_read_b128 v[188:191], v229 offset:11264
    s_waitcnt lgkmcnt(6)
    v_mfma_f32_32x32x16_bf16 v[32:47], v[196:199], v[124:127], v[32:47]
    v_exp_f32 v103, v71
    ds_read_b128 v[192:195], v229 offset:12288
    s_waitcnt lgkmcnt(6)
    v_mfma_f32_32x32x16_bf16 v[48:63], v[200:203], v[120:123], v[48:63]
    v_cvt_pk_bf16_f32 v114, v100, v101
    v_add_f32 v100, v100, v101
    v_add_f32 v234, v234, v100
    v_exp_f32 v104, v72
    ds_read_b128 v[196:199], v229 offset:13312
    s_waitcnt lgkmcnt(6)
    v_mfma_f32_32x32x16_bf16 v[48:63], v[204:207], v[124:127], v[48:63]
    v_exp_f32 v105, v73
    ds_read_b128 v[200:203], v229 offset:14336
    s_waitcnt lgkmcnt(6)
    s_cmp_lt_u32 s45, s43
    s_cbranch_scc1 k2_mask5
    v_mfma_f32_32x32x16_bf16 v[80:95], v[176:179], v[128:131], v[160:175]
k2_mback5:
    v_cvt_pk_bf16_f32 v115, v102, v103
    v_add_f32 v102, v102, v103
    v_add_f32 v234, v234, v102
    v_exp_f32 v106, v74
    ds_read_b128 v[204:207], v229 offset:15360
    s_waitcnt lgkmcnt(6)
    v_mfma_f32_32x32x16_bf16 v[80:95], v[180:183], v[132:135], v[80:95]
    v_exp_f32 v107, v75
    s_add_u32 s53, s53, 16384
    s_and_b32 s53, s53, 65535
    v_add_u32 v230, s53, v239
    ds_read_b128 v[176:179], v230 offset:0
    s_waitcnt lgkmcnt(6)
    v_mfma_f32_32x32x16_bf16 v[80:95], v[184:187], v[136:139], v[80:95]
    v_cvt_pk_bf16_f32 v116, v104, v105
    v_add_f32 v104, v104, v105
    v_add_f32 v234, v234, v104
    v_exp_f32 v108, v76
    ds_read_b128 v[180:183], v230 offset:1024
    s_waitcnt lgkmcnt(6)
    v_mfma_f32_32x32x16_bf16 v[80:95], v[188:191], v[140:143], v[80:95]
    v_exp_f32 v109, v77
    ds_read_b128 v[184:187], v230 offset:2048
    s_waitcnt lgkmcnt(6)
    v_mfma_f32_32x32x16_bf16 v[80:95], v[192:195], v[144:147], v[80:95]
    s_waitcnt lgkmcnt(3)
    s_waitcnt vmcnt(4)
    s_barrier
    s_add_u32 m0, s5, 8192
    s_sub_u32 s37, s4, 8192
    buffer_load_dwordx4 v228, s[76:79], s37 offen lds
    v_cvt_pk_bf16_f32 v117, v106, v107
    v_add_f32 v106, v106, v107
    v_add_f32 v234, v234, v106
    v_exp_f32 v110, v78
    ds_read_b128 v[188:191], v230 offset:3072
    v_mfma_f32_32x32x16_bf16 v[80:95], v[196:199], v[148:151], v[80:95]
    v_exp_f32 v111, v79
    ds_read_b128 v[192:195], v230 offset:4096
    v_mfma_f32_32x32x16_bf16 v[80:95], v[200:203], v[152:155], v[80:95]
    v_cvt_pk_bf16_f32 v118, v108, v109
    v_add_f32 v108, v108, v109
    v_add_f32 v234, v234, v108
    v_cvt_pk_bf16_f32 v119, v110, v111
    ds_read_b128 v[196:199], v230 offset:5120
    v_mfma_f32_32x32x16_bf16 v[80:95], v[204:207], v[156:159], v[80:95]
    v_add_f32 v110, v110, v111
    v_add_f32 v234, v234, v110
    v_cmp_lt_f32 vcc, s49, v234
    s_cbranch_vccnz k2_slow6
k2_sback6:
    v_add_f32 v233, v233, v234
    s_cmp_lg_u32 s6, s45
    s_cbranch_scc1 k2_w10
    s_lshl_b32 s38, s2, 4
    s_add_u32 s38, s38, 16384
    v_lshlrev_b32 v249, 12, v224
    v_mov_b32 v250, 1
    s_mov_b64 exec, 255
    buffer_store_dword v250, v249, s[84:87], s38 offen sc1
    s_mov_b64 exec, -1
k2_w10:
    s_cmp_lg_u32 s45, 0
    s_cbranch_scc1 k2_loop1
    s_lshl_b32 s37, s36, 1
    s_sub_u32 s45, 14, s37
    s_mov_b32 s43, 1
    s_lshl_b32 s6, s34, 6
    s_add_u32 s6, s6, s45
    s_sub_u32 s6, s6, 1
    s_lshl_b32 s3, s36, 11
    s_and_b32 s37, s2, 31
    s_lshl_b32 s37, s37, 4
    s_add_u32 s3, s3, s37
    s_add_u32 s3, s3, 49152
    s_cmp_eq_u32 s41, 0
    s_cbranch_scc1 k2_tr0
    ds_read_b128 v[128:131], v225 offset:0
    ds_read_b128 v[132:135], v225 offset:1024
    ds_read_b128 v[136:139], v225 offset:2048
    ds_read_b128 v[140:143], v225 offset:3072
    ds_read_b128 v[144:147], v225 offset:4096
    ds_read_b128 v[148:151], v225 offset:5120
    ds_read_b128 v[152:155], v225 offset:6144
    ds_read_b128 v[156:159], v225 offset:7168
    v_mov_b32 v160, 0
    v_mov_b32 v161, 0
    v_mov_b32 v162, 0
    v_mov_b32 v163, 0
    v_mov_b32 v164, 0
    v_mov_b32 v165, 0
    v_mov_b32 v166, 0
    v_mov_b32 v167, 0
    v_mov_b32 v168, 0
    v_mov_b32 v169, 0
    v_mov_b32 v170, 0
    v_mov_b32 v171, 0
    v_mov_b32 v172, 0
    v_mov_b32 v173, 0
    v_mov_b32 v174, 0
    v_mov_b32 v175, 0
    ds_read_b128 v[200:203], v230 offset:6144
    s_waitcnt lgkmcnt(14)
    v_mfma_f32_32x32x16_bf16 v[0:15], v[176:179], v[112:115], v[0:15]
    s_add_u32 m0, s50, 8192
    s_add_u32 s37, s4, 8192
    buffer_load_dwordx4 v228, s[76:79], s37 offen lds
    s_add_u32 s5, s50, 65536
    s_add_u32 s50, s50, 16384
    s_and_b32 s50, s50, 65535
    s_add_u32 s4, s4, 32768
    v_exp_f32 v96, v80
    v_exp_f32 v97, v81
    ds_read_b128 v[204:207], v230 offset:7168
    s_waitcnt lgkmcnt(14)
    v_mfma_f32_32x32x16_bf16 v[0:15], v[180:183], v[116:119], v[0:15]
    v_exp_f32 v98, v82
    v_exp_f32 v99, v83
    s_add_u32 s51, s51, s39
    s_and_b32 s51, s51, 65535
    v_add_u32 v229, s51, v228
    ds_read_b128 v[176:179], v229 offset:0
    s_waitcnt lgkmcnt(14)
    v_mfma_f32_32x32x16_bf16 v[16:31], v[184:187], v[112:115], v[16:31]
    v_cvt_pk_bf16_f32 v120, v96, v97
    v_add_f32 v234, v96, v97
    v_exp_f32 v100, v84
    ds_read_b128 v[180:183], v229 offset:1024
    s_waitcnt lgkmcnt(14)
    v_mfma_f32_32x32x16_bf16 v[16:31], v[188:191], v[116:119], v[16:31]
    v_exp_f32 v101, v85
    ds_read_b128 v[184:187], v229 offset:2048
    s_waitcnt lgkmcnt(14)
    v_mfma_f32_32x32x16_bf16 v[32:47], v[192:195], v[112:115], v[32:47]
    v_cvt_pk_bf16_f32 v121, v98, v99
    v_add_f32 v98, v98, v99
    v_add_f32 v234, v234, v98
    v_exp_f32 v102, v86
    ds_read_b128 v[188:191], v229 offset:3072
    s_waitcnt lgkmcnt(14)
    v_mfma_f32_32x32x16_bf16 v[32:47], v[196:199], v[116:119], v[32:47]
    v_exp_f32 v103, v87
    ds_read_b128 v[192:195], v229 offset:4096
    s_waitcnt lgkmcnt(6)
    v_mfma_f32_32x32x16_bf16 v[48:63], v[200:203], v[112:115], v[48:63]
    v_cvt_pk_bf16_f32 v122, v100, v101
    v_add_f32 v100, v100, v101
    v_add_f32 v234, v234, v100
    v_exp_f32 v104, v88
    ds_read_b128 v[196:199], v229 offset:5120
    s_waitcnt lgkmcnt(6)
    v_mfma_f32_32x32x16_bf16 v[48:63], v[204:207], v[116:119], v[48:63]
    v_exp_f32 v105, v89
    ds_read_b128 v[200:203], v229 offset:6144
    s_waitcnt lgkmcnt(6)
    s_cmp_lt_u32 s45, s43
    s_cbranch_scc1 k2_mask7
    v_mfma_f32_32x32x16_bf16 v[64:79], v[176:179], v[128:131], v[160:175]
k2_mback7:
    v_cvt_pk_bf16_f32 v123, v102, v103
    v_add_f32 v102, v102, v103
    v_add_f32 v234, v234, v102
    v_exp_f32 v106, v90
    ds_read_b128 v[204:207], v229 offset:7168
    s_waitcnt lgkmcnt(6)
    v_mfma_f32_32x32x16_bf16 v[64:79], v[180:183], v[132:135], v[64:79]
    v_exp_f32 v107, v91
    ds_read_b128 v[176:179], v230 offset:8192
    s_waitcnt lgkmcnt(6)
    v_mfma_f32_32x32x16_bf16 v[64:79], v[184:187], v[136:139], v[64:79]
    v_cvt_pk_bf16_f32 v124, v104, v105
    v_add_f32 v104, v104, v105
    v_add_f32 v234, v234, v104
    v_exp_f32 v108, v92
    ds_read_b128 v[180:183], v230 offset:9216
    s_waitcnt lgkmcnt(6)
    v_mfma_f32_32x32x16_bf16 v[64:79], v[188:191], v[140:143], v[64:79]
    v_exp_f32 v109, v93
    ds_read_b128 v[184:187], v230 offset:10240
    s_waitcnt lgkmcnt(6)
    v_mfma_f32_32x32x16_bf16 v[64:79], v[192:195], v[144:147], v[64:79]
    s_waitcnt lgkmcnt(3)
    s_waitcnt vmcnt(4)
    s_barrier
    s_add_u32 m0, s5, 0
    s_sub_u32 s37, s4, 16384
    buffer_load_dwordx4 v228, s[76:79], s37 offen lds
    v_cvt_pk_bf16_f32 v125, v106, v107
    v_add_f32 v106, v106, v107
    v_add_f32 v234, v234, v106
    v_exp_f32 v110, v94
    ds_read_b128 v[188:191], v230 offset:11264
    v_mfma_f32_32x32x16_bf16 v[64:79], v[196:199], v[148:151], v[64:79]
    v_exp_f32 v111, v95
    ds_read_b128 v[192:195], v230 offset:12288
    v_mfma_f32_32x32x16_bf16 v[64:79], v[200:203], v[152:155], v[64:79]
    v_cvt_pk_bf16_f32 v126, v108, v109
    v_add_f32 v108, v108, v109
    v_add_f32 v234, v234, v108
    v_cvt_pk_bf16_f32 v127, v110, v111
    ds_read_b128 v[196:199], v230 offset:13312
    v_mfma_f32_32x32x16_bf16 v[64:79], v[204:207], v[156:159], v[64:79]
    v_add_f32 v110, v110, v111
    v_add_f32 v234, v234, v110
    v_cmp_lt_f32 vcc, s49, v234
    s_cbranch_vccnz k2_slow8
k2_sback8:
    v_add_f32 v233, v233, v234
    ds_read_b128 v[200:203], v230 offset:14336
    s_waitcnt lgkmcnt(6)
    v_mfma_f32_32x32x16_bf16 v[0:15], v[176:179], v[120:123], v[0:15]
    s_add_u32 m0, s46, 0
    s_nop 0
    buffer_load_dwordx4 v228, s[76:79], s58 offen offset:0 lds
    s_nop 0
    v_max3_f32 v235, v64, v65, v66
    v_max3_f32 v235, v235, v67, v68
    v_max3_f32 v235, v235, v69, v70
    v_max3_f32 v235, v235, v71, v72
    v_max3_f32 v235, v235, v73, v74
    v_max3_f32 v235, v235, v75, v76
    v_max3_f32 v235, v235, v77, v78
    ds_read_b128 v[204:207], v230 offset:15360
    s_waitcnt lgkmcnt(6)
    v_mfma_f32_32x32x16_bf16 v[0:15], v[180:183], v[124:127], v[0:15]
    v_max_f32 v235, v235, v79
    v_mov_b32 v236, v235
    s_nop 1
    v_permlane32_swap_b32 v236, v235
    v_max_f32 v235, v235, v236
    v_max_f32 v235, 0xf149f2ca, v235
    v_sub_f32 v96, v64, v235
    ds_read_b128 v[176:179], v229 offset:8192
    s_waitcnt lgkmcnt(6)
    v_mfma_f32_32x32x16_bf16 v[16:31], v[184:187], v[120:123], v[16:31]
    v_sub_f32 v97, v65, v235
    v_sub_f32 v98, v66, v235
    v_sub_f32 v99, v67, v235
    v_sub_f32 v100, v68, v235
    v_sub_f32 v101, v69, v235
    v_sub_f32 v102, v70, v235
    ds_read_b128 v[180:183], v229 offset:9216
    s_waitcnt lgkmcnt(6)
    v_mfma_f32_32x32x16_bf16 v[16:31], v[188:191], v[124:127], v[16:31]
    v_sub_f32 v103, v71, v235
    v_sub_f32 v104, v72, v235
    v_sub_f32 v105, v73, v235
    v_sub_f32 v106, v74, v235
    v_sub_f32 v107, v75, v235
    v_sub_f32 v108, v76, v235
    ds_read_b128 v[184:187], v229 offset:10240
    s_waitcnt lgkmcnt(6)
    v_mfma_f32_32x32x16_bf16 v[32:47], v[192:195], v[120:123], v[32:47]
    buffer_load_dwordx4 v228, s[76:79], s58 offen offset:1024 lds
    v_sub_f32 v109, v77, v235
    v_sub_f32 v110, v78, v235
    v_sub_f32 v111, v79, v235
    v_exp_f32 v96, v96
    v_exp_f32 v97, v97
    ds_read_b128 v[188:191], v229 offset:11264
    s_waitcnt lgkmcnt(6)
    v_mfma_f32_32x32x16_bf16 v[32:47], v[196:199], v[124:127], v[32:47]
    v_exp_f32 v98, v98
    v_exp_f32 v99, v99
    v_cvt_pk_bf16_f32 v112, v96, v97
    v_add_f32 v234, v96, v97
    ds_read_b128 v[192:195], v229 offset:12288
    s_waitcnt lgkmcnt(6)
    v_mfma_f32_32x32x16_bf16 v[48:63], v[200:203], v[120:123], v[48:63]
    v_exp_f32 v100, v100
    v_exp_f32 v101, v101
    v_cvt_pk_bf16_f32 v113, v98, v99
    v_add_f32 v98, v98, v99
    ds_read_b128 v[196:199], v229 offset:13312
    s_waitcnt lgkmcnt(6)
    v_mfma_f32_32x32x16_bf16 v[48:63], v[204:207], v[124:127], v[48:63]
    v_add_f32 v234, v234, v98
    v_exp_f32 v102, v102
    v_exp_f32 v103, v103
    v_cvt_pk_bf16_f32 v114, v100, v101
    ds_read_b128 v[200:203], v229 offset:14336
    s_waitcnt lgkmcnt(6)
    s_cmp_lt_u32 s45, s43
    s_cbranch_scc1 k2_mask9
    v_mfma_f32_32x32x16_bf16 v[80:95], v[176:179], v[128:131], v[160:175]
k2_mback9:
    v_add_f32 v100, v100, v101
    v_add_f32 v234, v234, v100
    v_exp_f32 v104, v104
    v_exp_f32 v105, v105
    ds_read_b128 v[204:207], v229 offset:15360
    s_waitcnt lgkmcnt(6)
    v_mfma_f32_32x32x16_bf16 v[80:95], v[180:183], v[132:135], v[80:95]
    v_cvt_pk_bf16_f32 v115, v102, v103
    v_add_f32 v102, v102, v103
    v_add_f32 v234, v234, v102
    v_exp_f32 v106, v106
    v_exp_f32 v107, v107
    s_add_u32 s53, s53, s39
    s_and_b32 s53, s53, 65535
    v_add_u32 v230, s53, v239
    ds_read_b128 v[176:179], v230 offset:0
    s_waitcnt lgkmcnt(6)
    v_mfma_f32_32x32x16_bf16 v[80:95], v[184:187], v[136:139], v[80:95]
    v_cvt_pk_bf16_f32 v116, v104, v105
    v_add_f32 v104, v104, v105
    v_add_f32 v234, v234, v104
    v_exp_f32 v108, v108
    v_exp_f32 v109, v109
    ds_read_b128 v[180:183], v230 offset:1024
    s_waitcnt lgkmcnt(6)
    v_mfma_f32_32x32x16_bf16 v[80:95], v[188:191], v[140:143], v[80:95]
    v_cvt_pk_bf16_f32 v117, v106, v107
    v_add_f32 v106, v106, v107
    v_add_f32 v234, v234, v106
    v_exp_f32 v110, v110
    ds_read_b128 v[184:187], v230 offset:2048
    s_waitcnt lgkmcnt(6)
    v_mfma_f32_32x32x16_bf16 v[80:95], v[192:195], v[144:147], v[80:95]
    s_waitcnt lgkmcnt(3)
    s_waitcnt vmcnt(4)
    s_barrier
    s_add_u32 m0, s5, 8192
    s_sub_u32 s37, s4, 8192
    buffer_load_dwordx4 v228, s[76:79], s37 offen lds
    v_exp_f32 v111, v111
    v_cvt_pk_bf16_f32 v118, v108, v109
    v_add_f32 v108, v108, v109
    v_add_f32 v234, v234, v108
    v_cvt_pk_bf16_f32 v119, v110, v111
    ds_read_b128 v[188:191], v230 offset:3072
    v_mfma_f32_32x32x16_bf16 v[80:95], v[196:199], v[148:151], v[80:95]
    v_add_f32 v110, v110, v111
    v_add_f32 v234, v234, v110
    v_sub_f32 v160, 0, v235
    v_sub_f32 v161, 0, v235
    v_sub_f32 v162, 0, v235
    v_sub_f32 v163, 0, v235
    ds_read_b128 v[192:195], v230 offset:4096
    v_mfma_f32_32x32x16_bf16 v[80:95], v[200:203], v[152:155], v[80:95]
    v_sub_f32 v164, 0, v235
    v_sub_f32 v165, 0, v235
    v_sub_f32 v166, 0, v235
    v_sub_f32 v167, 0, v235
    v_sub_f32 v168, 0, v235
    v_sub_f32 v169, 0, v235
    ds_read_b128 v[196:199], v230 offset:5120
    v_mfma_f32_32x32x16_bf16 v[80:95], v[204:207], v[156:159], v[80:95]
    v_sub_f32 v170, 0, v235
    v_sub_f32 v171, 0, v235
    v_sub_f32 v172, 0, v235
    v_sub_f32 v173, 0, v235
    v_sub_f32 v174, 0, v235
    v_sub_f32 v175, 0, v235
    s_nop 5
    v_sub_f32 v80, v80, v235
    v_sub_f32 v81, v81, v235
    v_sub_f32 v82, v82, v235
    v_sub_f32 v83, v83, v235
    v_sub_f32 v84, v84, v235
    v_sub_f32 v85, v85, v235
    v_sub_f32 v86, v86, v235
    v_sub_f32 v87, v87, v235
    v_sub_f32 v88, v88, v235
    v_sub_f32 v89, v89, v235
    v_sub_f32 v90, v90, v235
    v_sub_f32 v91, v91, v235
    v_sub_f32 v92, v92, v235
    v_sub_f32 v93, v93, v235
    v_sub_f32 v94, v94, v235
    v_sub_f32 v95, v95, v235
    v_mov_b32 v226, v233
    v_mov_b32 v233, v234
    v_mov_b32 v236, v226
    s_nop 1
    v_permlane32_swap_b32 v236, v226
    v_add_f32 v226, v226, v236
    v_rcp_f32 v226, v226
    s_lshl_b32 s37, s40, 18
    s_lshl_b32 s38, s35, 13
    s_add_u32 s37, s37, s38
    v_add_u32 v235, s37, v228
    v_mul_f32 v0, v0, v226
    v_mul_f32 v1, v1, v226
    v_mul_f32 v2, v2, v226
    v_mul_f32 v3, v3, v226
    v_mul_f32 v4, v4, v226
    v_mul_f32 v5, v5, v226
    v_mul_f32 v6, v6, v226
    v_mul_f32 v7, v7, v226
    v_cvt_pk_bf16_f32 v248, v0, v1
    v_cvt_pk_bf16_f32 v249, v2, v3
    v_cvt_pk_bf16_f32 v250, v4, v5
    v_cvt_pk_bf16_f32 v251, v6, v7
    s_mov_b32 s38, 0
    buffer_store_dwordx4 v[248:251], v235, s[64:67], s38 offen offset:0 sc1
    v_mov_b32 v0, 0
    v_mov_b32 v1, 0
    v_mov_b32 v2, 0
    v_mov_b32 v3, 0
    v_mov_b32 v4, 0
    v_mov_b32 v5, 0
    v_mov_b32 v6, 0
    v_mov_b32 v7, 0
    v_mul_f32 v8, v8, v226
    v_mul_f32 v9, v9, v226
    v_mul_f32 v10, v10, v226
    v_mul_f32 v11, v11, v226
    v_mul_f32 v12, v12, v226
    v_mul_f32 v13, v13, v226
    v_mul_f32 v14, v14, v226
    v_mul_f32 v15, v15, v226
    v_cvt_pk_bf16_f32 v252, v8, v9
    v_cvt_pk_bf16_f32 v253, v10, v11
    v_cvt_pk_bf16_f32 v254, v12, v13
    v_cvt_pk_bf16_f32 v255, v14, v15
    buffer_store_dwordx4 v[252:255], v235, s[64:67], s38 offen offset:1024 sc1
    v_mov_b32 v8, 0
    v_mov_b32 v9, 0
    v_mov_b32 v10, 0
    v_mov_b32 v11, 0
    v_mov_b32 v12, 0
    v_mov_b32 v13, 0
    v_mov_b32 v14, 0
    v_mov_b32 v15, 0
    v_mul_f32 v16, v16, v226
    v_mul_f32 v17, v17, v226
    v_mul_f32 v18, v18, v226
    v_mul_f32 v19, v19, v226
    v_mul_f32 v20, v20, v226
    v_mul_f32 v21, v21, v226
    v_mul_f32 v22, v22, v226
    v_mul_f32 v23, v23, v226
    v_cvt_pk_bf16_f32 v248, v16, v17
    v_cvt_pk_bf16_f32 v249, v18, v19
    v_cvt_pk_bf16_f32 v250, v20, v21
    v_cvt_pk_bf16_f32 v251, v22, v23
    buffer_store_dwordx4 v[248:251], v235, s[64:67], s38 offen offset:2048 sc1
    v_mov_b32 v16, 0
    v_mov_b32 v17, 0
    v_mov_b32 v18, 0
    v_mov_b32 v19, 0
    v_mov_b32 v20, 0
    v_mov_b32 v21, 0
    v_mov_b32 v22, 0
    v_mov_b32 v23, 0
    v_mul_f32 v24, v24, v226
    v_mul_f32 v25, v25, v226
    v_mul_f32 v26, v26, v226
    v_mul_f32 v27, v27, v226
    v_mul_f32 v28, v28, v226
    v_mul_f32 v29, v29, v226
    v_mul_f32 v30, v30, v226
    v_mul_f32 v31, v31, v226
    v_cvt_pk_bf16_f32 v252, v24, v25
    v_cvt_pk_bf16_f32 v253, v26, v27
    v_cvt_pk_bf16_f32 v254, v28, v29
    v_cvt_pk_bf16_f32 v255, v30, v31
    buffer_store_dwordx4 v[252:255], v235, s[64:67], s38 offen offset:3072 sc1
    v_mov_b32 v24, 0
    v_mov_b32 v25, 0
    v_mov_b32 v26, 0
    v_mov_b32 v27, 0
    v_mov_b32 v28, 0
    v_mov_b32 v29, 0
    v_mov_b32 v30, 0
    v_mov_b32 v31, 0
    v_mul_f32 v32, v32, v226
    v_mul_f32 v33, v33, v226
    v_mul_f32 v34, v34, v226
    v_mul_f32 v35, v35, v226
    v_mul_f32 v36, v36, v226
    v_mul_f32 v37, v37, v226
    v_mul_f32 v38, v38, v226
    v_mul_f32 v39, v39, v226
    v_cvt_pk_bf16_f32 v248, v32, v33
    v_cvt_pk_bf16_f32 v249, v34, v35
    v_cvt_pk_bf16_f32 v250, v36, v37
    v_cvt_pk_bf16_f32 v251, v38, v39
    s_mov_b32 s38, 4096
    buffer_store_dwordx4 v[248:251], v235, s[64:67], s38 offen offset:0 sc1
    v_mov_b32 v32, 0
    v_mov_b32 v33, 0
    v_mov_b32 v34, 0
    v_mov_b32 v35, 0
    v_mov_b32 v36, 0
    v_mov_b32 v37, 0
    v_mov_b32 v38, 0
    v_mov_b32 v39, 0
    v_mul_f32 v40, v40, v226
    v_mul_f32 v41, v41, v226
    v_mul_f32 v42, v42, v226
    v_mul_f32 v43, v43, v226
    v_mul_f32 v44, v44, v226
    v_mul_f32 v45, v45, v226
    v_mul_f32 v46, v46, v226
    v_mul_f32 v47, v47, v226
    v_cvt_pk_bf16_f32 v252, v40, v41
    v_cvt_pk_bf16_f32 v253, v42, v43
    v_cvt_pk_bf16_f32 v254, v44, v45
    v_cvt_pk_bf16_f32 v255, v46, v47
    buffer_store_dwordx4 v[252:255], v235, s[64:67], s38 offen offset:1024 sc1
    v_mov_b32 v40, 0
    v_mov_b32 v41, 0
    v_mov_b32 v42, 0
    v_mov_b32 v43, 0
    v_mov_b32 v44, 0
    v_mov_b32 v45, 0
    v_mov_b32 v46, 0
    v_mov_b32 v47, 0
    v_mul_f32 v48, v48, v226
    v_mul_f32 v49, v49, v226
    v_mul_f32 v50, v50, v226
    v_mul_f32 v51, v51, v226
    v_mul_f32 v52, v52, v226
    v_mul_f32 v53, v53, v226
    v_mul_f32 v54, v54, v226
    v_mul_f32 v55, v55, v226
    v_cvt_pk_bf16_f32 v248, v48, v49
    v_cvt_pk_bf16_f32 v249, v50, v51
    v_cvt_pk_bf16_f32 v250, v52, v53
    v_cvt_pk_bf16_f32 v251, v54, v55
    buffer_store_dwordx4 v[248:251], v235, s[64:67], s38 offen offset:2048 sc1
    v_mov_b32 v48, 0
    v_mov_b32 v49, 0
    v_mov_b32 v50, 0
    v_mov_b32 v51, 0
    v_mov_b32 v52, 0
    v_mov_b32 v53, 0
    v_mov_b32 v54, 0
    v_mov_b32 v55, 0
    v_mul_f32 v56, v56, v226
    v_mul_f32 v57, v57, v226
    v_mul_f32 v58, v58, v226
    v_mul_f32 v59, v59, v226
    v_mul_f32 v60, v60, v226
    v_mul_f32 v61, v61, v226
    v_mul_f32 v62, v62, v226
    v_mul_f32 v63, v63, v226
    v_cvt_pk_bf16_f32 v252, v56, v57
    v_cvt_pk_bf16_f32 v253, v58, v59
    v_cvt_pk_bf16_f32 v254, v60, v61
    v_cvt_pk_bf16_f32 v255, v62, v63
    buffer_store_dwordx4 v[252:255], v235, s[64:67], s38 offen offset:3072 sc1
    v_mov_b32 v56, 0
    v_mov_b32 v57, 0
    v_mov_b32 v58, 0
    v_mov_b32 v59, 0
    v_mov_b32 v60, 0
    v_mov_b32 v61, 0
    v_mov_b32 v62, 0
    v_mov_b32 v63, 0
    s_nop 1
    s_branch k2_trj
k2_tr0:
    ds_read_b128 v[200:203], v230 offset:6144
    s_waitcnt lgkmcnt(6)
    v_mfma_f32_32x32x16_bf16 v[0:15], v[176:179], v[112:115], v[0:15]
    s_add_u32 m0, s50, 8192
    s_add_u32 s37, s4, 8192
    buffer_load_dwordx4 v228, s[76:79], s37 offen lds
    s_add_u32 s5, s50, 65536
    s_add_u32 s50, s50, 16384
    s_and_b32 s50, s50, 65535
    s_add_u32 s4, s4, 32768
    v_exp_f32 v96, v80
    v_exp_f32 v97, v81
    ds_read_b128 v[204:207], v230 offset:7168
    s_waitcnt lgkmcnt(6)
    v_mfma_f32_32x32x16_bf16 v[0:15], v[180:183], v[116:119], v[0:15]
    v_exp_f32 v98, v82
    v_exp_f32 v99, v83
    s_add_u32 s51, s51, s39
    s_and_b32 s51, s51, 65535
    v_add_u32 v229, s51, v228
    ds_read_b128 v[176:179], v229 offset:0
    s_waitcnt lgkmcnt(6)
    v_mfma_f32_32x32x16_bf16 v[16:31], v[184:187], v[112:115], v[16:31]
    v_cvt_pk_bf16_f32 v120, v96, v97
    v_add_f32 v234, v96, v97
    v_exp_f32 v100, v84
    ds_read_b128 v[180:183], v229 offset:1024
    s_waitcnt lgkmcnt(6)
    v_mfma_f32_32x32x16_bf16 v[16:31], v[188:191], v[116:119], v[16:31]
    v_exp_f32 v101, v85
    ds_read_b128 v[184:187], v229 offset:2048
    s_waitcnt lgkmcnt(6)
    v_mfma_f32_32x32x16_bf16 v[32:47], v[192:195], v[112:115], v[32:47]
    v_cvt_pk_bf16_f32 v121, v98, v99
    v_add_f32 v98, v98, v99
    v_add_f32 v234, v234, v98
    v_exp_f32 v102, v86
    ds_read_b128 v[188:191], v229 offset:3072
    s_waitcnt lgkmcnt(6)
    v_mfma_f32_32x32x16_bf16 v[32:47], v[196:199], v[116:119], v[32:47]
    v_exp_f32 v103, v87
    ds_read_b128 v[192:195], v229 offset:4096
    s_waitcnt lgkmcnt(6)
    v_mfma_f32_32x32x16_bf16 v[48:63], v[200:203], v[112:115], v[48:63]
    v_cvt_pk_bf16_f32 v122, v100, v101
    v_add_f32 v100, v100, v101
    v_add_f32 v234, v234, v100
    v_exp_f32 v104, v88
    ds_read_b128 v[196:199], v229 offset:5120
    s_waitcnt lgkmcnt(6)
    v_mfma_f32_32x32x16_bf16 v[48:63], v[204:207], v[116:119], v[48:63]
    v_exp_f32 v105, v89
    ds_read_b128 v[200:203], v229 offset:6144
    s_waitcnt lgkmcnt(6)
    s_cmp_lt_u32 s45, s43
    s_cbranch_scc1 k2_mask10
    v_mfma_f32_32x32x16_bf16 v[64:79], v[176:179], v[128:131], v[160:175]
k2_mback10:
    v_cvt_pk_bf16_f32 v123, v102, v103
    v_add_f32 v102, v102, v103
    v_add_f32 v234, v234, v102
    v_exp_f32 v106, v90
    ds_read_b128 v[204:207], v229 offset:7168
    s_waitcnt lgkmcnt(6)
    v_mfma_f32_32x32x16_bf16 v[64:79], v[180:183], v[132:135], v[64:79]
    v_exp_f32 v107, v91
    ds_read_b128 v[176:179], v230 offset:8192
    s_waitcnt lgkmcnt(6)
    v_mfma_f32_32x32x16_bf16 v[64:79], v[184:187], v[136:139], v[64:79]
    v_cvt_pk_bf16_f32 v124, v104, v105
    v_add_f32 v104, v104, v105
    v_add_f32 v234, v234, v104
    v_exp_f32 v108, v92
    ds_read_b128 v[180:183], v230 offset:9216
    s_waitcnt lgkmcnt(6)
    v_mfma_f32_32x32x16_bf16 v[64:79], v[188:191], v[140:143], v[64:79]
    v_exp_f32 v109, v93
    ds_read_b128 v[184:187], v230 offset:10240
    s_waitcnt lgkmcnt(6)
    v_mfma_f32_32x32x16_bf16 v[64:79], v[192:195], v[144:147], v[64:79]
    s_waitcnt lgkmcnt(3)
    s_waitcnt vmcnt(4)
    s_barrier
    s_add_u32 m0, s5, 0
    s_sub_u32 s37, s4, 16384
    buffer_load_dwordx4 v228, s[76:79], s37 offen lds
    v_cvt_pk_bf16_f32 v125, v106, v107
    v_add_f32 v106, v106, v107
    v_add_f32 v234, v234, v106
    v_exp_f32 v110, v94
    ds_read_b128 v[188:191], v230 offset:11264
    v_mfma_f32_32x32x16_bf16 v[64:79], v[196:199], v[148:151], v[64:79]
    v_exp_f32 v111, v95
    ds_read_b128 v[192:195], v230 offset:12288
    v_mfma_f32_32x32x16_bf16 v[64:79], v[200:203], v[152:155], v[64:79]
    v_cvt_pk_bf16_f32 v126, v108, v109
    v_add_f32 v108, v108, v109
    v_add_f32 v234, v234, v108
    v_cvt_pk_bf16_f32 v127, v110, v111
    ds_read_b128 v[196:199], v230 offset:13312
    v_mfma_f32_32x32x16_bf16 v[64:79], v[204:207], v[156:159], v[64:79]
    v_add_f32 v110, v110, v111
    v_add_f32 v234, v234, v110
    v_cmp_lt_f32 vcc, s49, v234
    s_cbranch_vccnz k2_slow11
k2_sback11:
    v_add_f32 v233, v233, v234
    ds_read_b128 v[200:203], v230 offset:14336
    s_waitcnt lgkmcnt(6)
    v_mfma_f32_32x32x16_bf16 v[0:15], v[176:179], v[120:123], v[0:15]
    s_add_u32 m0, s46, 0
    s_nop 0
    buffer_load_dwordx4 v228, s[76:79], s58 offen offset:0 lds
    s_nop 0
    v_exp_f32 v96, v64
    v_exp_f32 v97, v65
    ds_read_b128 v[204:207], v230 offset:15360
    s_waitcnt lgkmcnt(6)
    v_mfma_f32_32x32x16_bf16 v[0:15], v[180:183], v[124:127], v[0:15]
    v_exp_f32 v98, v66
    v_exp_f32 v99, v67
    ds_read_b128 v[176:179], v229 offset:8192
    s_waitcnt lgkmcnt(6)
    v_mfma_f32_32x32x16_bf16 v[16:31], v[184:187], v[120:123], v[16:31]
    v_cvt_pk_bf16_f32 v112, v96, v97
    v_add_f32 v234, v96, v97
    v_exp_f32 v100, v68
    ds_read_b128 v[180:183], v229 offset:9216
    s_waitcnt lgkmcnt(6)
    v_mfma_f32_32x32x16_bf16 v[16:31], v[188:191], v[124:127], v[16:31]
    v_exp_f32 v101, v69
    ds_read_b128 v[184:187], v229 offset:10240
    s_waitcnt lgkmcnt(6)
    v_mfma_f32_32x32x16_bf16 v[32:47], v[192:195], v[120:123], v[32:47]
    buffer_load_dwordx4 v228, s[76:79], s58 offen offset:1024 lds
    v_cvt_pk_bf16_f32 v113, v98, v99
    v_add_f32 v98, v98, v99
    v_add_f32 v234, v234, v98
    v_exp_f32 v102, v70
    ds_read_b128 v[188:191], v229 offset:11264
    s_waitcnt lgkmcnt(6)
    v_mfma_f32_32x32x16_bf16 v[32:47], v[196:199], v[124:127], v[32:47]
    v_exp_f32 v103, v71
    ds_read_b128 v[192:195], v229 offset:12288
    s_waitcnt lgkmcnt(6)
    v_mfma_f32_32x32x16_bf16 v[48:63], v[200:203], v[120:123], v[48:63]
    v_cvt_pk_bf16_f32 v114, v100, v101
    v_add_f32 v100, v100, v101
    v_add_f32 v234, v234, v100
    v_exp_f32 v104, v72
    ds_read_b128 v[196:199], v229 offset:13312
    s_waitcnt lgkmcnt(6)
    v_mfma_f32_32x32x16_bf16 v[48:63], v[204:207], v[124:127], v[48:63]
    v_exp_f32 v105, v73
    ds_read_b128 v[200:203], v229 offset:14336
    s_waitcnt lgkmcnt(6)
    s_cmp_lt_u32 s45, s43
    s_cbranch_scc1 k2_mask12
    v_mfma_f32_32x32x16_bf16 v[80:95], v[176:179], v[128:131], v[160:175]
k2_mback12:
    v_cvt_pk_bf16_f32 v115, v102, v103
    v_add_f32 v102, v102, v103
    v_add_f32 v234, v234, v102
    v_exp_f32 v106, v74
    ds_read_b128 v[204:207], v229 offset:15360
    s_waitcnt lgkmcnt(6)
    v_mfma_f32_32x32x16_bf16 v[80:95], v[180:183], v[132:135], v[80:95]
    v_exp_f32 v107, v75
    s_add_u32 s53, s53, s39
    s_and_b32 s53, s53, 65535
    v_add_u32 v230, s53, v239
    ds_read_b128 v[176:179], v230 offset:0
    s_waitcnt lgkmcnt(6)
    v_mfma_f32_32x32x16_bf16 v[80:95], v[184:187], v[136:139], v[80:95]
    v_cvt_pk_bf16_f32 v116, v104, v105
    v_add_f32 v104, v104, v105
    v_add_f32 v234, v234, v104
    v_exp_f32 v108, v76
    ds_read_b128 v[180:183], v230 offset:1024
    s_waitcnt lgkmcnt(6)
    v_mfma_f32_32x32x16_bf16 v[80:95], v[188:191], v[140:143], v[80:95]
    v_exp_f32 v109, v77
    ds_read_b128 v[184:187], v230 offset:2048
    s_waitcnt lgkmcnt(6)
    v_mfma_f32_32x32x16_bf16 v[80:95], v[192:195], v[144:147], v[80:95]
    s_waitcnt lgkmcnt(3)
    s_waitcnt vmcnt(4)
    s_barrier
    s_add_u32 m0, s5, 8192
    s_sub_u32 s37, s4, 8192
    buffer_load_dwordx4 v228, s[76:79], s37 offen lds
    v_cvt_pk_bf16_f32 v117, v106, v107
    v_add_f32 v106, v106, v107
    v_add_f32 v234, v234, v106
    v_exp_f32 v110, v78
    ds_read_b128 v[188:191], v230 offset:3072
    v_mfma_f32_32x32x16_bf16 v[80:95], v[196:199], v[148:151], v[80:95]
    v_exp_f32 v111, v79
    ds_read_b128 v[192:195], v230 offset:4096
    v_mfma_f32_32x32x16_bf16 v[80:95], v[200:203], v[152:155], v[80:95]
    v_cvt_pk_bf16_f32 v118, v108, v109
    v_add_f32 v108, v108, v109
    v_add_f32 v234, v234, v108
    v_cvt_pk_bf16_f32 v119, v110, v111
    ds_read_b128 v[196:199], v230 offset:5120
    v_mfma_f32_32x32x16_bf16 v[80:95], v[204:207], v[156:159], v[80:95]
    v_add_f32 v110, v110, v111
    v_add_f32 v234, v234, v110
    v_cmp_lt_f32 vcc, s49, v234
    s_cbranch_vccnz k2_slow13
k2_sback13:
    v_add_f32 v233, v233, v234
k2_trj:
    s_and_b32 s7, s2, 7
    s_lshl_b32 s7, s7, 12
    s_add_u32 s7, s7, 16384
    s_cmp_lg_u32 s34, 0
    s_cbranch_scc1 k2_w11
    buffer_load_dword v252, v228, s[84:87], s7 offen offset:0 sc1
    buffer_load_dword v253, v228, s[84:87], s7 offen offset:1024 sc1
    buffer_load_dword v254, v228, s[84:87], s7 offen offset:2048 sc1
    buffer_load_dword v255, v228, s[84:87], s7 offen offset:3072 sc1
k2_w11:
    s_cmp_eq_u32 s45, 0
    s_cbranch_scc1 k2_tail
k2_loop2:
    s_sub_u32 s45, s45, 1
    ds_read_b128 v[200:203], v230 offset:6144
    s_waitcnt lgkmcnt(6)
    v_mfma_f32_32x32x16_bf16 v[0:15], v[176:179], v[112:115], v[0:15]
    s_add_u32 m0, s46, 8192
    s_add_u32 s58, s58, 8192
    buffer_load_dwordx4 v228, s[76:79], s58 offen offset:0 lds
    s_nop 1
    v_exp_f32 v96, v80
    v_exp_f32 v97, v81
    ds_read_b128 v[204:207], v230 offset:7168
    s_waitcnt lgkmcnt(6)
    v_mfma_f32_32x32x16_bf16 v[0:15], v[180:183], v[116:119], v[0:15]
    v_exp_f32 v98, v82
    v_exp_f32 v99, v83
    s_add_u32 s51, s51, 32768
    s_and_b32 s51, s51, 65535
    v_add_u32 v229, s51, v228
    ds_read_b128 v[176:179], v229 offset:0
    s_waitcnt lgkmcnt(6)
    v_mfma_f32_32x32x16_bf16 v[16:31], v[184:187], v[112:115], v[16:31]
    v_cvt_pk_bf16_f32 v120, v96, v97
    v_add_f32 v234, v96, v97
    v_exp_f32 v100, v84
    ds_read_b128 v[180:183], v229 offset:1024
    s_waitcnt lgkmcnt(6)
    v_mfma_f32_32x32x16_bf16 v[16:31], v[188:191], v[116:119], v[16:31]
    v_exp_f32 v101, v85
    ds_read_b128 v[184:187], v229 offset:2048
    s_waitcnt lgkmcnt(6)
    v_mfma_f32_32x32x16_bf16 v[32:47], v[192:195], v[112:115], v[32:47]
    buffer_load_dwordx4 v228, s[76:79], s58 offen offset:1024 lds
    s_xor_b32 s47, s47, 32768
    s_xor_b32 s46, s46, 32768
    s_add_u32 s44, s44, 1
    v_cvt_pk_bf16_f32 v121, v98, v99
    v_add_f32 v98, v98, v99
    v_add_f32 v234, v234, v98
    v_exp_f32 v102, v86
    ds_read_b128 v[188:191], v229 offset:3072
    s_waitcnt lgkmcnt(6)
    v_mfma_f32_32x32x16_bf16 v[32:47], v[196:199], v[116:119], v[32:47]
    v_exp_f32 v103, v87
    ds_read_b128 v[192:195], v229 offset:4096
    s_waitcnt lgkmcnt(6)
    v_mfma_f32_32x32x16_bf16 v[48:63], v[200:203], v[112:115], v[48:63]
    v_cvt_pk_bf16_f32 v122, v100, v101
    v_add_f32 v100, v100, v101
    v_add_f32 v234, v234, v100
    v_exp_f32 v104, v88
    ds_read_b128 v[196:199], v229 offset:5120
    s_waitcnt lgkmcnt(6)
    v_mfma_f32_32x32x16_bf16 v[48:63], v[204:207], v[116:119], v[48:63]
    v_exp_f32 v105, v89
    ds_read_b128 v[200:203], v229 offset:6144
    s_waitcnt lgkmcnt(6)
    s_cmp_lt_u32 s45, s43
    s_cbranch_scc1 k2_mask14
    v_mfma_f32_32x32x16_bf16 v[64:79], v[176:179], v[128:131], v[160:175]
k2_mback14:
    v_cvt_pk_bf16_f32 v123, v102, v103
    v_add_f32 v102, v102, v103
    v_add_f32 v234, v234, v102
    v_exp_f32 v106, v90
    ds_read_b128 v[204:207], v229 offset:7168
    s_waitcnt lgkmcnt(6)
    v_mfma_f32_32x32x16_bf16 v[64:79], v[180:183], v[132:135], v[64:79]
    v_exp_f32 v107, v91
    ds_read_b128 v[176:179], v230 offset:8192
    s_waitcnt lgkmcnt(6)
    v_mfma_f32_32x32x16_bf16 v[64:79], v[184:187], v[136:139], v[64:79]
    v_cvt_pk_bf16_f32 v124, v104, v105
    v_add_f32 v104, v104, v105
    v_add_f32 v234, v234, v104
    v_exp_f32 v108, v92
    ds_read_b128 v[180:183], v230 offset:9216
    s_waitcnt lgkmcnt(6)
    v_mfma_f32_32x32x16_bf16 v[64:79], v[188:191], v[140:143], v[64:79]
    v_exp_f32 v109, v93
    ds_read_b128 v[184:187], v230 offset:10240
    s_waitcnt lgkmcnt(6)
    v_mfma_f32_32x32x16_bf16 v[64:79], v[192:195], v[144:147], v[64:79]
    s_waitcnt lgkmcnt(3)
    s_waitcnt vmcnt(4)
    s_barrier
    s_add_u32 s59, s58, 8192
    s_add_u32 m0, s47, 0
    s_nop 0
    buffer_load_dwordx4 v228, s[76:79], s59 offen offset:0 lds
    v_cvt_pk_bf16_f32 v125, v106, v107
    v_add_f32 v106, v106, v107
    v_add_f32 v234, v234, v106
    v_exp_f32 v110, v94
    ds_read_b128 v[188:191], v230 offset:11264
    v_mfma_f32_32x32x16_bf16 v[64:79], v[196:199], v[148:151], v[64:79]
    v_exp_f32 v111, v95
    ds_read_b128 v[192:195], v230 offset:12288
    v_mfma_f32_32x32x16_bf16 v[64:79], v[200:203], v[152:155], v[64:79]
    v_cvt_pk_bf16_f32 v126, v108, v109
    v_add_f32 v108, v108, v109
    v_add_f32 v234, v234, v108
    v_cvt_pk_bf16_f32 v127, v110, v111
    ds_read_b128 v[196:199], v230 offset:13312
    v_mfma_f32_32x32x16_bf16 v[64:79], v[204:207], v[156:159], v[64:79]
    v_add_f32 v110, v110, v111
    v_add_f32 v234, v234, v110
    v_cmp_lt_f32 vcc, s49, v234
    s_cbranch_vccnz k2_slow15
k2_sback15:
    v_add_f32 v233, v233, v234
    ds_read_b128 v[200:203], v230 offset:14336
    s_waitcnt lgkmcnt(6)
    v_mfma_f32_32x32x16_bf16 v[0:15], v[176:179], v[120:123], v[0:15]
    buffer_load_dwordx4 v228, s[76:79], s59 offen offset:1024 lds
    s_min_u32 s37, s44, 15
    s_lshl_b32 s37, s37, 16
    s_add_u32 s58, s37, s48
    v_exp_f32 v96, v64
    v_exp_f32 v97, v65
    ds_read_b128 v[204:207], v230 offset:15360
    s_waitcnt lgkmcnt(6)
    v_mfma_f32_32x32x16_bf16 v[0:15], v[180:183], v[124:127], v[0:15]
    v_exp_f32 v98, v66
    v_exp_f32 v99, v67
    ds_read_b128 v[176:179], v229 offset:8192
    s_waitcnt lgkmcnt(6)
    v_mfma_f32_32x32x16_bf16 v[16:31], v[184:187], v[120:123], v[16:31]
    v_cvt_pk_bf16_f32 v112, v96, v97
    v_add_f32 v234, v96, v97
    v_exp_f32 v100, v68
    ds_read_b128 v[180:183], v229 offset:9216
    s_waitcnt lgkmcnt(6)
    v_mfma_f32_32x32x16_bf16 v[16:31], v[188:191], v[124:127], v[16:31]
    v_exp_f32 v101, v69
    ds_read_b128 v[184:187], v229 offset:10240
    s_waitcnt lgkmcnt(6)
    v_mfma_f32_32x32x16_bf16 v[32:47], v[192:195], v[120:123], v[32:47]
    s_add_u32 m0, s46, 0
    s_nop 0
    buffer_load_dwordx4 v228, s[76:79], s58 offen offset:0 lds
    v_cvt_pk_bf16_f32 v113, v98, v99
    v_add_f32 v98, v98, v99
    v_add_f32 v234, v234, v98
    v_exp_f32 v102, v70
    ds_read_b128 v[188:191], v229 offset:11264
    s_waitcnt lgkmcnt(6)
    v_mfma_f32_32x32x16_bf16 v[32:47], v[196:199], v[124:127], v[32:47]
    v_exp_f32 v103, v71
    ds_read_b128 v[192:195], v229 offset:12288
    s_waitcnt lgkmcnt(6)
    v_mfma_f32_32x32x16_bf16 v[48:63], v[200:203], v[120:123], v[48:63]
    v_cvt_pk_bf16_f32 v114, v100, v101
    v_add_f32 v100, v100, v101
    v_add_f32 v234, v234, v100
    v_exp_f32 v104, v72
    ds_read_b128 v[196:199], v229 offset:13312
    s_waitcnt lgkmcnt(6)
    v_mfma_f32_32x32x16_bf16 v[48:63], v[204:207], v[124:127], v[48:63]
    v_exp_f32 v105, v73
    ds_read_b128 v[200:203], v229 offset:14336
    s_waitcnt lgkmcnt(6)
    s_cmp_lt_u32 s45, s43
    s_cbranch_scc1 k2_mask16
    v_mfma_f32_32x32x16_bf16 v[80:95], v[176:179], v[128:131], v[160:175]
k2_mback16:
    buffer_load_dwordx4 v228, s[76:79], s58 offen offset:1024 lds
    v_cvt_pk_bf16_f32 v115, v102, v103
    v_add_f32 v102, v102, v103
    v_add_f32 v234, v234, v102
    v_exp_f32 v106, v74
    ds_read_b128 v[204:207], v229 offset:15360
    s_waitcnt lgkmcnt(6)
    v_mfma_f32_32x32x16_bf16 v[80:95], v[180:183], v[132:135], v[80:95]
    v_exp_f32 v107, v75
    s_add_u32 s53, s53, 32768
    s_and_b32 s53, s53, 65535
    v_add_u32 v230, s53, v239
    ds_read_b128 v[176:179], v230 offset:0
    s_waitcnt lgkmcnt(6)
    v_mfma_f32_32x32x16_bf16 v[80:95], v[184:187], v[136:139], v[80:95]
    v_cvt_pk_bf16_f32 v116, v104, v105
    v_add_f32 v104, v104, v105
    v_add_f32 v234, v234, v104
    v_exp_f32 v108, v76
    ds_read_b128 v[180:183], v230 offset:1024
    s_waitcnt lgkmcnt(6)
    v_mfma_f32_32x32x16_bf16 v[80:95], v[188:191], v[140:143], v[80:95]
    v_exp_f32 v109, v77
    ds_read_b128 v[184:187], v230 offset:2048
    s_waitcnt lgkmcnt(6)
    v_mfma_f32_32x32x16_bf16 v[80:95], v[192:195], v[144:147], v[80:95]
    s_waitcnt lgkmcnt(3)
    s_waitcnt vmcnt(4)
    s_barrier
    s_add_u32 m0, s47, 8192
    s_add_u32 s59, s59, 8192
    buffer_load_dwordx4 v228, s[76:79], s59 offen offset:0 lds
    v_cvt_pk_bf16_f32 v117, v106, v107
    v_add_f32 v106, v106, v107
    v_add_f32 v234, v234, v106
    v_exp_f32 v110, v78
    ds_read_b128 v[188:191], v230 offset:3072
    v_mfma_f32_32x32x16_bf16 v[80:95], v[196:199], v[148:151], v[80:95]
    v_exp_f32 v111, v79
    ds_read_b128 v[192:195], v230 offset:4096
    v_mfma_f32_32x32x16_bf16 v[80:95], v[200:203], v[152:155], v[80:95]
    buffer_load_dwordx4 v228, s[76:79], s59 offen offset:1024 lds
    v_cvt_pk_bf16_f32 v118, v108, v109
    v_add_f32 v108, v108, v109
    v_add_f32 v234, v234, v108
    v_cvt_pk_bf16_f32 v119, v110, v111
    ds_read_b128 v[196:199], v230 offset:5120
    v_mfma_f32_32x32x16_bf16 v[80:95], v[204:207], v[156:159], v[80:95]
    v_add_f32 v110, v110, v111
    v_add_f32 v234, v234, v110
    v_cmp_lt_f32 vcc, s49, v234
    s_cbranch_vccnz k2_slow17
k2_sback17:
    v_add_f32 v233, v233, v234
    s_cmp_lg_u32 s6, s45
    s_cbranch_scc1 k2_w12
    v_lshlrev_b32 v249, 9, v224
    v_mov_b32 v250, 1
    s_mov_b64 exec, 15
    buffer_store_dword v250, v249, s[84:87], s3 offen offset:4 sc1
    s_mov_b64 exec, -1
k2_w12:
    s_cmp_lg_u32 s45, 0
    s_cbranch_scc1 k2_loop2
k2_tail:
    ds_read_b128 v[200:203], v230 offset:6144
    s_waitcnt lgkmcnt(6)
    v_mfma_f32_32x32x16_bf16 v[0:15], v[176:179], v[112:115], v[0:15]
    s_nop 5
    v_exp_f32 v96, v80
    v_exp_f32 v97, v81
    v_exp_f32 v98, v82
    v_exp_f32 v99, v83
    ds_read_b128 v[204:207], v230 offset:7168
    s_waitcnt lgkmcnt(6)
    v_mfma_f32_32x32x16_bf16 v[0:15], v[180:183], v[116:119], v[0:15]
    v_cvt_pk_bf16_f32 v120, v96, v97
    v_add_f32 v234, v96, v97
    v_exp_f32 v100, v84
    v_exp_f32 v101, v85
    ds_read_b128 v[176:179], v230 offset:8192
    s_waitcnt lgkmcnt(6)
    v_mfma_f32_32x32x16_bf16 v[16:31], v[184:187], v[112:115], v[16:31]
    v_cvt_pk_bf16_f32 v121, v98, v99
    v_add_f32 v98, v98, v99
    v_add_f32 v234, v234, v98
    v_exp_f32 v102, v86
    v_exp_f32 v103, v87
    ds_read_b128 v[180:183], v230 offset:9216
    s_waitcnt lgkmcnt(6)
    v_mfma_f32_32x32x16_bf16 v[16:31], v[188:191], v[116:119], v[16:31]
    v_cvt_pk_bf16_f32 v122, v100, v101
    v_add_f32 v100, v100, v101
    v_add_f32 v234, v234, v100
    v_exp_f32 v104, v88
    v_exp_f32 v105, v89
    ds_read_b128 v[184:187], v230 offset:10240
    s_waitcnt lgkmcnt(6)
    v_mfma_f32_32x32x16_bf16 v[32:47], v[192:195], v[112:115], v[32:47]
    v_cvt_pk_bf16_f32 v123, v102, v103
    v_add_f32 v102, v102, v103
    v_add_f32 v234, v234, v102
    v_exp_f32 v106, v90
    v_exp_f32 v107, v91
    ds_read_b128 v[188:191], v230 offset:11264
    s_waitcnt lgkmcnt(6)
    v_mfma_f32_32x32x16_bf16 v[32:47], v[196:199], v[116:119], v[32:47]
    v_cvt_pk_bf16_f32 v124, v104, v105
    v_add_f32 v104, v104, v105
    v_add_f32 v234, v234, v104
    v_exp_f32 v108, v92
    v_exp_f32 v109, v93
    ds_read_b128 v[192:195], v230 offset:12288
    s_waitcnt lgkmcnt(6)
    v_mfma_f32_32x32x16_bf16 v[48:63], v[200:203], v[112:115], v[48:63]
    v_cvt_pk_bf16_f32 v125, v106, v107
    v_add_f32 v106, v106, v107
    v_add_f32 v234, v234, v106
    v_exp_f32 v110, v94
    v_exp_f32 v111, v95
    ds_read_b128 v[196:199], v230 offset:13312
    s_waitcnt lgkmcnt(6)
    v_mfma_f32_32x32x16_bf16 v[48:63], v[204:207], v[116:119], v[48:63]
    v_cvt_pk_bf16_f32 v126, v108, v109
    v_add_f32 v108, v108, v109
    v_add_f32 v234, v234, v108
    v_cvt_pk_bf16_f32 v127, v110, v111
    v_add_f32 v110, v110, v111
    v_add_f32 v234, v234, v110
    v_cmp_lt_f32 vcc, s49, v234
    s_cbranch_vccnz k2_slow18
k2_sback18:
    v_add_f32 v233, v233, v234
    ds_read_b128 v[200:203], v230 offset:14336
    s_waitcnt lgkmcnt(6)
    v_mfma_f32_32x32x16_bf16 v[0:15], v[176:179], v[120:123], v[0:15]
    ds_read_b128 v[204:207], v230 offset:15360
    s_waitcnt lgkmcnt(6)
    v_mfma_f32_32x32x16_bf16 v[0:15], v[180:183], v[124:127], v[0:15]
    s_waitcnt lgkmcnt(5)
    v_mfma_f32_32x32x16_bf16 v[16:31], v[184:187], v[120:123], v[16:31]
    s_waitcnt lgkmcnt(4)
    v_mfma_f32_32x32x16_bf16 v[16:31], v[188:191], v[124:127], v[16:31]
    s_waitcnt lgkmcnt(3)
    v_mfma_f32_32x32x16_bf16 v[32:47], v[192:195], v[120:123], v[32:47]
    s_waitcnt lgkmcnt(2)
    v_mfma_f32_32x32x16_bf16 v[32:47], v[196:199], v[124:127], v[32:47]
    s_waitcnt lgkmcnt(1)
    v_mfma_f32_32x32x16_bf16 v[48:63], v[200:203], v[120:123], v[48:63]
    s_waitcnt lgkmcnt(0)
    v_mfma_f32_32x32x16_bf16 v[48:63], v[204:207], v[124:127], v[48:63]
    s_lshl_b32 s37, s42, 13
    s_add_u32 s38, s37, 131072
    s_and_b32 s53, s53, 32768
    s_add_u32 s37, s37, s53
    s_add_u32 s37, s37, 65536
    s_cmp_eq_u32 s41, 0
    s_cselect_b32 s54, s37, s38
    s_cselect_b32 s55, s38, s37
    v_mov_b32 v236, v233
    s_nop 1
    v_permlane32_swap_b32 v236, v233
    v_add_f32 v233, v233, v236
    v_cmp_gt_u32 vcc, 32, v224
    s_nop 1
    v_cndmask_b32 v236, v233, v160
    v_lshlrev_b32 v240, 2, v224
    v_add_u32 v241, s55, v240
    v_and_b32 v240, 127, v240
    v_add_u32 v242, s54, v240
    s_waitcnt vmcnt(0)
    s_cmp_lg_u32 s34, 0
    s_cbranch_scc1 k2_w13
    s_mov_b32 s56, 131072
k2_pspin:
    v_and_b32 v252, v252, v253
    v_and_b32 v254, v254, v255
    v_and_b32 v252, v252, v254
    v_cmp_ne_u32 vcc, 1, v252
    s_nop 4
    s_cbranch_vccz k2_pok
    s_sub_u32 s56, s56, 1
    s_cbranch_scc1 k2_pok
    s_sleep 4
    buffer_load_dword v252, v228, s[84:87], s7 offen offset:0 sc1
    buffer_load_dword v253, v228, s[84:87], s7 offen offset:1024 sc1
    buffer_load_dword v254, v228, s[84:87], s7 offen offset:2048 sc1
    buffer_load_dword v255, v228, s[84:87], s7 offen offset:3072 sc1
    s_waitcnt vmcnt(0)
    s_branch k2_pspin
k2_pok:
k2_w13:
    s_barrier
    ds_write_b32 v241, v236
    s_and_b32 s38, s2, 7
    s_lshl_b32 s44, s38, 1
    s_bfe_u32 s37, s2, 0x10006
    s_add_u32 s44, s44, s37
    s_lshr_b32 s37, s2, 7
    s_lshl_b32 s37, s37, 4
    s_add_u32 s44, s44, s37
    s_bfe_u32 s45, s2, 0x30003
    s_lshl_b32 s49, s38, 15
    s_min_u32 s50, s38, 6
    s_lshl_b32 s50, s50, 14
    v_lshrrev_b32 v244, 4, v224
    v_and_b32 v245, 15, v224
    v_lshlrev_b32 v225, 4, v245
    v_lshl_add_u32 v225, v244, 9, v225
    s_lshl_b32 s37, s34, 11
    s_lshl_b32 s46, s44, 19
    s_add_u32 s46, s46, s37
    s_mul_i32 s47, s44, 229376
    s_add_u32 s47, s47, s37
    s_mul_i32 s48, s45, 753664
    s_lshl_b32 s37, s34, 12
    s_add_u32 s48, s48, s37
    s_add_u32 s48, s48, 524288
    s_add_u32 s76, s47, s50
    s_add_u32 s77, s76, 0x1c000
    s_lshl_b32 s78, s50, 1
    s_add_u32 s78, s78, s48
    s_add_u32 s50, s50, 16384
    s_cmp_eq_u32 s50, 114688
    s_cselect_b32 s50, 0, s50
    buffer_load_dwordx4 v[96:99], v225, s[80:83], s76 offen offset:0
    buffer_load_dwordx4 v[100:103], v225, s[80:83], s76 offen offset:256
    buffer_load_dwordx4 v[104:107], v225, s[80:83], s77 offen offset:0
    buffer_load_dwordx4 v[108:111], v225, s[80:83], s77 offen offset:256
    buffer_load_dwordx4 v[112:115], v225, s[68:71], s78 offen offset:0
    buffer_load_dwordx4 v[116:119], v225, s[68:71], s78 offen offset:256
    buffer_load_dwordx4 v[120:123], v225, s[68:71], s78 offen offset:2048
    buffer_load_dwordx4 v[124:127], v225, s[68:71], s78 offen offset:2304
    s_add_u32 s56, s47, s50
    s_add_u32 s57, s56, 0x1c000
    s_lshl_b32 s58, s50, 1
    s_add_u32 s58, s58, s48
    s_add_u32 s50, s50, 16384
    s_cmp_eq_u32 s50, 114688
    s_cselect_b32 s50, 0, s50
    buffer_load_dwordx4 v[128:131], v225, s[80:83], s56 offen offset:0
    buffer_load_dwordx4 v[132:135], v225, s[80:83], s56 offen offset:256
    buffer_load_dwordx4 v[136:139], v225, s[80:83], s57 offen offset:0
    buffer_load_dwordx4 v[140:143], v225, s[80:83], s57 offen offset:256
    buffer_load_dwordx4 v[144:147], v225, s[68:71], s58 offen offset:0
    buffer_load_dwordx4 v[148:151], v225, s[68:71], s58 offen offset:256
    buffer_load_dwordx4 v[152:155], v225, s[68:71], s58 offen offset:2048
    buffer_load_dwordx4 v[156:159], v225, s[68:71], s58 offen offset:2304
    s_add_u32 s76, s47, s50
    s_add_u32 s77, s76, 0x1c000
    s_lshl_b32 s78, s50, 1
    s_add_u32 s78, s78, s48
    s_add_u32 s50, s50, 16384
    s_cmp_eq_u32 s50, 114688
    s_cselect_b32 s50, 0, s50
    buffer_load_dwordx4 v[192:195], v225, s[80:83], s76 offen offset:0
    buffer_load_dwordx4 v[196:199], v225, s[80:83], s76 offen offset:256
    buffer_load_dwordx4 v[200:203], v225, s[80:83], s77 offen offset:0
    buffer_load_dwordx4 v[204:207], v225, s[80:83], s77 offen offset:256
    buffer_load_dwordx4 v[208:211], v225, s[68:71], s78 offen offset:0
    buffer_load_dwordx4 v[212:215], v225, s[68:71], s78 offen offset:256
    buffer_load_dwordx4 v[216:219], v225, s[68:71], s78 offen offset:2048
    buffer_load_dwordx4 v[220:223], v225, s[68:71], s78 offen offset:2304
    s_waitcnt lgkmcnt(0)
    s_barrier
    ds_read_b32 v243, v242
    ds_read_b32 v244, v242 offset:128
    v_add_u32 v241, s54, v228
    v_add_u32 v242, s55, v228
    s_lshl_b32 s37, s52, 18
    s_lshl_b32 s38, s35, 13
    s_add_u32 s37, s37, s38
    s_lshl_b32 s38, s41, 12
    s_add_u32 s37, s37, s38
    v_add_u32 v235, s37, v228
    s_waitcnt lgkmcnt(0)
    s_cmp_eq_u32 s41, 0
    s_cbranch_scc1 k2_m0
    ds_write_b128 v241, v[0:3] offset:0
    ds_write_b128 v241, v[4:7] offset:1024
    ds_write_b128 v241, v[8:11] offset:2048
    ds_write_b128 v241, v[12:15] offset:3072
    ds_write_b128 v241, v[16:19] offset:4096
    ds_write_b128 v241, v[20:23] offset:5120
    ds_write_b128 v241, v[24:27] offset:6144
    ds_write_b128 v241, v[28:31] offset:7168
    v_min_f32 v245, v243, v160
    v_sub_f32 v246, v245, v160
    v_exp_f32 v246, v246
    v_sub_f32 v247, v245, v243
    v_exp_f32 v247, v247
    v_mul_f32 v245, v233, v246
    v_fmac_f32 v245, v244, v247
    v_rcp_f32 v245, v245
    s_nop 0
    v_mul_f32 v246, v246, v245
    v_mul_f32 v247, v247, v245
    s_waitcnt lgkmcnt(0)
    s_barrier
    ds_read_b128 v[64:67], v242 offset:0
    ds_read_b128 v[68:71], v242 offset:1024
    ds_read_b128 v[72:75], v242 offset:2048
    ds_read_b128 v[76:79], v242 offset:3072
    ds_read_b128 v[80:83], v242 offset:4096
    ds_read_b128 v[84:87], v242 offset:5120
    ds_read_b128 v[88:91], v242 offset:6144
    ds_read_b128 v[92:95], v242 offset:7168
    v_mul_f32 v32, v32, v246
    v_mul_f32 v33, v33, v246
    v_mul_f32 v34, v34, v246
    v_mul_f32 v35, v35, v246
    v_mul_f32 v36, v36, v246
    v_mul_f32 v37, v37, v246
    v_mul_f32 v38, v38, v246
    v_mul_f32 v39, v39, v246
    v_mul_f32 v40, v40, v246
    v_mul_f32 v41, v41, v246
    v_mul_f32 v42, v42, v246
    v_mul_f32 v43, v43, v246
    v_mul_f32 v44, v44, v246
    v_mul_f32 v45, v45, v246
    v_mul_f32 v46, v46, v246
    v_mul_f32 v47, v47, v246
    v_mul_f32 v48, v48, v246
    v_mul_f32 v49, v49, v246
    v_mul_f32 v50, v50, v246
    v_mul_f32 v51, v51, v246
    v_mul_f32 v52, v52, v246
    v_mul_f32 v53, v53, v246
    v_mul_f32 v54, v54, v246
    v_mul_f32 v55, v55, v246
    v_mul_f32 v56, v56, v246
    v_mul_f32 v57, v57, v246
    v_mul_f32 v58, v58, v246
    v_mul_f32 v59, v59, v246
    v_mul_f32 v60, v60, v246
    v_mul_f32 v61, v61, v246
    v_mul_f32 v62, v62, v246
    v_mul_f32 v63, v63, v246
    s_waitcnt lgkmcnt(7)
    v_fmac_f32 v32, v64, v247
    v_fmac_f32 v33, v65, v247
    v_fmac_f32 v34, v66, v247
    v_fmac_f32 v35, v67, v247
    s_waitcnt lgkmcnt(6)
    v_fmac_f32 v36, v68, v247
    v_fmac_f32 v37, v69, v247
    v_fmac_f32 v38, v70, v247
    v_fmac_f32 v39, v71, v247
    s_waitcnt lgkmcnt(5)
    v_fmac_f32 v40, v72, v247
    v_fmac_f32 v41, v73, v247
    v_fmac_f32 v42, v74, v247
    v_fmac_f32 v43, v75, v247
    s_waitcnt lgkmcnt(4)
    v_fmac_f32 v44, v76, v247
    v_fmac_f32 v45, v77, v247
    v_fmac_f32 v46, v78, v247
    v_fmac_f32 v47, v79, v247
    s_waitcnt lgkmcnt(3)
    v_fmac_f32 v48, v80, v247
    v_fmac_f32 v49, v81, v247
    v_fmac_f32 v50, v82, v247
    v_fmac_f32 v51, v83, v247
    s_waitcnt lgkmcnt(2)
    v_fmac_f32 v52, v84, v247
    v_fmac_f32 v53, v85, v247
    v_fmac_f32 v54, v86, v247
    v_fmac_f32 v55, v87, v247
    s_waitcnt lgkmcnt(1)
    v_fmac_f32 v56, v88, v247
    v_fmac_f32 v57, v89, v247
    v_fmac_f32 v58, v90, v247
    v_fmac_f32 v59, v91, v247
    s_waitcnt lgkmcnt(0)
    v_fmac_f32 v60, v92, v247
    v_fmac_f32 v61, v93, v247
    v_fmac_f32 v62, v94, v247
    v_fmac_f32 v63, v95, v247
    v_cvt_pk_bf16_f32 v248, v32, v33
    v_cvt_pk_bf16_f32 v249, v34, v35
    v_cvt_pk_bf16_f32 v250, v36, v37
    v_cvt_pk_bf16_f32 v251, v38, v39
    s_mov_b32 s38, 0x0
    buffer_store_dwordx4 v[248:251], v235, s[64:67], s38 offen offset:0 sc1
    v_cvt_pk_bf16_f32 v252, v40, v41
    v_cvt_pk_bf16_f32 v253, v42, v43
    v_cvt_pk_bf16_f32 v254, v44, v45
    v_cvt_pk_bf16_f32 v255, v46, v47
    buffer_store_dwordx4 v[252:255], v235, s[64:67], s38 offen offset:1024 sc1
    v_cvt_pk_bf16_f32 v248, v48, v49
    v_cvt_pk_bf16_f32 v249, v50, v51
    v_cvt_pk_bf16_f32 v250, v52, v53
    v_cvt_pk_bf16_f32 v251, v54, v55
    buffer_store_dwordx4 v[248:251], v235, s[64:67], s38 offen offset:2048 sc1
    v_cvt_pk_bf16_f32 v252, v56, v57
    v_cvt_pk_bf16_f32 v253, v58, v59
    v_cvt_pk_bf16_f32 v254, v60, v61
    v_cvt_pk_bf16_f32 v255, v62, v63
    buffer_store_dwordx4 v[252:255], v235, s[64:67], s38 offen offset:3072 sc1
    s_nop 1
    s_branch k2_fin
k2_m0:
    ds_write_b128 v241, v[32:35] offset:0
    ds_write_b128 v241, v[36:39] offset:1024
    ds_write_b128 v241, v[40:43] offset:2048
    ds_write_b128 v241, v[44:47] offset:3072
    ds_write_b128 v241, v[48:51] offset:4096
    ds_write_b128 v241, v[52:55] offset:5120
    ds_write_b128 v241, v[56:59] offset:6144
    ds_write_b128 v241, v[60:63] offset:7168
    v_min_f32 v245, v243, v160
    v_sub_f32 v246, v245, v160
    v_exp_f32 v246, v246
    v_sub_f32 v247, v245, v243
    v_exp_f32 v247, v247
    v_mul_f32 v245, v233, v246
    v_fmac_f32 v245, v244, v247
    v_rcp_f32 v245, v245
    s_nop 0
    v_mul_f32 v246, v246, v245
    v_mul_f32 v247, v247, v245
    s_waitcnt lgkmcnt(0)
    s_barrier
    ds_read_b128 v[64:67], v242 offset:0
    ds_read_b128 v[68:71], v242 offset:1024
    ds_read_b128 v[72:75], v242 offset:2048
    ds_read_b128 v[76:79], v242 offset:3072
    ds_read_b128 v[80:83], v242 offset:4096
    ds_read_b128 v[84:87], v242 offset:5120
    ds_read_b128 v[88:91], v242 offset:6144
    ds_read_b128 v[92:95], v242 offset:7168
    v_mul_f32 v0, v0, v246
    v_mul_f32 v1, v1, v246
    v_mul_f32 v2, v2, v246
    v_mul_f32 v3, v3, v246
    v_mul_f32 v4, v4, v246
    v_mul_f32 v5, v5, v246
    v_mul_f32 v6, v6, v246
    v_mul_f32 v7, v7, v246
    v_mul_f32 v8, v8, v246
    v_mul_f32 v9, v9, v246
    v_mul_f32 v10, v10, v246
    v_mul_f32 v11, v11, v246
    v_mul_f32 v12, v12, v246
    v_mul_f32 v13, v13, v246
    v_mul_f32 v14, v14, v246
    v_mul_f32 v15, v15, v246
    v_mul_f32 v16, v16, v246
    v_mul_f32 v17, v17, v246
    v_mul_f32 v18, v18, v246
    v_mul_f32 v19, v19, v246
    v_mul_f32 v20, v20, v246
    v_mul_f32 v21, v21, v246
    v_mul_f32 v22, v22, v246
    v_mul_f32 v23, v23, v246
    v_mul_f32 v24, v24, v246
    v_mul_f32 v25, v25, v246
    v_mul_f32 v26, v26, v246
    v_mul_f32 v27, v27, v246
    v_mul_f32 v28, v28, v246
    v_mul_f32 v29, v29, v246
    v_mul_f32 v30, v30, v246
    v_mul_f32 v31, v31, v246
    s_waitcnt lgkmcnt(7)
    v_fmac_f32 v0, v64, v247
    v_fmac_f32 v1, v65, v247
    v_fmac_f32 v2, v66, v247
    v_fmac_f32 v3, v67, v247
    s_waitcnt lgkmcnt(6)
    v_fmac_f32 v4, v68, v247
    v_fmac_f32 v5, v69, v247
    v_fmac_f32 v6, v70, v247
    v_fmac_f32 v7, v71, v247
    s_waitcnt lgkmcnt(5)
    v_fmac_f32 v8, v72, v247
    v_fmac_f32 v9, v73, v247
    v_fmac_f32 v10, v74, v247
    v_fmac_f32 v11, v75, v247
    s_waitcnt lgkmcnt(4)
    v_fmac_f32 v12, v76, v247
    v_fmac_f32 v13, v77, v247
    v_fmac_f32 v14, v78, v247
    v_fmac_f32 v15, v79, v247
    s_waitcnt lgkmcnt(3)
    v_fmac_f32 v16, v80, v247
    v_fmac_f32 v17, v81, v247
    v_fmac_f32 v18, v82, v247
    v_fmac_f32 v19, v83, v247
    s_waitcnt lgkmcnt(2)
    v_fmac_f32 v20, v84, v247
    v_fmac_f32 v21, v85, v247
    v_fmac_f32 v22, v86, v247
    v_fmac_f32 v23, v87, v247
    s_waitcnt lgkmcnt(1)
    v_fmac_f32 v24, v88, v247
    v_fmac_f32 v25, v89, v247
    v_fmac_f32 v26, v90, v247
    v_fmac_f32 v27, v91, v247
    s_waitcnt lgkmcnt(0)
    v_fmac_f32 v28, v92, v247
    v_fmac_f32 v29, v93, v247
    v_fmac_f32 v30, v94, v247
    v_fmac_f32 v31, v95, v247
    v_cvt_pk_bf16_f32 v248, v0, v1
    v_cvt_pk_bf16_f32 v249, v2, v3
    v_cvt_pk_bf16_f32 v250, v4, v5
    v_cvt_pk_bf16_f32 v251, v6, v7
    s_mov_b32 s38, 0x0
    buffer_store_dwordx4 v[248:251], v235, s[64:67], s38 offen offset:0 sc1
    v_cvt_pk_bf16_f32 v252, v8, v9
    v_cvt_pk_bf16_f32 v253, v10, v11
    v_cvt_pk_bf16_f32 v254, v12, v13
    v_cvt_pk_bf16_f32 v255, v14, v15
    buffer_store_dwordx4 v[252:255], v235, s[64:67], s38 offen offset:1024 sc1
    v_cvt_pk_bf16_f32 v248, v16, v17
    v_cvt_pk_bf16_f32 v249, v18, v19
    v_cvt_pk_bf16_f32 v250, v20, v21
    v_cvt_pk_bf16_f32 v251, v22, v23
    buffer_store_dwordx4 v[248:251], v235, s[64:67], s38 offen offset:2048 sc1
    v_cvt_pk_bf16_f32 v252, v24, v25
    v_cvt_pk_bf16_f32 v253, v26, v27
    v_cvt_pk_bf16_f32 v254, v28, v29
    v_cvt_pk_bf16_f32 v255, v30, v31
    buffer_store_dwordx4 v[252:255], v235, s[64:67], s38 offen offset:3072 sc1
    s_nop 1
    s_branch k2_fin
k2_spinz:
    s_nop 7
    s_nop 7
    s_mov_b32 s56, 131072
k2_splz:
    s_sleep 8
    buffer_load_dword v248, v249, s[72:75], 0 offen sc1
    s_waitcnt vmcnt(0)
    v_and_b32 v248, 1, v248
    v_cmp_ne_u32 vcc, 1, v248
    s_sub_u32 s56, s56, 1
    s_nop 3
    s_cbranch_scc1 k2_spz
    s_cbranch_vccnz k2_splz
    s_branch k2_spz
k2_spinx:
    s_nop 7
    s_nop 7
    s_mov_b32 s56, 131072
k2_splx:
    s_sleep 8
    buffer_load_dword v248, v249, s[84:87], 0 offen sc1
    s_waitcnt vmcnt(0)
    v_and_b32 v248, 1, v248
    v_cmp_ne_u32 vcc, 1, v248
    s_sub_u32 s56, s56, 1
    s_nop 3
    s_cbranch_scc1 k2_spx
    s_cbranch_vccnz k2_splx
    s_branch k2_spx
k2_spink:
    s_nop 7
    s_nop 7
    s_mov_b32 s56, 131072
k2_splk:
    s_sleep 8
    buffer_load_dword v248, v249, s[84:87], 0 offen sc1
    s_waitcnt vmcnt(0)
    v_and_b32 v248, 1, v248
    v_cmp_ne_u32 vcc, 1, v248
    s_sub_u32 s56, s56, 1
    s_nop 3
    s_cbranch_scc1 k2_spk
    s_cbranch_vccnz k2_splk
    s_branch k2_spk
k2_mask1:
    s_nop 7
    s_nop 7
    s_lshl_b32 s38, s45, 6
    v_add_u32 v240, s38, v231
    v_cmp_gt_i32 s[56:57], 0, v240
    s_nop 1
    v_cndmask_b32 v64, v160, v232, s[56:57]
    v_cmp_gt_i32 s[56:57], 1, v240
    s_nop 1
    v_cndmask_b32 v65, v161, v232, s[56:57]
    v_cmp_gt_i32 s[56:57], 2, v240
    s_nop 1
    v_cndmask_b32 v66, v162, v232, s[56:57]
    v_cmp_gt_i32 s[56:57], 3, v240
    s_nop 1
    v_cndmask_b32 v67, v163, v232, s[56:57]
    v_cmp_gt_i32 s[56:57], 8, v240
    s_nop 1
    v_cndmask_b32 v68, v164, v232, s[56:57]
    v_cmp_gt_i32 s[56:57], 9, v240
    s_nop 1
    v_cndmask_b32 v69, v165, v232, s[56:57]
    v_cmp_gt_i32 s[56:57], 10, v240
    s_nop 1
    v_cndmask_b32 v70, v166, v232, s[56:57]
    v_cmp_gt_i32 s[56:57], 11, v240
    s_nop 1
    v_cndmask_b32 v71, v167, v232, s[56:57]
    v_cmp_gt_i32 s[56:57], 16, v240
    s_nop 1
    v_cndmask_b32 v72, v168, v232, s[56:57]
    v_cmp_gt_i32 s[56:57], 17, v240
    s_nop 1
    v_cndmask_b32 v73, v169, v232, s[56:57]
    v_cmp_gt_i32 s[56:57], 18, v240
    s_nop 1
    v_cndmask_b32 v74, v170, v232, s[56:57]
    v_cmp_gt_i32 s[56:57], 19, v240
    s_nop 1
    v_cndmask_b32 v75, v171, v232, s[56:57]
    v_cmp_gt_i32 s[56:57], 24, v240
    s_nop 1
    v_cndmask_b32 v76, v172, v232, s[56:57]
    v_cmp_gt_i32 s[56:57], 25, v240
    s_nop 1
    v_cndmask_b32 v77, v173, v232, s[56:57]
    v_cmp_gt_i32 s[56:57], 26, v240
    s_nop 1
    v_cndmask_b32 v78, v174, v232, s[56:57]
    v_cmp_gt_i32 s[56:57], 27, v240
    s_nop 1
    v_cndmask_b32 v79, v175, v232, s[56:57]
    s_nop 1
    v_mfma_f32_32x32x16_bf16 v[64:79], v[176:179], v[128:131], v[64:79]
    s_branch k2_mback1
k2_mask2:
    s_nop 7
    s_nop 7
    s_lshl_b32 s38, s45, 6
    v_add_u32 v240, s38, v231
    v_cmp_gt_i32 s[56:57], 32, v240
    s_nop 1
    v_cndmask_b32 v80, v160, v232, s[56:57]
    v_cmp_gt_i32 s[56:57], 33, v240
    s_nop 1
    v_cndmask_b32 v81, v161, v232, s[56:57]
    v_cmp_gt_i32 s[56:57], 34, v240
    s_nop 1
    v_cndmask_b32 v82, v162, v232, s[56:57]
    v_cmp_gt_i32 s[56:57], 35, v240
    s_nop 1
    v_cndmask_b32 v83, v163, v232, s[56:57]
    v_cmp_gt_i32 s[56:57], 40, v240
    s_nop 1
    v_cndmask_b32 v84, v164, v232, s[56:57]
    v_cmp_gt_i32 s[56:57], 41, v240
    s_nop 1
    v_cndmask_b32 v85, v165, v232, s[56:57]
    v_cmp_gt_i32 s[56:57], 42, v240
    s_nop 1
    v_cndmask_b32 v86, v166, v232, s[56:57]
    v_cmp_gt_i32 s[56:57], 43, v240
    s_nop 1
    v_cndmask_b32 v87, v167, v232, s[56:57]
    v_cmp_gt_i32 s[56:57], 48, v240
    s_nop 1
    v_cndmask_b32 v88, v168, v232, s[56:57]
    v_cmp_gt_i32 s[56:57], 49, v240
    s_nop 1
    v_cndmask_b32 v89, v169, v232, s[56:57]
    v_cmp_gt_i32 s[56:57], 50, v240
    s_nop 1
    v_cndmask_b32 v90, v170, v232, s[56:57]
    v_cmp_gt_i32 s[56:57], 51, v240
    s_nop 1
    v_cndmask_b32 v91, v171, v232, s[56:57]
    v_cmp_gt_i32 s[56:57], 56, v240
    s_nop 1
    v_cndmask_b32 v92, v172, v232, s[56:57]
    v_cmp_gt_i32 s[56:57], 57, v240
    s_nop 1
    v_cndmask_b32 v93, v173, v232, s[56:57]
    v_cmp_gt_i32 s[56:57], 58, v240
    s_nop 1
    v_cndmask_b32 v94, v174, v232, s[56:57]
    v_cmp_gt_i32 s[56:57], 59, v240
    s_nop 1
    v_cndmask_b32 v95, v175, v232, s[56:57]
    s_nop 1
    v_mfma_f32_32x32x16_bf16 v[80:95], v[176:179], v[128:131], v[80:95]
    s_branch k2_mback2
k2_mask3:
    s_nop 7
    s_nop 7
    s_lshl_b32 s38, s45, 6
    v_add_u32 v240, s38, v231
    v_cmp_gt_i32 s[56:57], 0, v240
    s_nop 1
    v_cndmask_b32 v64, v160, v232, s[56:57]
    v_cmp_gt_i32 s[56:57], 1, v240
    s_nop 1
    v_cndmask_b32 v65, v161, v232, s[56:57]
    v_cmp_gt_i32 s[56:57], 2, v240
    s_nop 1
    v_cndmask_b32 v66, v162, v232, s[56:57]
    v_cmp_gt_i32 s[56:57], 3, v240
    s_nop 1
    v_cndmask_b32 v67, v163, v232, s[56:57]
    v_cmp_gt_i32 s[56:57], 8, v240
    s_nop 1
    v_cndmask_b32 v68, v164, v232, s[56:57]
    v_cmp_gt_i32 s[56:57], 9, v240
    s_nop 1
    v_cndmask_b32 v69, v165, v232, s[56:57]
    v_cmp_gt_i32 s[56:57], 10, v240
    s_nop 1
    v_cndmask_b32 v70, v166, v232, s[56:57]
    v_cmp_gt_i32 s[56:57], 11, v240
    s_nop 1
    v_cndmask_b32 v71, v167, v232, s[56:57]
    v_cmp_gt_i32 s[56:57], 16, v240
    s_nop 1
    v_cndmask_b32 v72, v168, v232, s[56:57]
    v_cmp_gt_i32 s[56:57], 17, v240
    s_nop 1
    v_cndmask_b32 v73, v169, v232, s[56:57]
    v_cmp_gt_i32 s[56:57], 18, v240
    s_nop 1
    v_cndmask_b32 v74, v170, v232, s[56:57]
    v_cmp_gt_i32 s[56:57], 19, v240
    s_nop 1
    v_cndmask_b32 v75, v171, v232, s[56:57]
    v_cmp_gt_i32 s[56:57], 24, v240
    s_nop 1
    v_cndmask_b32 v76, v172, v232, s[56:57]
    v_cmp_gt_i32 s[56:57], 25, v240
    s_nop 1
    v_cndmask_b32 v77, v173, v232, s[56:57]
    v_cmp_gt_i32 s[56:57], 26, v240
    s_nop 1
    v_cndmask_b32 v78, v174, v232, s[56:57]
    v_cmp_gt_i32 s[56:57], 27, v240
    s_nop 1
    v_cndmask_b32 v79, v175, v232, s[56:57]
    s_nop 1
    v_mfma_f32_32x32x16_bf16 v[64:79], v[176:179], v[128:131], v[64:79]
    s_branch k2_mback3
k2_slow4:
    s_nop 7
    s_nop 7
    v_max3_f32 v235, v80, v81, v82
    v_max3_f32 v235, v235, v83, v84
    v_max3_f32 v235, v235, v85, v86
    v_max3_f32 v235, v235, v87, v88
    v_max3_f32 v235, v235, v89, v90
    v_max3_f32 v235, v235, v91, v92
    v_max3_f32 v235, v235, v93, v94
    v_max_f32 v235, v235, v95
    v_mov_b32 v236, v235
    s_nop 1
    v_permlane32_swap_b32 v236, v235
    v_max_f32 v235, v235, v236
    v_max_f32 v235, 0, v235
    v_exp_f32 v236, -v235
    v_sub_f32 v160, v160, v235
    v_sub_f32 v161, v161, v235
    v_sub_f32 v162, v162, v235
    v_sub_f32 v163, v163, v235
    v_sub_f32 v164, v164, v235
    v_sub_f32 v165, v165, v235
    v_sub_f32 v166, v166, v235
    v_sub_f32 v167, v167, v235
    v_sub_f32 v168, v168, v235
    v_sub_f32 v169, v169, v235
    v_sub_f32 v170, v170, v235
    v_sub_f32 v171, v171, v235
    v_sub_f32 v172, v172, v235
    v_sub_f32 v173, v173, v235
    v_sub_f32 v174, v174, v235
    v_sub_f32 v175, v175, v235
    v_sub_f32 v64, v64, v235
    v_sub_f32 v65, v65, v235
    v_sub_f32 v66, v66, v235
    v_sub_f32 v67, v67, v235
    v_sub_f32 v68, v68, v235
    v_sub_f32 v69, v69, v235
    v_sub_f32 v70, v70, v235
    v_sub_f32 v71, v71, v235
    v_sub_f32 v72, v72, v235
    v_sub_f32 v73, v73, v235
    v_sub_f32 v74, v74, v235
    v_sub_f32 v75, v75, v235
    v_sub_f32 v76, v76, v235
    v_sub_f32 v77, v77, v235
    v_sub_f32 v78, v78, v235
    v_sub_f32 v79, v79, v235
    v_mul_f32 v0, v0, v236
    v_mul_f32 v1, v1, v236
    v_mul_f32 v2, v2, v236
    v_mul_f32 v3, v3, v236
    v_mul_f32 v4, v4, v236
    v_mul_f32 v5, v5, v236
    v_mul_f32 v6, v6, v236
    v_mul_f32 v7, v7, v236
    v_mul_f32 v8, v8, v236
    v_mul_f32 v9, v9, v236
    v_mul_f32 v10, v10, v236
    v_mul_f32 v11, v11, v236
    v_mul_f32 v12, v12, v236
    v_mul_f32 v13, v13, v236
    v_mul_f32 v14, v14, v236
    v_mul_f32 v15, v15, v236
    v_mul_f32 v16, v16, v236
    v_mul_f32 v17, v17, v236
    v_mul_f32 v18, v18, v236
    v_mul_f32 v19, v19, v236
    v_mul_f32 v20, v20, v236
    v_mul_f32 v21, v21, v236
    v_mul_f32 v22, v22, v236
    v_mul_f32 v23, v23, v236
    v_mul_f32 v24, v24, v236
    v_mul_f32 v25, v25, v236
    v_mul_f32 v26, v26, v236
    v_mul_f32 v27, v27, v236
    v_mul_f32 v28, v28, v236
    v_mul_f32 v29, v29, v236
    v_mul_f32 v30, v30, v236
    v_mul_f32 v31, v31, v236
    v_mul_f32 v32, v32, v236
    v_mul_f32 v33, v33, v236
    v_mul_f32 v34, v34, v236
    v_mul_f32 v35, v35, v236
    v_mul_f32 v36, v36, v236
    v_mul_f32 v37, v37, v236
    v_mul_f32 v38, v38, v236
    v_mul_f32 v39, v39, v236
    v_mul_f32 v40, v40, v236
    v_mul_f32 v41, v41, v236
    v_mul_f32 v42, v42, v236
    v_mul_f32 v43, v43, v236
    v_mul_f32 v44, v44, v236
    v_mul_f32 v45, v45, v236
    v_mul_f32 v46, v46, v236
    v_mul_f32 v47, v47, v236
    v_mul_f32 v48, v48, v236
    v_mul_f32 v49, v49, v236
    v_mul_f32 v50, v50, v236
    v_mul_f32 v51, v51, v236
    v_mul_f32 v52, v52, v236
    v_mul_f32 v53, v53, v236
    v_mul_f32 v54, v54, v236
    v_mul_f32 v55, v55, v236
    v_mul_f32 v56, v56, v236
    v_mul_f32 v57, v57, v236
    v_mul_f32 v58, v58, v236
    v_mul_f32 v59, v59, v236
    v_mul_f32 v60, v60, v236
    v_mul_f32 v61, v61, v236
    v_mul_f32 v62, v62, v236
    v_mul_f32 v63, v63, v236
    v_mul_f32 v233, v233, v236
    v_sub_f32 v96, v80, v235
    v_sub_f32 v97, v81, v235
    v_sub_f32 v98, v82, v235
    v_sub_f32 v99, v83, v235
    v_sub_f32 v100, v84, v235
    v_sub_f32 v101, v85, v235
    v_sub_f32 v102, v86, v235
    v_sub_f32 v103, v87, v235
    v_sub_f32 v104, v88, v235
    v_sub_f32 v105, v89, v235
    v_sub_f32 v106, v90, v235
    v_sub_f32 v107, v91, v235
    v_sub_f32 v108, v92, v235
    v_sub_f32 v109, v93, v235
    v_sub_f32 v110, v94, v235
    v_sub_f32 v111, v95, v235
    v_exp_f32 v96, v96
    v_exp_f32 v97, v97
    v_exp_f32 v98, v98
    v_exp_f32 v99, v99
    v_exp_f32 v100, v100
    v_exp_f32 v101, v101
    v_exp_f32 v102, v102
    v_exp_f32 v103, v103
    v_exp_f32 v104, v104
    v_exp_f32 v105, v105
    v_exp_f32 v106, v106
    v_exp_f32 v107, v107
    v_exp_f32 v108, v108
    v_exp_f32 v109, v109
    v_exp_f32 v110, v110
    v_exp_f32 v111, v111
    v_cvt_pk_bf16_f32 v120, v96, v97
    v_cvt_pk_bf16_f32 v121, v98, v99
    v_cvt_pk_bf16_f32 v122, v100, v101
    v_cvt_pk_bf16_f32 v123, v102, v103
    v_cvt_pk_bf16_f32 v124, v104, v105
    v_cvt_pk_bf16_f32 v125, v106, v107
    v_cvt_pk_bf16_f32 v126, v108, v109
    v_cvt_pk_bf16_f32 v127, v110, v111
    v_add_f32 v234, v96, v97
    v_add_f32 v234, v234, v98
    v_add_f32 v234, v234, v99
    v_add_f32 v234, v234, v100
    v_add_f32 v234, v234, v101
    v_add_f32 v234, v234, v102
    v_add_f32 v234, v234, v103
    v_add_f32 v234, v234, v104
    v_add_f32 v234, v234, v105
    v_add_f32 v234, v234, v106
    v_add_f32 v234, v234, v107
    v_add_f32 v234, v234, v108
    v_add_f32 v234, v234, v109
    v_add_f32 v234, v234, v110
    v_add_f32 v234, v234, v111
    s_nop 1
    s_branch k2_sback4
k2_mask5:
    s_nop 7
    s_nop 7
    s_lshl_b32 s38, s45, 6
    v_add_u32 v240, s38, v231
    v_cmp_gt_i32 s[56:57], 32, v240
    s_nop 1
    v_cndmask_b32 v80, v160, v232, s[56:57]
    v_cmp_gt_i32 s[56:57], 33, v240
    s_nop 1
    v_cndmask_b32 v81, v161, v232, s[56:57]
    v_cmp_gt_i32 s[56:57], 34, v240
    s_nop 1
    v_cndmask_b32 v82, v162, v232, s[56:57]
    v_cmp_gt_i32 s[56:57], 35, v240
    s_nop 1
    v_cndmask_b32 v83, v163, v232, s[56:57]
    v_cmp_gt_i32 s[56:57], 40, v240
    s_nop 1
    v_cndmask_b32 v84, v164, v232, s[56:57]
    v_cmp_gt_i32 s[56:57], 41, v240
    s_nop 1
    v_cndmask_b32 v85, v165, v232, s[56:57]
    v_cmp_gt_i32 s[56:57], 42, v240
    s_nop 1
    v_cndmask_b32 v86, v166, v232, s[56:57]
    v_cmp_gt_i32 s[56:57], 43, v240
    s_nop 1
    v_cndmask_b32 v87, v167, v232, s[56:57]
    v_cmp_gt_i32 s[56:57], 48, v240
    s_nop 1
    v_cndmask_b32 v88, v168, v232, s[56:57]
    v_cmp_gt_i32 s[56:57], 49, v240
    s_nop 1
    v_cndmask_b32 v89, v169, v232, s[56:57]
    v_cmp_gt_i32 s[56:57], 50, v240
    s_nop 1
    v_cndmask_b32 v90, v170, v232, s[56:57]
    v_cmp_gt_i32 s[56:57], 51, v240
    s_nop 1
    v_cndmask_b32 v91, v171, v232, s[56:57]
    v_cmp_gt_i32 s[56:57], 56, v240
    s_nop 1
    v_cndmask_b32 v92, v172, v232, s[56:57]
    v_cmp_gt_i32 s[56:57], 57, v240
    s_nop 1
    v_cndmask_b32 v93, v173, v232, s[56:57]
    v_cmp_gt_i32 s[56:57], 58, v240
    s_nop 1
    v_cndmask_b32 v94, v174, v232, s[56:57]
    v_cmp_gt_i32 s[56:57], 59, v240
    s_nop 1
    v_cndmask_b32 v95, v175, v232, s[56:57]
    s_nop 1
    v_mfma_f32_32x32x16_bf16 v[80:95], v[176:179], v[128:131], v[80:95]
    s_branch k2_mback5
k2_slow6:
    s_nop 7
    s_nop 7
    v_max3_f32 v235, v64, v65, v66
    v_max3_f32 v235, v235, v67, v68
    v_max3_f32 v235, v235, v69, v70
    v_max3_f32 v235, v235, v71, v72
    v_max3_f32 v235, v235, v73, v74
    v_max3_f32 v235, v235, v75, v76
    v_max3_f32 v235, v235, v77, v78
    v_max_f32 v235, v235, v79
    v_mov_b32 v236, v235
    s_nop 1
    v_permlane32_swap_b32 v236, v235
    v_max_f32 v235, v235, v236
    v_max_f32 v235, 0, v235
    v_exp_f32 v236, -v235
    v_sub_f32 v160, v160, v235
    v_sub_f32 v161, v161, v235
    v_sub_f32 v162, v162, v235
    v_sub_f32 v163, v163, v235
    v_sub_f32 v164, v164, v235
    v_sub_f32 v165, v165, v235
    v_sub_f32 v166, v166, v235
    v_sub_f32 v167, v167, v235
    v_sub_f32 v168, v168, v235
    v_sub_f32 v169, v169, v235
    v_sub_f32 v170, v170, v235
    v_sub_f32 v171, v171, v235
    v_sub_f32 v172, v172, v235
    v_sub_f32 v173, v173, v235
    v_sub_f32 v174, v174, v235
    v_sub_f32 v175, v175, v235
    v_sub_f32 v80, v80, v235
    v_sub_f32 v81, v81, v235
    v_sub_f32 v82, v82, v235
    v_sub_f32 v83, v83, v235
    v_sub_f32 v84, v84, v235
    v_sub_f32 v85, v85, v235
    v_sub_f32 v86, v86, v235
    v_sub_f32 v87, v87, v235
    v_sub_f32 v88, v88, v235
    v_sub_f32 v89, v89, v235
    v_sub_f32 v90, v90, v235
    v_sub_f32 v91, v91, v235
    v_sub_f32 v92, v92, v235
    v_sub_f32 v93, v93, v235
    v_sub_f32 v94, v94, v235
    v_sub_f32 v95, v95, v235
    v_mul_f32 v0, v0, v236
    v_mul_f32 v1, v1, v236
    v_mul_f32 v2, v2, v236
    v_mul_f32 v3, v3, v236
    v_mul_f32 v4, v4, v236
    v_mul_f32 v5, v5, v236
    v_mul_f32 v6, v6, v236
    v_mul_f32 v7, v7, v236
    v_mul_f32 v8, v8, v236
    v_mul_f32 v9, v9, v236
    v_mul_f32 v10, v10, v236
    v_mul_f32 v11, v11, v236
    v_mul_f32 v12, v12, v236
    v_mul_f32 v13, v13, v236
    v_mul_f32 v14, v14, v236
    v_mul_f32 v15, v15, v236
    v_mul_f32 v16, v16, v236
    v_mul_f32 v17, v17, v236
    v_mul_f32 v18, v18, v236
    v_mul_f32 v19, v19, v236
    v_mul_f32 v20, v20, v236
    v_mul_f32 v21, v21, v236
    v_mul_f32 v22, v22, v236
    v_mul_f32 v23, v23, v236
    v_mul_f32 v24, v24, v236
    v_mul_f32 v25, v25, v236
    v_mul_f32 v26, v26, v236
    v_mul_f32 v27, v27, v236
    v_mul_f32 v28, v28, v236
    v_mul_f32 v29, v29, v236
    v_mul_f32 v30, v30, v236
    v_mul_f32 v31, v31, v236
    v_mul_f32 v32, v32, v236
    v_mul_f32 v33, v33, v236
    v_mul_f32 v34, v34, v236
    v_mul_f32 v35, v35, v236
    v_mul_f32 v36, v36, v236
    v_mul_f32 v37, v37, v236
    v_mul_f32 v38, v38, v236
    v_mul_f32 v39, v39, v236
    v_mul_f32 v40, v40, v236
    v_mul_f32 v41, v41, v236
    v_mul_f32 v42, v42, v236
    v_mul_f32 v43, v43, v236
    v_mul_f32 v44, v44, v236
    v_mul_f32 v45, v45, v236
    v_mul_f32 v46, v46, v236
    v_mul_f32 v47, v47, v236
    v_mul_f32 v48, v48, v236
    v_mul_f32 v49, v49, v236
    v_mul_f32 v50, v50, v236
    v_mul_f32 v51, v51, v236
    v_mul_f32 v52, v52, v236
    v_mul_f32 v53, v53, v236
    v_mul_f32 v54, v54, v236
    v_mul_f32 v55, v55, v236
    v_mul_f32 v56, v56, v236
    v_mul_f32 v57, v57, v236
    v_mul_f32 v58, v58, v236
    v_mul_f32 v59, v59, v236
    v_mul_f32 v60, v60, v236
    v_mul_f32 v61, v61, v236
    v_mul_f32 v62, v62, v236
    v_mul_f32 v63, v63, v236
    v_mul_f32 v233, v233, v236
    v_sub_f32 v96, v64, v235
    v_sub_f32 v97, v65, v235
    v_sub_f32 v98, v66, v235
    v_sub_f32 v99, v67, v235
    v_sub_f32 v100, v68, v235
    v_sub_f32 v101, v69, v235
    v_sub_f32 v102, v70, v235
    v_sub_f32 v103, v71, v235
    v_sub_f32 v104, v72, v235
    v_sub_f32 v105, v73, v235
    v_sub_f32 v106, v74, v235
    v_sub_f32 v107, v75, v235
    v_sub_f32 v108, v76, v235
    v_sub_f32 v109, v77, v235
    v_sub_f32 v110, v78, v235
    v_sub_f32 v111, v79, v235
    v_exp_f32 v96, v96
    v_exp_f32 v97, v97
    v_exp_f32 v98, v98
    v_exp_f32 v99, v99
    v_exp_f32 v100, v100
    v_exp_f32 v101, v101
    v_exp_f32 v102, v102
    v_exp_f32 v103, v103
    v_exp_f32 v104, v104
    v_exp_f32 v105, v105
    v_exp_f32 v106, v106
    v_exp_f32 v107, v107
    v_exp_f32 v108, v108
    v_exp_f32 v109, v109
    v_exp_f32 v110, v110
    v_exp_f32 v111, v111
    v_cvt_pk_bf16_f32 v112, v96, v97
    v_cvt_pk_bf16_f32 v113, v98, v99
    v_cvt_pk_bf16_f32 v114, v100, v101
    v_cvt_pk_bf16_f32 v115, v102, v103
    v_cvt_pk_bf16_f32 v116, v104, v105
    v_cvt_pk_bf16_f32 v117, v106, v107
    v_cvt_pk_bf16_f32 v118, v108, v109
    v_cvt_pk_bf16_f32 v119, v110, v111
    v_add_f32 v234, v96, v97
    v_add_f32 v234, v234, v98
    v_add_f32 v234, v234, v99
    v_add_f32 v234, v234, v100
    v_add_f32 v234, v234, v101
    v_add_f32 v234, v234, v102
    v_add_f32 v234, v234, v103
    v_add_f32 v234, v234, v104
    v_add_f32 v234, v234, v105
    v_add_f32 v234, v234, v106
    v_add_f32 v234, v234, v107
    v_add_f32 v234, v234, v108
    v_add_f32 v234, v234, v109
    v_add_f32 v234, v234, v110
    v_add_f32 v234, v234, v111
    s_nop 1
    s_branch k2_sback6
k2_mask7:
    s_nop 7
    s_nop 7
    s_lshl_b32 s38, s45, 6
    v_add_u32 v240, s38, v231
    v_cmp_gt_i32 s[56:57], 0, v240
    s_nop 1
    v_cndmask_b32 v64, v160, v232, s[56:57]
    v_cmp_gt_i32 s[56:57], 1, v240
    s_nop 1
    v_cndmask_b32 v65, v161, v232, s[56:57]
    v_cmp_gt_i32 s[56:57], 2, v240
    s_nop 1
    v_cndmask_b32 v66, v162, v232, s[56:57]
    v_cmp_gt_i32 s[56:57], 3, v240
    s_nop 1
    v_cndmask_b32 v67, v163, v232, s[56:57]
    v_cmp_gt_i32 s[56:57], 8, v240
    s_nop 1
    v_cndmask_b32 v68, v164, v232, s[56:57]
    v_cmp_gt_i32 s[56:57], 9, v240
    s_nop 1
    v_cndmask_b32 v69, v165, v232, s[56:57]
    v_cmp_gt_i32 s[56:57], 10, v240
    s_nop 1
    v_cndmask_b32 v70, v166, v232, s[56:57]
    v_cmp_gt_i32 s[56:57], 11, v240
    s_nop 1
    v_cndmask_b32 v71, v167, v232, s[56:57]
    v_cmp_gt_i32 s[56:57], 16, v240
    s_nop 1
    v_cndmask_b32 v72, v168, v232, s[56:57]
    v_cmp_gt_i32 s[56:57], 17, v240
    s_nop 1
    v_cndmask_b32 v73, v169, v232, s[56:57]
    v_cmp_gt_i32 s[56:57], 18, v240
    s_nop 1
    v_cndmask_b32 v74, v170, v232, s[56:57]
    v_cmp_gt_i32 s[56:57], 19, v240
    s_nop 1
    v_cndmask_b32 v75, v171, v232, s[56:57]
    v_cmp_gt_i32 s[56:57], 24, v240
    s_nop 1
    v_cndmask_b32 v76, v172, v232, s[56:57]
    v_cmp_gt_i32 s[56:57], 25, v240
    s_nop 1
    v_cndmask_b32 v77, v173, v232, s[56:57]
    v_cmp_gt_i32 s[56:57], 26, v240
    s_nop 1
    v_cndmask_b32 v78, v174, v232, s[56:57]
    v_cmp_gt_i32 s[56:57], 27, v240
    s_nop 1
    v_cndmask_b32 v79, v175, v232, s[56:57]
    s_nop 1
    v_mfma_f32_32x32x16_bf16 v[64:79], v[176:179], v[128:131], v[64:79]
    s_branch k2_mback7
k2_slow8:
    s_nop 7
    s_nop 7
    v_max3_f32 v235, v80, v81, v82
    v_max3_f32 v235, v235, v83, v84
    v_max3_f32 v235, v235, v85, v86
    v_max3_f32 v235, v235, v87, v88
    v_max3_f32 v235, v235, v89, v90
    v_max3_f32 v235, v235, v91, v92
    v_max3_f32 v235, v235, v93, v94
    v_max_f32 v235, v235, v95
    v_mov_b32 v236, v235
    s_nop 1
    v_permlane32_swap_b32 v236, v235
    v_max_f32 v235, v235, v236
    v_max_f32 v235, 0, v235
    v_exp_f32 v236, -v235
    s_nop 0
    v_mul_f32 v0, v0, v236
    v_mul_f32 v1, v1, v236
    v_mul_f32 v2, v2, v236
    v_mul_f32 v3, v3, v236
    v_mul_f32 v4, v4, v236
    v_mul_f32 v5, v5, v236
    v_mul_f32 v6, v6, v236
    v_mul_f32 v7, v7, v236
    v_mul_f32 v8, v8, v236
    v_mul_f32 v9, v9, v236
    v_mul_f32 v10, v10, v236
    v_mul_f32 v11, v11, v236
    v_mul_f32 v12, v12, v236
    v_mul_f32 v13, v13, v236
    v_mul_f32 v14, v14, v236
    v_mul_f32 v15, v15, v236
    v_mul_f32 v16, v16, v236
    v_mul_f32 v17, v17, v236
    v_mul_f32 v18, v18, v236
    v_mul_f32 v19, v19, v236
    v_mul_f32 v20, v20, v236
    v_mul_f32 v21, v21, v236
    v_mul_f32 v22, v22, v236
    v_mul_f32 v23, v23, v236
    v_mul_f32 v24, v24, v236
    v_mul_f32 v25, v25, v236
    v_mul_f32 v26, v26, v236
    v_mul_f32 v27, v27, v236
    v_mul_f32 v28, v28, v236
    v_mul_f32 v29, v29, v236
    v_mul_f32 v30, v30, v236
    v_mul_f32 v31, v31, v236
    v_mul_f32 v32, v32, v236
    v_mul_f32 v33, v33, v236
    v_mul_f32 v34, v34, v236
    v_mul_f32 v35, v35, v236
    v_mul_f32 v36, v36, v236
    v_mul_f32 v37, v37, v236
    v_mul_f32 v38, v38, v236
    v_mul_f32 v39, v39, v236
    v_mul_f32 v40, v40, v236
    v_mul_f32 v41, v41, v236
    v_mul_f32 v42, v42, v236
    v_mul_f32 v43, v43, v236
    v_mul_f32 v44, v44, v236
    v_mul_f32 v45, v45, v236
    v_mul_f32 v46, v46, v236
    v_mul_f32 v47, v47, v236
    v_mul_f32 v48, v48, v236
    v_mul_f32 v49, v49, v236
    v_mul_f32 v50, v50, v236
    v_mul_f32 v51, v51, v236
    v_mul_f32 v52, v52, v236
    v_mul_f32 v53, v53, v236
    v_mul_f32 v54, v54, v236
    v_mul_f32 v55, v55, v236
    v_mul_f32 v56, v56, v236
    v_mul_f32 v57, v57, v236
    v_mul_f32 v58, v58, v236
    v_mul_f32 v59, v59, v236
    v_mul_f32 v60, v60, v236
    v_mul_f32 v61, v61, v236
    v_mul_f32 v62, v62, v236
    v_mul_f32 v63, v63, v236
    v_mul_f32 v233, v233, v236
    v_sub_f32 v96, v80, v235
    v_sub_f32 v97, v81, v235
    v_sub_f32 v98, v82, v235
    v_sub_f32 v99, v83, v235
    v_sub_f32 v100, v84, v235
    v_sub_f32 v101, v85, v235
    v_sub_f32 v102, v86, v235
    v_sub_f32 v103, v87, v235
    v_sub_f32 v104, v88, v235
    v_sub_f32 v105, v89, v235
    v_sub_f32 v106, v90, v235
    v_sub_f32 v107, v91, v235
    v_sub_f32 v108, v92, v235
    v_sub_f32 v109, v93, v235
    v_sub_f32 v110, v94, v235
    v_sub_f32 v111, v95, v235
    v_exp_f32 v96, v96
    v_exp_f32 v97, v97
    v_exp_f32 v98, v98
    v_exp_f32 v99, v99
    v_exp_f32 v100, v100
    v_exp_f32 v101, v101
    v_exp_f32 v102, v102
    v_exp_f32 v103, v103
    v_exp_f32 v104, v104
    v_exp_f32 v105, v105
    v_exp_f32 v106, v106
    v_exp_f32 v107, v107
    v_exp_f32 v108, v108
    v_exp_f32 v109, v109
    v_exp_f32 v110, v110
    v_exp_f32 v111, v111
    v_cvt_pk_bf16_f32 v120, v96, v97
    v_cvt_pk_bf16_f32 v121, v98, v99
    v_cvt_pk_bf16_f32 v122, v100, v101
    v_cvt_pk_bf16_f32 v123, v102, v103
    v_cvt_pk_bf16_f32 v124, v104, v105
    v_cvt_pk_bf16_f32 v125, v106, v107
    v_cvt_pk_bf16_f32 v126, v108, v109
    v_cvt_pk_bf16_f32 v127, v110, v111
    v_add_f32 v234, v96, v97
    v_add_f32 v234, v234, v98
    v_add_f32 v234, v234, v99
    v_add_f32 v234, v234, v100
    v_add_f32 v234, v234, v101
    v_add_f32 v234, v234, v102
    v_add_f32 v234, v234, v103
    v_add_f32 v234, v234, v104
    v_add_f32 v234, v234, v105
    v_add_f32 v234, v234, v106
    v_add_f32 v234, v234, v107
    v_add_f32 v234, v234, v108
    v_add_f32 v234, v234, v109
    v_add_f32 v234, v234, v110
    v_add_f32 v234, v234, v111
    s_nop 1
    s_branch k2_sback8
k2_mask9:
    s_nop 7
    s_nop 7
    s_lshl_b32 s38, s45, 6
    v_add_u32 v240, s38, v231
    v_cmp_gt_i32 s[56:57], 32, v240
    s_nop 1
    v_cndmask_b32 v80, v160, v232, s[56:57]
    v_cmp_gt_i32 s[56:57], 33, v240
    s_nop 1
    v_cndmask_b32 v81, v161, v232, s[56:57]
    v_cmp_gt_i32 s[56:57], 34, v240
    s_nop 1
    v_cndmask_b32 v82, v162, v232, s[56:57]
    v_cmp_gt_i32 s[56:57], 35, v240
    s_nop 1
    v_cndmask_b32 v83, v163, v232, s[56:57]
    v_cmp_gt_i32 s[56:57], 40, v240
    s_nop 1
    v_cndmask_b32 v84, v164, v232, s[56:57]
    v_cmp_gt_i32 s[56:57], 41, v240
    s_nop 1
    v_cndmask_b32 v85, v165, v232, s[56:57]
    v_cmp_gt_i32 s[56:57], 42, v240
    s_nop 1
    v_cndmask_b32 v86, v166, v232, s[56:57]
    v_cmp_gt_i32 s[56:57], 43, v240
    s_nop 1
    v_cndmask_b32 v87, v167, v232, s[56:57]
    v_cmp_gt_i32 s[56:57], 48, v240
    s_nop 1
    v_cndmask_b32 v88, v168, v232, s[56:57]
    v_cmp_gt_i32 s[56:57], 49, v240
    s_nop 1
    v_cndmask_b32 v89, v169, v232, s[56:57]
    v_cmp_gt_i32 s[56:57], 50, v240
    s_nop 1
    v_cndmask_b32 v90, v170, v232, s[56:57]
    v_cmp_gt_i32 s[56:57], 51, v240
    s_nop 1
    v_cndmask_b32 v91, v171, v232, s[56:57]
    v_cmp_gt_i32 s[56:57], 56, v240
    s_nop 1
    v_cndmask_b32 v92, v172, v232, s[56:57]
    v_cmp_gt_i32 s[56:57], 57, v240
    s_nop 1
    v_cndmask_b32 v93, v173, v232, s[56:57]
    v_cmp_gt_i32 s[56:57], 58, v240
    s_nop 1
    v_cndmask_b32 v94, v174, v232, s[56:57]
    v_cmp_gt_i32 s[56:57], 59, v240
    s_nop 1
    v_cndmask_b32 v95, v175, v232, s[56:57]
    s_nop 1
    v_mfma_f32_32x32x16_bf16 v[80:95], v[176:179], v[128:131], v[80:95]
    s_branch k2_mback9
k2_mask10:
    s_nop 7
    s_nop 7
    s_lshl_b32 s38, s45, 6
    v_add_u32 v240, s38, v231
    v_cmp_gt_i32 s[56:57], 0, v240
    s_nop 1
    v_cndmask_b32 v64, v160, v232, s[56:57]
    v_cmp_gt_i32 s[56:57], 1, v240
    s_nop 1
    v_cndmask_b32 v65, v161, v232, s[56:57]
    v_cmp_gt_i32 s[56:57], 2, v240
    s_nop 1
    v_cndmask_b32 v66, v162, v232, s[56:57]
    v_cmp_gt_i32 s[56:57], 3, v240
    s_nop 1
    v_cndmask_b32 v67, v163, v232, s[56:57]
    v_cmp_gt_i32 s[56:57], 8, v240
    s_nop 1
    v_cndmask_b32 v68, v164, v232, s[56:57]
    v_cmp_gt_i32 s[56:57], 9, v240
    s_nop 1
    v_cndmask_b32 v69, v165, v232, s[56:57]
    v_cmp_gt_i32 s[56:57], 10, v240
    s_nop 1
    v_cndmask_b32 v70, v166, v232, s[56:57]
    v_cmp_gt_i32 s[56:57], 11, v240
    s_nop 1
    v_cndmask_b32 v71, v167, v232, s[56:57]
    v_cmp_gt_i32 s[56:57], 16, v240
    s_nop 1
    v_cndmask_b32 v72, v168, v232, s[56:57]
    v_cmp_gt_i32 s[56:57], 17, v240
    s_nop 1
    v_cndmask_b32 v73, v169, v232, s[56:57]
    v_cmp_gt_i32 s[56:57], 18, v240
    s_nop 1
    v_cndmask_b32 v74, v170, v232, s[56:57]
    v_cmp_gt_i32 s[56:57], 19, v240
    s_nop 1
    v_cndmask_b32 v75, v171, v232, s[56:57]
    v_cmp_gt_i32 s[56:57], 24, v240
    s_nop 1
    v_cndmask_b32 v76, v172, v232, s[56:57]
    v_cmp_gt_i32 s[56:57], 25, v240
    s_nop 1
    v_cndmask_b32 v77, v173, v232, s[56:57]
    v_cmp_gt_i32 s[56:57], 26, v240
    s_nop 1
    v_cndmask_b32 v78, v174, v232, s[56:57]
    v_cmp_gt_i32 s[56:57], 27, v240
    s_nop 1
    v_cndmask_b32 v79, v175, v232, s[56:57]
    s_nop 1
    v_mfma_f32_32x32x16_bf16 v[64:79], v[176:179], v[128:131], v[64:79]
    s_branch k2_mback10
k2_slow11:
    s_nop 7
    s_nop 7
    v_max3_f32 v235, v80, v81, v82
    v_max3_f32 v235, v235, v83, v84
    v_max3_f32 v235, v235, v85, v86
    v_max3_f32 v235, v235, v87, v88
    v_max3_f32 v235, v235, v89, v90
    v_max3_f32 v235, v235, v91, v92
    v_max3_f32 v235, v235, v93, v94
    v_max_f32 v235, v235, v95
    v_mov_b32 v236, v235
    s_nop 1
    v_permlane32_swap_b32 v236, v235
    v_max_f32 v235, v235, v236
    v_max_f32 v235, 0, v235
    v_exp_f32 v236, -v235
    v_sub_f32 v160, v160, v235
    v_sub_f32 v161, v161, v235
    v_sub_f32 v162, v162, v235
    v_sub_f32 v163, v163, v235
    v_sub_f32 v164, v164, v235
    v_sub_f32 v165, v165, v235
    v_sub_f32 v166, v166, v235
    v_sub_f32 v167, v167, v235
    v_sub_f32 v168, v168, v235
    v_sub_f32 v169, v169, v235
    v_sub_f32 v170, v170, v235
    v_sub_f32 v171, v171, v235
    v_sub_f32 v172, v172, v235
    v_sub_f32 v173, v173, v235
    v_sub_f32 v174, v174, v235
    v_sub_f32 v175, v175, v235
    v_sub_f32 v64, v64, v235
    v_sub_f32 v65, v65, v235
    v_sub_f32 v66, v66, v235
    v_sub_f32 v67, v67, v235
    v_sub_f32 v68, v68, v235
    v_sub_f32 v69, v69, v235
    v_sub_f32 v70, v70, v235
    v_sub_f32 v71, v71, v235
    v_sub_f32 v72, v72, v235
    v_sub_f32 v73, v73, v235
    v_sub_f32 v74, v74, v235
    v_sub_f32 v75, v75, v235
    v_sub_f32 v76, v76, v235
    v_sub_f32 v77, v77, v235
    v_sub_f32 v78, v78, v235
    v_sub_f32 v79, v79, v235
    v_mul_f32 v0, v0, v236
    v_mul_f32 v1, v1, v236
    v_mul_f32 v2, v2, v236
    v_mul_f32 v3, v3, v236
    v_mul_f32 v4, v4, v236
    v_mul_f32 v5, v5, v236
    v_mul_f32 v6, v6, v236
    v_mul_f32 v7, v7, v236
    v_mul_f32 v8, v8, v236
    v_mul_f32 v9, v9, v236
    v_mul_f32 v10, v10, v236
    v_mul_f32 v11, v11, v236
    v_mul_f32 v12, v12, v236
    v_mul_f32 v13, v13, v236
    v_mul_f32 v14, v14, v236
    v_mul_f32 v15, v15, v236
    v_mul_f32 v16, v16, v236
    v_mul_f32 v17, v17, v236
    v_mul_f32 v18, v18, v236
    v_mul_f32 v19, v19, v236
    v_mul_f32 v20, v20, v236
    v_mul_f32 v21, v21, v236
    v_mul_f32 v22, v22, v236
    v_mul_f32 v23, v23, v236
    v_mul_f32 v24, v24, v236
    v_mul_f32 v25, v25, v236
    v_mul_f32 v26, v26, v236
    v_mul_f32 v27, v27, v236
    v_mul_f32 v28, v28, v236
    v_mul_f32 v29, v29, v236
    v_mul_f32 v30, v30, v236
    v_mul_f32 v31, v31, v236
    v_mul_f32 v32, v32, v236
    v_mul_f32 v33, v33, v236
    v_mul_f32 v34, v34, v236
    v_mul_f32 v35, v35, v236
    v_mul_f32 v36, v36, v236
    v_mul_f32 v37, v37, v236
    v_mul_f32 v38, v38, v236
    v_mul_f32 v39, v39, v236
    v_mul_f32 v40, v40, v236
    v_mul_f32 v41, v41, v236
    v_mul_f32 v42, v42, v236
    v_mul_f32 v43, v43, v236
    v_mul_f32 v44, v44, v236
    v_mul_f32 v45, v45, v236
    v_mul_f32 v46, v46, v236
    v_mul_f32 v47, v47, v236
    v_mul_f32 v48, v48, v236
    v_mul_f32 v49, v49, v236
    v_mul_f32 v50, v50, v236
    v_mul_f32 v51, v51, v236
    v_mul_f32 v52, v52, v236
    v_mul_f32 v53, v53, v236
    v_mul_f32 v54, v54, v236
    v_mul_f32 v55, v55, v236
    v_mul_f32 v56, v56, v236
    v_mul_f32 v57, v57, v236
    v_mul_f32 v58, v58, v236
    v_mul_f32 v59, v59, v236
    v_mul_f32 v60, v60, v236
    v_mul_f32 v61, v61, v236
    v_mul_f32 v62, v62, v236
    v_mul_f32 v63, v63, v236
    v_mul_f32 v233, v233, v236
    v_sub_f32 v96, v80, v235
    v_sub_f32 v97, v81, v235
    v_sub_f32 v98, v82, v235
    v_sub_f32 v99, v83, v235
    v_sub_f32 v100, v84, v235
    v_sub_f32 v101, v85, v235
    v_sub_f32 v102, v86, v235
    v_sub_f32 v103, v87, v235
    v_sub_f32 v104, v88, v235
    v_sub_f32 v105, v89, v235
    v_sub_f32 v106, v90, v235
    v_sub_f32 v107, v91, v235
    v_sub_f32 v108, v92, v235
    v_sub_f32 v109, v93, v235
    v_sub_f32 v110, v94, v235
    v_sub_f32 v111, v95, v235
    v_exp_f32 v96, v96
    v_exp_f32 v97, v97
    v_exp_f32 v98, v98
    v_exp_f32 v99, v99
    v_exp_f32 v100, v100
    v_exp_f32 v101, v101
    v_exp_f32 v102, v102
    v_exp_f32 v103, v103
    v_exp_f32 v104, v104
    v_exp_f32 v105, v105
    v_exp_f32 v106, v106
    v_exp_f32 v107, v107
    v_exp_f32 v108, v108
    v_exp_f32 v109, v109
    v_exp_f32 v110, v110
    v_exp_f32 v111, v111
    v_cvt_pk_bf16_f32 v120, v96, v97
    v_cvt_pk_bf16_f32 v121, v98, v99
    v_cvt_pk_bf16_f32 v122, v100, v101
    v_cvt_pk_bf16_f32 v123, v102, v103
    v_cvt_pk_bf16_f32 v124, v104, v105
    v_cvt_pk_bf16_f32 v125, v106, v107
    v_cvt_pk_bf16_f32 v126, v108, v109
    v_cvt_pk_bf16_f32 v127, v110, v111
    v_add_f32 v234, v96, v97
    v_add_f32 v234, v234, v98
    v_add_f32 v234, v234, v99
    v_add_f32 v234, v234, v100
    v_add_f32 v234, v234, v101
    v_add_f32 v234, v234, v102
    v_add_f32 v234, v234, v103
    v_add_f32 v234, v234, v104
    v_add_f32 v234, v234, v105
    v_add_f32 v234, v234, v106
    v_add_f32 v234, v234, v107
    v_add_f32 v234, v234, v108
    v_add_f32 v234, v234, v109
    v_add_f32 v234, v234, v110
    v_add_f32 v234, v234, v111
    s_nop 1
    s_branch k2_sback11
k2_mask12:
    s_nop 7
    s_nop 7
    s_lshl_b32 s38, s45, 6
    v_add_u32 v240, s38, v231
    v_cmp_gt_i32 s[56:57], 32, v240
    s_nop 1
    v_cndmask_b32 v80, v160, v232, s[56:57]
    v_cmp_gt_i32 s[56:57], 33, v240
    s_nop 1
    v_cndmask_b32 v81, v161, v232, s[56:57]
    v_cmp_gt_i32 s[56:57], 34, v240
    s_nop 1
    v_cndmask_b32 v82, v162, v232, s[56:57]
    v_cmp_gt_i32 s[56:57], 35, v240
    s_nop 1
    v_cndmask_b32 v83, v163, v232, s[56:57]
    v_cmp_gt_i32 s[56:57], 40, v240
    s_nop 1
    v_cndmask_b32 v84, v164, v232, s[56:57]
    v_cmp_gt_i32 s[56:57], 41, v240
    s_nop 1
    v_cndmask_b32 v85, v165, v232, s[56:57]
    v_cmp_gt_i32 s[56:57], 42, v240
    s_nop 1
    v_cndmask_b32 v86, v166, v232, s[56:57]
    v_cmp_gt_i32 s[56:57], 43, v240
    s_nop 1
    v_cndmask_b32 v87, v167, v232, s[56:57]
    v_cmp_gt_i32 s[56:57], 48, v240
    s_nop 1
    v_cndmask_b32 v88, v168, v232, s[56:57]
    v_cmp_gt_i32 s[56:57], 49, v240
    s_nop 1
    v_cndmask_b32 v89, v169, v232, s[56:57]
    v_cmp_gt_i32 s[56:57], 50, v240
    s_nop 1
    v_cndmask_b32 v90, v170, v232, s[56:57]
    v_cmp_gt_i32 s[56:57], 51, v240
    s_nop 1
    v_cndmask_b32 v91, v171, v232, s[56:57]
    v_cmp_gt_i32 s[56:57], 56, v240
    s_nop 1
    v_cndmask_b32 v92, v172, v232, s[56:57]
    v_cmp_gt_i32 s[56:57], 57, v240
    s_nop 1
    v_cndmask_b32 v93, v173, v232, s[56:57]
    v_cmp_gt_i32 s[56:57], 58, v240
    s_nop 1
    v_cndmask_b32 v94, v174, v232, s[56:57]
    v_cmp_gt_i32 s[56:57], 59, v240
    s_nop 1
    v_cndmask_b32 v95, v175, v232, s[56:57]
    s_nop 1
    v_mfma_f32_32x32x16_bf16 v[80:95], v[176:179], v[128:131], v[80:95]
    s_branch k2_mback12
k2_slow13:
    s_nop 7
    s_nop 7
    v_max3_f32 v235, v64, v65, v66
    v_max3_f32 v235, v235, v67, v68
    v_max3_f32 v235, v235, v69, v70
    v_max3_f32 v235, v235, v71, v72
    v_max3_f32 v235, v235, v73, v74
    v_max3_f32 v235, v235, v75, v76
    v_max3_f32 v235, v235, v77, v78
    v_max_f32 v235, v235, v79
    v_mov_b32 v236, v235
    s_nop 1
    v_permlane32_swap_b32 v236, v235
    v_max_f32 v235, v235, v236
    v_max_f32 v235, 0, v235
    v_exp_f32 v236, -v235
    v_sub_f32 v160, v160, v235
    v_sub_f32 v161, v161, v235
    v_sub_f32 v162, v162, v235
    v_sub_f32 v163, v163, v235
    v_sub_f32 v164, v164, v235
    v_sub_f32 v165, v165, v235
    v_sub_f32 v166, v166, v235
    v_sub_f32 v167, v167, v235
    v_sub_f32 v168, v168, v235
    v_sub_f32 v169, v169, v235
    v_sub_f32 v170, v170, v235
    v_sub_f32 v171, v171, v235
    v_sub_f32 v172, v172, v235
    v_sub_f32 v173, v173, v235
    v_sub_f32 v174, v174, v235
    v_sub_f32 v175, v175, v235
    v_sub_f32 v80, v80, v235
    v_sub_f32 v81, v81, v235
    v_sub_f32 v82, v82, v235
    v_sub_f32 v83, v83, v235
    v_sub_f32 v84, v84, v235
    v_sub_f32 v85, v85, v235
    v_sub_f32 v86, v86, v235
    v_sub_f32 v87, v87, v235
    v_sub_f32 v88, v88, v235
    v_sub_f32 v89, v89, v235
    v_sub_f32 v90, v90, v235
    v_sub_f32 v91, v91, v235
    v_sub_f32 v92, v92, v235
    v_sub_f32 v93, v93, v235
    v_sub_f32 v94, v94, v235
    v_sub_f32 v95, v95, v235
    v_mul_f32 v0, v0, v236
    v_mul_f32 v1, v1, v236
    v_mul_f32 v2, v2, v236
    v_mul_f32 v3, v3, v236
    v_mul_f32 v4, v4, v236
    v_mul_f32 v5, v5, v236
    v_mul_f32 v6, v6, v236
    v_mul_f32 v7, v7, v236
    v_mul_f32 v8, v8, v236
    v_mul_f32 v9, v9, v236
    v_mul_f32 v10, v10, v236
    v_mul_f32 v11, v11, v236
    v_mul_f32 v12, v12, v236
    v_mul_f32 v13, v13, v236
    v_mul_f32 v14, v14, v236
    v_mul_f32 v15, v15, v236
    v_mul_f32 v16, v16, v236
    v_mul_f32 v17, v17, v236
    v_mul_f32 v18, v18, v236
    v_mul_f32 v19, v19, v236
    v_mul_f32 v20, v20, v236
    v_mul_f32 v21, v21, v236
    v_mul_f32 v22, v22, v236
    v_mul_f32 v23, v23, v236
    v_mul_f32 v24, v24, v236
    v_mul_f32 v25, v25, v236
    v_mul_f32 v26, v26, v236
    v_mul_f32 v27, v27, v236
    v_mul_f32 v28, v28, v236
    v_mul_f32 v29, v29, v236
    v_mul_f32 v30, v30, v236
    v_mul_f32 v31, v31, v236
    v_mul_f32 v32, v32, v236
    v_mul_f32 v33, v33, v236
    v_mul_f32 v34, v34, v236
    v_mul_f32 v35, v35, v236
    v_mul_f32 v36, v36, v236
    v_mul_f32 v37, v37, v236
    v_mul_f32 v38, v38, v236
    v_mul_f32 v39, v39, v236
    v_mul_f32 v40, v40, v236
    v_mul_f32 v41, v41, v236
    v_mul_f32 v42, v42, v236
    v_mul_f32 v43, v43, v236
    v_mul_f32 v44, v44, v236
    v_mul_f32 v45, v45, v236
    v_mul_f32 v46, v46, v236
    v_mul_f32 v47, v47, v236
    v_mul_f32 v48, v48, v236
    v_mul_f32 v49, v49, v236
    v_mul_f32 v50, v50, v236
    v_mul_f32 v51, v51, v236
    v_mul_f32 v52, v52, v236
    v_mul_f32 v53, v53, v236
    v_mul_f32 v54, v54, v236
    v_mul_f32 v55, v55, v236
    v_mul_f32 v56, v56, v236
    v_mul_f32 v57, v57, v236
    v_mul_f32 v58, v58, v236
    v_mul_f32 v59, v59, v236
    v_mul_f32 v60, v60, v236
    v_mul_f32 v61, v61, v236
    v_mul_f32 v62, v62, v236
    v_mul_f32 v63, v63, v236
    v_mul_f32 v233, v233, v236
    v_sub_f32 v96, v64, v235
    v_sub_f32 v97, v65, v235
    v_sub_f32 v98, v66, v235
    v_sub_f32 v99, v67, v235
    v_sub_f32 v100, v68, v235
    v_sub_f32 v101, v69, v235
    v_sub_f32 v102, v70, v235
    v_sub_f32 v103, v71, v235
    v_sub_f32 v104, v72, v235
    v_sub_f32 v105, v73, v235
    v_sub_f32 v106, v74, v235
    v_sub_f32 v107, v75, v235
    v_sub_f32 v108, v76, v235
    v_sub_f32 v109, v77, v235
    v_sub_f32 v110, v78, v235
    v_sub_f32 v111, v79, v235
    v_exp_f32 v96, v96
    v_exp_f32 v97, v97
    v_exp_f32 v98, v98
    v_exp_f32 v99, v99
    v_exp_f32 v100, v100
    v_exp_f32 v101, v101
    v_exp_f32 v102, v102
    v_exp_f32 v103, v103
    v_exp_f32 v104, v104
    v_exp_f32 v105, v105
    v_exp_f32 v106, v106
    v_exp_f32 v107, v107
    v_exp_f32 v108, v108
    v_exp_f32 v109, v109
    v_exp_f32 v110, v110
    v_exp_f32 v111, v111
    v_cvt_pk_bf16_f32 v112, v96, v97
    v_cvt_pk_bf16_f32 v113, v98, v99
    v_cvt_pk_bf16_f32 v114, v100, v101
    v_cvt_pk_bf16_f32 v115, v102, v103
    v_cvt_pk_bf16_f32 v116, v104, v105
    v_cvt_pk_bf16_f32 v117, v106, v107
    v_cvt_pk_bf16_f32 v118, v108, v109
    v_cvt_pk_bf16_f32 v119, v110, v111
    v_add_f32 v234, v96, v97
    v_add_f32 v234, v234, v98
    v_add_f32 v234, v234, v99
    v_add_f32 v234, v234, v100
    v_add_f32 v234, v234, v101
    v_add_f32 v234, v234, v102
    v_add_f32 v234, v234, v103
    v_add_f32 v234, v234, v104
    v_add_f32 v234, v234, v105
    v_add_f32 v234, v234, v106
    v_add_f32 v234, v234, v107
    v_add_f32 v234, v234, v108
    v_add_f32 v234, v234, v109
    v_add_f32 v234, v234, v110
    v_add_f32 v234, v234, v111
    s_nop 1
    s_branch k2_sback13
k2_mask14:
    s_nop 7
    s_nop 7
    s_lshl_b32 s38, s45, 6
    v_add_u32 v240, s38, v231
    v_cmp_gt_i32 s[56:57], 0, v240
    s_nop 1
    v_cndmask_b32 v64, v160, v232, s[56:57]
    v_cmp_gt_i32 s[56:57], 1, v240
    s_nop 1
    v_cndmask_b32 v65, v161, v232, s[56:57]
    v_cmp_gt_i32 s[56:57], 2, v240
    s_nop 1
    v_cndmask_b32 v66, v162, v232, s[56:57]
    v_cmp_gt_i32 s[56:57], 3, v240
    s_nop 1
    v_cndmask_b32 v67, v163, v232, s[56:57]
    v_cmp_gt_i32 s[56:57], 8, v240
    s_nop 1
    v_cndmask_b32 v68, v164, v232, s[56:57]
    v_cmp_gt_i32 s[56:57], 9, v240
    s_nop 1
    v_cndmask_b32 v69, v165, v232, s[56:57]
    v_cmp_gt_i32 s[56:57], 10, v240
    s_nop 1
    v_cndmask_b32 v70, v166, v232, s[56:57]
    v_cmp_gt_i32 s[56:57], 11, v240
    s_nop 1
    v_cndmask_b32 v71, v167, v232, s[56:57]
    v_cmp_gt_i32 s[56:57], 16, v240
    s_nop 1
    v_cndmask_b32 v72, v168, v232, s[56:57]
    v_cmp_gt_i32 s[56:57], 17, v240
    s_nop 1
    v_cndmask_b32 v73, v169, v232, s[56:57]
    v_cmp_gt_i32 s[56:57], 18, v240
    s_nop 1
    v_cndmask_b32 v74, v170, v232, s[56:57]
    v_cmp_gt_i32 s[56:57], 19, v240
    s_nop 1
    v_cndmask_b32 v75, v171, v232, s[56:57]
    v_cmp_gt_i32 s[56:57], 24, v240
    s_nop 1
    v_cndmask_b32 v76, v172, v232, s[56:57]
    v_cmp_gt_i32 s[56:57], 25, v240
    s_nop 1
    v_cndmask_b32 v77, v173, v232, s[56:57]
    v_cmp_gt_i32 s[56:57], 26, v240
    s_nop 1
    v_cndmask_b32 v78, v174, v232, s[56:57]
    v_cmp_gt_i32 s[56:57], 27, v240
    s_nop 1
    v_cndmask_b32 v79, v175, v232, s[56:57]
    s_nop 1
    v_mfma_f32_32x32x16_bf16 v[64:79], v[176:179], v[128:131], v[64:79]
    s_branch k2_mback14
k2_slow15:
    s_nop 7
    s_nop 7
    v_max3_f32 v235, v80, v81, v82
    v_max3_f32 v235, v235, v83, v84
    v_max3_f32 v235, v235, v85, v86
    v_max3_f32 v235, v235, v87, v88
    v_max3_f32 v235, v235, v89, v90
    v_max3_f32 v235, v235, v91, v92
    v_max3_f32 v235, v235, v93, v94
    v_max_f32 v235, v235, v95
    v_mov_b32 v236, v235
    s_nop 1
    v_permlane32_swap_b32 v236, v235
    v_max_f32 v235, v235, v236
    v_max_f32 v235, 0, v235
    v_exp_f32 v236, -v235
    v_sub_f32 v160, v160, v235
    v_sub_f32 v161, v161, v235
    v_sub_f32 v162, v162, v235
    v_sub_f32 v163, v163, v235
    v_sub_f32 v164, v164, v235
    v_sub_f32 v165, v165, v235
    v_sub_f32 v166, v166, v235
    v_sub_f32 v167, v167, v235
    v_sub_f32 v168, v168, v235
    v_sub_f32 v169, v169, v235
    v_sub_f32 v170, v170, v235
    v_sub_f32 v171, v171, v235
    v_sub_f32 v172, v172, v235
    v_sub_f32 v173, v173, v235
    v_sub_f32 v174, v174, v235
    v_sub_f32 v175, v175, v235
    v_sub_f32 v64, v64, v235
    v_sub_f32 v65, v65, v235
    v_sub_f32 v66, v66, v235
    v_sub_f32 v67, v67, v235
    v_sub_f32 v68, v68, v235
    v_sub_f32 v69, v69, v235
    v_sub_f32 v70, v70, v235
    v_sub_f32 v71, v71, v235
    v_sub_f32 v72, v72, v235
    v_sub_f32 v73, v73, v235
    v_sub_f32 v74, v74, v235
    v_sub_f32 v75, v75, v235
    v_sub_f32 v76, v76, v235
    v_sub_f32 v77, v77, v235
    v_sub_f32 v78, v78, v235
    v_sub_f32 v79, v79, v235
    v_mul_f32 v0, v0, v236
    v_mul_f32 v1, v1, v236
    v_mul_f32 v2, v2, v236
    v_mul_f32 v3, v3, v236
    v_mul_f32 v4, v4, v236
    v_mul_f32 v5, v5, v236
    v_mul_f32 v6, v6, v236
    v_mul_f32 v7, v7, v236
    v_mul_f32 v8, v8, v236
    v_mul_f32 v9, v9, v236
    v_mul_f32 v10, v10, v236
    v_mul_f32 v11, v11, v236
    v_mul_f32 v12, v12, v236
    v_mul_f32 v13, v13, v236
    v_mul_f32 v14, v14, v236
    v_mul_f32 v15, v15, v236
    v_mul_f32 v16, v16, v236
    v_mul_f32 v17, v17, v236
    v_mul_f32 v18, v18, v236
    v_mul_f32 v19, v19, v236
    v_mul_f32 v20, v20, v236
    v_mul_f32 v21, v21, v236
    v_mul_f32 v22, v22, v236
    v_mul_f32 v23, v23, v236
    v_mul_f32 v24, v24, v236
    v_mul_f32 v25, v25, v236
    v_mul_f32 v26, v26, v236
    v_mul_f32 v27, v27, v236
    v_mul_f32 v28, v28, v236
    v_mul_f32 v29, v29, v236
    v_mul_f32 v30, v30, v236
    v_mul_f32 v31, v31, v236
    v_mul_f32 v32, v32, v236
    v_mul_f32 v33, v33, v236
    v_mul_f32 v34, v34, v236
    v_mul_f32 v35, v35, v236
    v_mul_f32 v36, v36, v236
    v_mul_f32 v37, v37, v236
    v_mul_f32 v38, v38, v236
    v_mul_f32 v39, v39, v236
    v_mul_f32 v40, v40, v236
    v_mul_f32 v41, v41, v236
    v_mul_f32 v42, v42, v236
    v_mul_f32 v43, v43, v236
    v_mul_f32 v44, v44, v236
    v_mul_f32 v45, v45, v236
    v_mul_f32 v46, v46, v236
    v_mul_f32 v47, v47, v236
    v_mul_f32 v48, v48, v236
    v_mul_f32 v49, v49, v236
    v_mul_f32 v50, v50, v236
    v_mul_f32 v51, v51, v236
    v_mul_f32 v52, v52, v236
    v_mul_f32 v53, v53, v236
    v_mul_f32 v54, v54, v236
    v_mul_f32 v55, v55, v236
    v_mul_f32 v56, v56, v236
    v_mul_f32 v57, v57, v236
    v_mul_f32 v58, v58, v236
    v_mul_f32 v59, v59, v236
    v_mul_f32 v60, v60, v236
    v_mul_f32 v61, v61, v236
    v_mul_f32 v62, v62, v236
    v_mul_f32 v63, v63, v236
    v_mul_f32 v233, v233, v236
    v_sub_f32 v96, v80, v235
    v_sub_f32 v97, v81, v235
    v_sub_f32 v98, v82, v235
    v_sub_f32 v99, v83, v235
    v_sub_f32 v100, v84, v235
    v_sub_f32 v101, v85, v235
    v_sub_f32 v102, v86, v235
    v_sub_f32 v103, v87, v235
    v_sub_f32 v104, v88, v235
    v_sub_f32 v105, v89, v235
    v_sub_f32 v106, v90, v235
    v_sub_f32 v107, v91, v235
    v_sub_f32 v108, v92, v235
    v_sub_f32 v109, v93, v235
    v_sub_f32 v110, v94, v235
    v_sub_f32 v111, v95, v235
    v_exp_f32 v96, v96
    v_exp_f32 v97, v97
    v_exp_f32 v98, v98
    v_exp_f32 v99, v99
    v_exp_f32 v100, v100
    v_exp_f32 v101, v101
    v_exp_f32 v102, v102
    v_exp_f32 v103, v103
    v_exp_f32 v104, v104
    v_exp_f32 v105, v105
    v_exp_f32 v106, v106
    v_exp_f32 v107, v107
    v_exp_f32 v108, v108
    v_exp_f32 v109, v109
    v_exp_f32 v110, v110
    v_exp_f32 v111, v111
    v_cvt_pk_bf16_f32 v120, v96, v97
    v_cvt_pk_bf16_f32 v121, v98, v99
    v_cvt_pk_bf16_f32 v122, v100, v101
    v_cvt_pk_bf16_f32 v123, v102, v103
    v_cvt_pk_bf16_f32 v124, v104, v105
    v_cvt_pk_bf16_f32 v125, v106, v107
    v_cvt_pk_bf16_f32 v126, v108, v109
    v_cvt_pk_bf16_f32 v127, v110, v111
    v_add_f32 v234, v96, v97
    v_add_f32 v234, v234, v98
    v_add_f32 v234, v234, v99
    v_add_f32 v234, v234, v100
    v_add_f32 v234, v234, v101
    v_add_f32 v234, v234, v102
    v_add_f32 v234, v234, v103
    v_add_f32 v234, v234, v104
    v_add_f32 v234, v234, v105
    v_add_f32 v234, v234, v106
    v_add_f32 v234, v234, v107
    v_add_f32 v234, v234, v108
    v_add_f32 v234, v234, v109
    v_add_f32 v234, v234, v110
    v_add_f32 v234, v234, v111
    s_nop 1
    s_branch k2_sback15
k2_mask16:
    s_nop 7
    s_nop 7
    s_lshl_b32 s38, s45, 6
    v_add_u32 v240, s38, v231
    v_cmp_gt_i32 s[56:57], 32, v240
    s_nop 1
    v_cndmask_b32 v80, v160, v232, s[56:57]
    v_cmp_gt_i32 s[56:57], 33, v240
    s_nop 1
    v_cndmask_b32 v81, v161, v232, s[56:57]
    v_cmp_gt_i32 s[56:57], 34, v240
    s_nop 1
    v_cndmask_b32 v82, v162, v232, s[56:57]
    v_cmp_gt_i32 s[56:57], 35, v240
    s_nop 1
    v_cndmask_b32 v83, v163, v232, s[56:57]
    v_cmp_gt_i32 s[56:57], 40, v240
    s_nop 1
    v_cndmask_b32 v84, v164, v232, s[56:57]
    v_cmp_gt_i32 s[56:57], 41, v240
    s_nop 1
    v_cndmask_b32 v85, v165, v232, s[56:57]
    v_cmp_gt_i32 s[56:57], 42, v240
    s_nop 1
    v_cndmask_b32 v86, v166, v232, s[56:57]
    v_cmp_gt_i32 s[56:57], 43, v240
    s_nop 1
    v_cndmask_b32 v87, v167, v232, s[56:57]
    v_cmp_gt_i32 s[56:57], 48, v240
    s_nop 1
    v_cndmask_b32 v88, v168, v232, s[56:57]
    v_cmp_gt_i32 s[56:57], 49, v240
    s_nop 1
    v_cndmask_b32 v89, v169, v232, s[56:57]
    v_cmp_gt_i32 s[56:57], 50, v240
    s_nop 1
    v_cndmask_b32 v90, v170, v232, s[56:57]
    v_cmp_gt_i32 s[56:57], 51, v240
    s_nop 1
    v_cndmask_b32 v91, v171, v232, s[56:57]
    v_cmp_gt_i32 s[56:57], 56, v240
    s_nop 1
    v_cndmask_b32 v92, v172, v232, s[56:57]
    v_cmp_gt_i32 s[56:57], 57, v240
    s_nop 1
    v_cndmask_b32 v93, v173, v232, s[56:57]
    v_cmp_gt_i32 s[56:57], 58, v240
    s_nop 1
    v_cndmask_b32 v94, v174, v232, s[56:57]
    v_cmp_gt_i32 s[56:57], 59, v240
    s_nop 1
    v_cndmask_b32 v95, v175, v232, s[56:57]
    s_nop 1
    v_mfma_f32_32x32x16_bf16 v[80:95], v[176:179], v[128:131], v[80:95]
    s_branch k2_mback16
k2_slow17:
    s_nop 7
    s_nop 7
    v_max3_f32 v235, v64, v65, v66
    v_max3_f32 v235, v235, v67, v68
    v_max3_f32 v235, v235, v69, v70
    v_max3_f32 v235, v235, v71, v72
    v_max3_f32 v235, v235, v73, v74
    v_max3_f32 v235, v235, v75, v76
    v_max3_f32 v235, v235, v77, v78
    v_max_f32 v235, v235, v79
    v_mov_b32 v236, v235
    s_nop 1
    v_permlane32_swap_b32 v236, v235
    v_max_f32 v235, v235, v236
    v_max_f32 v235, 0, v235
    v_exp_f32 v236, -v235
    v_sub_f32 v160, v160, v235
    v_sub_f32 v161, v161, v235
    v_sub_f32 v162, v162, v235
    v_sub_f32 v163, v163, v235
    v_sub_f32 v164, v164, v235
    v_sub_f32 v165, v165, v235
    v_sub_f32 v166, v166, v235
    v_sub_f32 v167, v167, v235
    v_sub_f32 v168, v168, v235
    v_sub_f32 v169, v169, v235
    v_sub_f32 v170, v170, v235
    v_sub_f32 v171, v171, v235
    v_sub_f32 v172, v172, v235
    v_sub_f32 v173, v173, v235
    v_sub_f32 v174, v174, v235
    v_sub_f32 v175, v175, v235
    v_sub_f32 v80, v80, v235
    v_sub_f32 v81, v81, v235
    v_sub_f32 v82, v82, v235
    v_sub_f32 v83, v83, v235
    v_sub_f32 v84, v84, v235
    v_sub_f32 v85, v85, v235
    v_sub_f32 v86, v86, v235
    v_sub_f32 v87, v87, v235
    v_sub_f32 v88, v88, v235
    v_sub_f32 v89, v89, v235
    v_sub_f32 v90, v90, v235
    v_sub_f32 v91, v91, v235
    v_sub_f32 v92, v92, v235
    v_sub_f32 v93, v93, v235
    v_sub_f32 v94, v94, v235
    v_sub_f32 v95, v95, v235
    v_mul_f32 v0, v0, v236
    v_mul_f32 v1, v1, v236
    v_mul_f32 v2, v2, v236
    v_mul_f32 v3, v3, v236
    v_mul_f32 v4, v4, v236
    v_mul_f32 v5, v5, v236
    v_mul_f32 v6, v6, v236
    v_mul_f32 v7, v7, v236
    v_mul_f32 v8, v8, v236
    v_mul_f32 v9, v9, v236
    v_mul_f32 v10, v10, v236
    v_mul_f32 v11, v11, v236
    v_mul_f32 v12, v12, v236
    v_mul_f32 v13, v13, v236
    v_mul_f32 v14, v14, v236
    v_mul_f32 v15, v15, v236
    v_mul_f32 v16, v16, v236
    v_mul_f32 v17, v17, v236
    v_mul_f32 v18, v18, v236
    v_mul_f32 v19, v19, v236
    v_mul_f32 v20, v20, v236
    v_mul_f32 v21, v21, v236
    v_mul_f32 v22, v22, v236
    v_mul_f32 v23, v23, v236
    v_mul_f32 v24, v24, v236
    v_mul_f32 v25, v25, v236
    v_mul_f32 v26, v26, v236
    v_mul_f32 v27, v27, v236
    v_mul_f32 v28, v28, v236
    v_mul_f32 v29, v29, v236
    v_mul_f32 v30, v30, v236
    v_mul_f32 v31, v31, v236
    v_mul_f32 v32, v32, v236
    v_mul_f32 v33, v33, v236
    v_mul_f32 v34, v34, v236
    v_mul_f32 v35, v35, v236
    v_mul_f32 v36, v36, v236
    v_mul_f32 v37, v37, v236
    v_mul_f32 v38, v38, v236
    v_mul_f32 v39, v39, v236
    v_mul_f32 v40, v40, v236
    v_mul_f32 v41, v41, v236
    v_mul_f32 v42, v42, v236
    v_mul_f32 v43, v43, v236
    v_mul_f32 v44, v44, v236
    v_mul_f32 v45, v45, v236
    v_mul_f32 v46, v46, v236
    v_mul_f32 v47, v47, v236
    v_mul_f32 v48, v48, v236
    v_mul_f32 v49, v49, v236
    v_mul_f32 v50, v50, v236
    v_mul_f32 v51, v51, v236
    v_mul_f32 v52, v52, v236
    v_mul_f32 v53, v53, v236
    v_mul_f32 v54, v54, v236
    v_mul_f32 v55, v55, v236
    v_mul_f32 v56, v56, v236
    v_mul_f32 v57, v57, v236
    v_mul_f32 v58, v58, v236
    v_mul_f32 v59, v59, v236
    v_mul_f32 v60, v60, v236
    v_mul_f32 v61, v61, v236
    v_mul_f32 v62, v62, v236
    v_mul_f32 v63, v63, v236
    v_mul_f32 v233, v233, v236
    v_sub_f32 v96, v64, v235
    v_sub_f32 v97, v65, v235
    v_sub_f32 v98, v66, v235
    v_sub_f32 v99, v67, v235
    v_sub_f32 v100, v68, v235
    v_sub_f32 v101, v69, v235
    v_sub_f32 v102, v70, v235
    v_sub_f32 v103, v71, v235
    v_sub_f32 v104, v72, v235
    v_sub_f32 v105, v73, v235
    v_sub_f32 v106, v74, v235
    v_sub_f32 v107, v75, v235
    v_sub_f32 v108, v76, v235
    v_sub_f32 v109, v77, v235
    v_sub_f32 v110, v78, v235
    v_sub_f32 v111, v79, v235
    v_exp_f32 v96, v96
    v_exp_f32 v97, v97
    v_exp_f32 v98, v98
    v_exp_f32 v99, v99
    v_exp_f32 v100, v100
    v_exp_f32 v101, v101
    v_exp_f32 v102, v102
    v_exp_f32 v103, v103
    v_exp_f32 v104, v104
    v_exp_f32 v105, v105
    v_exp_f32 v106, v106
    v_exp_f32 v107, v107
    v_exp_f32 v108, v108
    v_exp_f32 v109, v109
    v_exp_f32 v110, v110
    v_exp_f32 v111, v111
    v_cvt_pk_bf16_f32 v112, v96, v97
    v_cvt_pk_bf16_f32 v113, v98, v99
    v_cvt_pk_bf16_f32 v114, v100, v101
    v_cvt_pk_bf16_f32 v115, v102, v103
    v_cvt_pk_bf16_f32 v116, v104, v105
    v_cvt_pk_bf16_f32 v117, v106, v107
    v_cvt_pk_bf16_f32 v118, v108, v109
    v_cvt_pk_bf16_f32 v119, v110, v111
    v_add_f32 v234, v96, v97
    v_add_f32 v234, v234, v98
    v_add_f32 v234, v234, v99
    v_add_f32 v234, v234, v100
    v_add_f32 v234, v234, v101
    v_add_f32 v234, v234, v102
    v_add_f32 v234, v234, v103
    v_add_f32 v234, v234, v104
    v_add_f32 v234, v234, v105
    v_add_f32 v234, v234, v106
    v_add_f32 v234, v234, v107
    v_add_f32 v234, v234, v108
    v_add_f32 v234, v234, v109
    v_add_f32 v234, v234, v110
    v_add_f32 v234, v234, v111
    s_nop 1
    s_branch k2_sback17
k2_slow18:
    s_nop 7
    s_nop 7
    v_max3_f32 v235, v80, v81, v82
    v_max3_f32 v235, v235, v83, v84
    v_max3_f32 v235, v235, v85, v86
    v_max3_f32 v235, v235, v87, v88
    v_max3_f32 v235, v235, v89, v90
    v_max3_f32 v235, v235, v91, v92
    v_max3_f32 v235, v235, v93, v94
    v_max_f32 v235, v235, v95
    v_mov_b32 v236, v235
    s_nop 1
    v_permlane32_swap_b32 v236, v235
    v_max_f32 v235, v235, v236
    v_max_f32 v235, 0, v235
    v_exp_f32 v236, -v235
    v_sub_f32 v160, v160, v235
    v_sub_f32 v161, v161, v235
    v_sub_f32 v162, v162, v235
    v_sub_f32 v163, v163, v235
    v_sub_f32 v164, v164, v235
    v_sub_f32 v165, v165, v235
    v_sub_f32 v166, v166, v235
    v_sub_f32 v167, v167, v235
    v_sub_f32 v168, v168, v235
    v_sub_f32 v169, v169, v235
    v_sub_f32 v170, v170, v235
    v_sub_f32 v171, v171, v235
    v_sub_f32 v172, v172, v235
    v_sub_f32 v173, v173, v235
    v_sub_f32 v174, v174, v235
    v_sub_f32 v175, v175, v235
    v_mul_f32 v0, v0, v236
    v_mul_f32 v1, v1, v236
    v_mul_f32 v2, v2, v236
    v_mul_f32 v3, v3, v236
    v_mul_f32 v4, v4, v236
    v_mul_f32 v5, v5, v236
    v_mul_f32 v6, v6, v236
    v_mul_f32 v7, v7, v236
    v_mul_f32 v8, v8, v236
    v_mul_f32 v9, v9, v236
    v_mul_f32 v10, v10, v236
    v_mul_f32 v11, v11, v236
    v_mul_f32 v12, v12, v236
    v_mul_f32 v13, v13, v236
    v_mul_f32 v14, v14, v236
    v_mul_f32 v15, v15, v236
    v_mul_f32 v16, v16, v236
    v_mul_f32 v17, v17, v236
    v_mul_f32 v18, v18, v236
    v_mul_f32 v19, v19, v236
    v_mul_f32 v20, v20, v236
    v_mul_f32 v21, v21, v236
    v_mul_f32 v22, v22, v236
    v_mul_f32 v23, v23, v236
    v_mul_f32 v24, v24, v236
    v_mul_f32 v25, v25, v236
    v_mul_f32 v26, v26, v236
    v_mul_f32 v27, v27, v236
    v_mul_f32 v28, v28, v236
    v_mul_f32 v29, v29, v236
    v_mul_f32 v30, v30, v236
    v_mul_f32 v31, v31, v236
    v_mul_f32 v32, v32, v236
    v_mul_f32 v33, v33, v236
    v_mul_f32 v34, v34, v236
    v_mul_f32 v35, v35, v236
    v_mul_f32 v36, v36, v236
    v_mul_f32 v37, v37, v236
    v_mul_f32 v38, v38, v236
    v_mul_f32 v39, v39, v236
    v_mul_f32 v40, v40, v236
    v_mul_f32 v41, v41, v236
    v_mul_f32 v42, v42, v236
    v_mul_f32 v43, v43, v236
    v_mul_f32 v44, v44, v236
    v_mul_f32 v45, v45, v236
    v_mul_f32 v46, v46, v236
    v_mul_f32 v47, v47, v236
    v_mul_f32 v48, v48, v236
    v_mul_f32 v49, v49, v236
    v_mul_f32 v50, v50, v236
    v_mul_f32 v51, v51, v236
    v_mul_f32 v52, v52, v236
    v_mul_f32 v53, v53, v236
    v_mul_f32 v54, v54, v236
    v_mul_f32 v55, v55, v236
    v_mul_f32 v56, v56, v236
    v_mul_f32 v57, v57, v236
    v_mul_f32 v58, v58, v236
    v_mul_f32 v59, v59, v236
    v_mul_f32 v60, v60, v236
    v_mul_f32 v61, v61, v236
    v_mul_f32 v62, v62, v236
    v_mul_f32 v63, v63, v236
    v_mul_f32 v233, v233, v236
    v_sub_f32 v96, v80, v235
    v_sub_f32 v97, v81, v235
    v_sub_f32 v98, v82, v235
    v_sub_f32 v99, v83, v235
    v_sub_f32 v100, v84, v235
    v_sub_f32 v101, v85, v235
    v_sub_f32 v102, v86, v235
    v_sub_f32 v103, v87, v235
    v_sub_f32 v104, v88, v235
    v_sub_f32 v105, v89, v235
    v_sub_f32 v106, v90, v235
    v_sub_f32 v107, v91, v235
    v_sub_f32 v108, v92, v235
    v_sub_f32 v109, v93, v235
    v_sub_f32 v110, v94, v235
    v_sub_f32 v111, v95, v235
    v_exp_f32 v96, v96
    v_exp_f32 v97, v97
    v_exp_f32 v98, v98
    v_exp_f32 v99, v99
    v_exp_f32 v100, v100
    v_exp_f32 v101, v101
    v_exp_f32 v102, v102
    v_exp_f32 v103, v103
    v_exp_f32 v104, v104
    v_exp_f32 v105, v105
    v_exp_f32 v106, v106
    v_exp_f32 v107, v107
    v_exp_f32 v108, v108
    v_exp_f32 v109, v109
    v_exp_f32 v110, v110
    v_exp_f32 v111, v111
    v_cvt_pk_bf16_f32 v120, v96, v97
    v_cvt_pk_bf16_f32 v121, v98, v99
    v_cvt_pk_bf16_f32 v122, v100, v101
    v_cvt_pk_bf16_f32 v123, v102, v103
    v_cvt_pk_bf16_f32 v124, v104, v105
    v_cvt_pk_bf16_f32 v125, v106, v107
    v_cvt_pk_bf16_f32 v126, v108, v109
    v_cvt_pk_bf16_f32 v127, v110, v111
    v_add_f32 v234, v96, v97
    v_add_f32 v234, v234, v98
    v_add_f32 v234, v234, v99
    v_add_f32 v234, v234, v100
    v_add_f32 v234, v234, v101
    v_add_f32 v234, v234, v102
    v_add_f32 v234, v234, v103
    v_add_f32 v234, v234, v104
    v_add_f32 v234, v234, v105
    v_add_f32 v234, v234, v106
    v_add_f32 v234, v234, v107
    v_add_f32 v234, v234, v108
    v_add_f32 v234, v234, v109
    v_add_f32 v234, v234, v110
    v_add_f32 v234, v234, v111
    s_nop 1
    s_branch k2_sback18
k2_fin:
    s_add_u32 s56, s47, s50
    s_add_u32 s57, s56, 0x1c000
    s_lshl_b32 s58, s50, 1
    s_add_u32 s58, s58, s48
    s_add_u32 s50, s50, 16384
    s_cmp_eq_u32 s50, 114688
    s_cselect_b32 s50, 0, s50
    buffer_load_dwordx4 v[160:163], v225, s[80:83], s56 offen offset:0
    buffer_load_dwordx4 v[164:167], v225, s[80:83], s56 offen offset:256
    buffer_load_dwordx4 v[168:171], v225, s[80:83], s57 offen offset:0
    buffer_load_dwordx4 v[172:175], v225, s[80:83], s57 offen offset:256
    buffer_load_dwordx4 v[176:179], v225, s[68:71], s58 offen offset:0
    buffer_load_dwordx4 v[180:183], v225, s[68:71], s58 offen offset:256
    buffer_load_dwordx4 v[184:187], v225, s[68:71], s58 offen offset:2048
    buffer_load_dwordx4 v[188:191], v225, s[68:71], s58 offen offset:2304
    s_add_u32 s76, s47, s50
    s_add_u32 s77, s76, 0x1c000
    s_lshl_b32 s78, s50, 1
    s_add_u32 s78, s78, s48
    s_add_u32 s50, s50, 16384
    s_cmp_eq_u32 s50, 114688
    s_cselect_b32 s50, 0, s50
    buffer_load_dwordx4 v[64:67], v225, s[80:83], s76 offen offset:0
    buffer_load_dwordx4 v[68:71], v225, s[80:83], s76 offen offset:256
    buffer_load_dwordx4 v[72:75], v225, s[80:83], s77 offen offset:0
    buffer_load_dwordx4 v[76:79], v225, s[80:83], s77 offen offset:256
    buffer_load_dwordx4 v[80:83], v225, s[68:71], s78 offen offset:0
    buffer_load_dwordx4 v[84:87], v225, s[68:71], s78 offen offset:256
    buffer_load_dwordx4 v[88:91], v225, s[68:71], s78 offen offset:2048
    buffer_load_dwordx4 v[92:95], v225, s[68:71], s78 offen offset:2304
    v_lshrrev_b32 v244, 4, v224
    v_and_b32 v245, 15, v224
    s_mov_b32 s60, s8
    s_mov_b32 s61, s9
    s_mov_b32 s62, 0x200000
    s_mov_b32 s63, 0x00020000
    s_mov_b32 s72, s28
    s_mov_b32 s73, s29
    s_mov_b32 s74, 0x200000
    s_mov_b32 s75, 0x00020000
    v_lshlrev_b32 v229, 10, v245
    v_lshl_add_u32 v229, v244, 3, v229
    s_lshl_b32 s37, s44, 16
    s_lshr_b32 s38, s34, 1
    s_lshl_b32 s38, s38, 14
    s_add_u32 s37, s37, s38
    s_lshl_b32 s38, s45, 7
    s_add_u32 s37, s37, s38
    s_and_b32 s38, s34, 1
    s_lshl_b32 s38, s38, 6
    s_add_u32 s37, s37, s38
    v_add_u32 v229, s37, v229
    v_lshlrev_b32 v244, 4, v224
    s_lshl_b32 s37, s34, 14
    v_add_u32 v226, s37, v244
    s_lshl_b32 s37, s34, 11
    v_add_u32 v227, s37, v244
    v_add_u32 v228, 65536, v227
    s_waitcnt vmcnt(36)
    v_mfma_f32_16x16x32_bf16 v[0:3], v[112:115], v[96:99], 0
    v_mfma_f32_16x16x32_bf16 v[4:7], v[116:119], v[96:99], 0
    v_mfma_f32_16x16x32_bf16 v[16:19], v[112:115], v[100:103], 0
    v_mfma_f32_16x16x32_bf16 v[20:23], v[116:119], v[100:103], 0
    v_mfma_f32_16x16x32_bf16 v[8:11], v[120:123], v[96:99], 0
    v_mfma_f32_16x16x32_bf16 v[12:15], v[124:127], v[96:99], 0
    s_add_u32 s56, s47, s50
    s_add_u32 s57, s56, 0x1c000
    s_lshl_b32 s58, s50, 1
    s_add_u32 s58, s58, s48
    s_add_u32 s50, s50, 16384
    s_cmp_eq_u32 s50, 114688
    s_cselect_b32 s50, 0, s50
    buffer_load_dwordx4 v[96:99], v225, s[80:83], s56 offen offset:0
    v_mfma_f32_16x16x32_bf16 v[24:27], v[120:123], v[100:103], 0
    v_mfma_f32_16x16x32_bf16 v[28:31], v[124:127], v[100:103], 0
    buffer_load_dwordx4 v[100:103], v225, s[80:83], s56 offen offset:256
    v_mfma_f32_16x16x32_bf16 v[32:35], v[112:115], v[104:107], 0
    v_mfma_f32_16x16x32_bf16 v[48:51], v[112:115], v[108:111], 0
    buffer_load_dwordx4 v[112:115], v225, s[68:71], s58 offen offset:0
    v_mfma_f32_16x16x32_bf16 v[36:39], v[116:119], v[104:107], 0
    v_mfma_f32_16x16x32_bf16 v[52:55], v[116:119], v[108:111], 0
    buffer_load_dwordx4 v[116:119], v225, s[68:71], s58 offen offset:256
    v_mfma_f32_16x16x32_bf16 v[40:43], v[120:123], v[104:107], 0
    v_mfma_f32_16x16x32_bf16 v[44:47], v[124:127], v[104:107], 0
    buffer_load_dwordx4 v[104:107], v225, s[80:83], s57 offen offset:0
    v_mfma_f32_16x16x32_bf16 v[56:59], v[120:123], v[108:111], 0
    buffer_load_dwordx4 v[120:123], v225, s[68:71], s58 offen offset:2048
    v_mfma_f32_16x16x32_bf16 v[60:63], v[124:127], v[108:111], 0
    buffer_load_dwordx4 v[108:111], v225, s[80:83], s57 offen offset:256
    buffer_load_dwordx4 v[124:127], v225, s[68:71], s58 offen offset:2304
    s_waitcnt vmcnt(36)
    v_mfma_f32_16x16x32_bf16 v[0:3], v[144:147], v[128:131], v[0:3]
    v_mfma_f32_16x16x32_bf16 v[4:7], v[148:151], v[128:131], v[4:7]
    v_mfma_f32_16x16x32_bf16 v[16:19], v[144:147], v[132:135], v[16:19]
    v_mfma_f32_16x16x32_bf16 v[20:23], v[148:151], v[132:135], v[20:23]
    v_mfma_f32_16x16x32_bf16 v[8:11], v[152:155], v[128:131], v[8:11]
    v_mfma_f32_16x16x32_bf16 v[12:15], v[156:159], v[128:131], v[12:15]
    s_add_u32 s76, s47, s50
    s_add_u32 s77, s76, 0x1c000
    s_lshl_b32 s78, s50, 1
    s_add_u32 s78, s78, s48
    s_add_u32 s50, s50, 16384
    s_cmp_eq_u32 s50, 114688
    s_cselect_b32 s50, 0, s50
    s_sub_u32 s48, s48, 524288
    buffer_load_dwordx4 v[128:131], v225, s[80:83], s76 offen offset:0
    v_mfma_f32_16x16x32_bf16 v[24:27], v[152:155], v[132:135], v[24:27]
    v_mfma_f32_16x16x32_bf16 v[28:31], v[156:159], v[132:135], v[28:31]
    buffer_load_dwordx4 v[132:135], v225, s[80:83], s76 offen offset:256
    v_mfma_f32_16x16x32_bf16 v[32:35], v[144:147], v[136:139], v[32:35]
    v_mfma_f32_16x16x32_bf16 v[48:51], v[144:147], v[140:143], v[48:51]
    buffer_load_dwordx4 v[144:147], v225, s[68:71], s78 offen offset:0
    v_mfma_f32_16x16x32_bf16 v[36:39], v[148:151], v[136:139], v[36:39]
    v_mfma_f32_16x16x32_bf16 v[52:55], v[148:151], v[140:143], v[52:55]
    buffer_load_dwordx4 v[148:151], v225, s[68:71], s78 offen offset:256
    v_mfma_f32_16x16x32_bf16 v[40:43], v[152:155], v[136:139], v[40:43]
    v_mfma_f32_16x16x32_bf16 v[44:47], v[156:159], v[136:139], v[44:47]
    buffer_load_dwordx4 v[136:139], v225, s[80:83], s77 offen offset:0
    v_mfma_f32_16x16x32_bf16 v[56:59], v[152:155], v[140:143], v[56:59]
    buffer_load_dwordx4 v[152:155], v225, s[68:71], s78 offen offset:2048
    v_mfma_f32_16x16x32_bf16 v[60:63], v[156:159], v[140:143], v[60:63]
    buffer_load_dwordx4 v[140:143], v225, s[80:83], s77 offen offset:256
    buffer_load_dwordx4 v[156:159], v225, s[68:71], s78 offen offset:2304
    s_waitcnt vmcnt(32)
    s_barrier
    s_cmp_lg_u32 s34, 0
    s_cbranch_scc1 k3_w1
    v_lshlrev_b32 v244, 9, v224
    v_mov_b32 v246, 1
    v_mov_b32 v247, 1
    s_mov_b64 exec, 15
    buffer_store_dwordx2 v[246:247], v244, s[84:87], s3 offen sc1
    s_mov_b64 exec, -1
k3_w1:
    v_mfma_f32_16x16x32_bf16 v[0:3], v[208:211], v[192:195], v[0:3]
    v_mfma_f32_16x16x32_bf16 v[4:7], v[212:215], v[192:195], v[4:7]
    v_mfma_f32_16x16x32_bf16 v[16:19], v[208:211], v[196:199], v[16:19]
    v_mfma_f32_16x16x32_bf16 v[20:23], v[212:215], v[196:199], v[20:23]
    v_mfma_f32_16x16x32_bf16 v[8:11], v[216:219], v[192:195], v[8:11]
    v_mfma_f32_16x16x32_bf16 v[12:15], v[220:223], v[192:195], v[12:15]
    v_mfma_f32_16x16x32_bf16 v[24:27], v[216:219], v[196:199], v[24:27]
    v_mfma_f32_16x16x32_bf16 v[28:31], v[220:223], v[196:199], v[28:31]
    v_mfma_f32_16x16x32_bf16 v[32:35], v[208:211], v[200:203], v[32:35]
    v_mfma_f32_16x16x32_bf16 v[48:51], v[208:211], v[204:207], v[48:51]
    s_add_u32 s56, s46, s49
    s_add_u32 s57, s56, 0x40000
    s_lshl_b32 s58, s49, 1
    s_add_u32 s58, s58, s48
    s_add_u32 s49, s49, 16384
    s_and_b32 s49, s49, 0x3ffff
    buffer_load_dwordx4 v[208:211], v225, s[68:71], s58 offen offset:0
    v_mfma_f32_16x16x32_bf16 v[36:39], v[212:215], v[200:203], v[36:39]
    v_mfma_f32_16x16x32_bf16 v[52:55], v[212:215], v[204:207], v[52:55]
    buffer_load_dwordx4 v[212:215], v225, s[68:71], s58 offen offset:256
    v_mfma_f32_16x16x32_bf16 v[40:43], v[216:219], v[200:203], v[40:43]
    v_mfma_f32_16x16x32_bf16 v[44:47], v[220:223], v[200:203], v[44:47]
    v_mfma_f32_16x16x32_bf16 v[56:59], v[216:219], v[204:207], v[56:59]
    buffer_load_dwordx4 v[216:219], v225, s[68:71], s58 offen offset:2048
    v_mfma_f32_16x16x32_bf16 v[60:63], v[220:223], v[204:207], v[60:63]
    buffer_load_dwordx4 v[220:223], v225, s[68:71], s58 offen offset:2304
    s_waitcnt vmcnt(28)
    v_mfma_f32_16x16x32_bf16 v[0:3], v[176:179], v[160:163], v[0:3]
    v_mfma_f32_16x16x32_bf16 v[4:7], v[180:183], v[160:163], v[4:7]
    v_mfma_f32_16x16x32_bf16 v[16:19], v[176:179], v[164:167], v[16:19]
    v_mfma_f32_16x16x32_bf16 v[20:23], v[180:183], v[164:167], v[20:23]
    v_mfma_f32_16x16x32_bf16 v[8:11], v[184:187], v[160:163], v[8:11]
    v_mfma_f32_16x16x32_bf16 v[12:15], v[188:191], v[160:163], v[12:15]
    v_mfma_f32_16x16x32_bf16 v[24:27], v[184:187], v[164:167], v[24:27]
    v_mfma_f32_16x16x32_bf16 v[28:31], v[188:191], v[164:167], v[28:31]
    v_mfma_f32_16x16x32_bf16 v[32:35], v[176:179], v[168:171], v[32:35]
    v_mfma_f32_16x16x32_bf16 v[48:51], v[176:179], v[172:175], v[48:51]
    s_add_u32 s76, s46, s49
    s_add_u32 s77, s76, 0x40000
    s_lshl_b32 s78, s49, 1
    s_add_u32 s78, s78, s48
    s_add_u32 s49, s49, 16384
    s_and_b32 s49, s49, 0x3ffff
    buffer_load_dwordx4 v[176:179], v225, s[68:71], s78 offen offset:0
    v_mfma_f32_16x16x32_bf16 v[36:39], v[180:183], v[168:171], v[36:39]
    v_mfma_f32_16x16x32_bf16 v[52:55], v[180:183], v[172:175], v[52:55]
    buffer_load_dwordx4 v[180:183], v225, s[68:71], s78 offen offset:256
    v_mfma_f32_16x16x32_bf16 v[40:43], v[184:187], v[168:171], v[40:43]
    v_mfma_f32_16x16x32_bf16 v[44:47], v[188:191], v[168:171], v[44:47]
    v_mfma_f32_16x16x32_bf16 v[56:59], v[184:187], v[172:175], v[56:59]
    buffer_load_dwordx4 v[184:187], v225, s[68:71], s78 offen offset:2048
    v_mfma_f32_16x16x32_bf16 v[60:63], v[188:191], v[172:175], v[60:63]
    buffer_load_dwordx4 v[188:191], v225, s[68:71], s78 offen offset:2304
    s_cmp_lg_u32 s34, 0
    s_cbranch_scc1 k3_w2
    s_mov_b32 s51, 49152
    s_lshr_b32 s37, s44, 1
    s_sub_u32 s38, 15, s37
    s_min_u32 s37, s37, s38
    s_lshl_b32 s37, s37, 11
    s_and_b32 s38, s45, 3
    s_lshl_b32 s38, s38, 9
    s_add_u32 s37, s37, s38
    s_cmp_lt_u32 s44, 16
    s_cselect_b32 s38, 49156, s51
    s_add_u32 s37, s37, s38
    v_and_b32 v244, 31, v224
    v_lshlrev_b32 v244, 4, v244
    s_mov_b32 s38, 131072
k3_spin:
    buffer_load_dword v245, v244, s[84:87], s37 offen sc1
    s_waitcnt vmcnt(0)
    v_cmp_ne_u32 vcc, 1, v245
    s_sub_u32 s38, s38, 1
    s_nop 3
    s_cbranch_scc1 k3_w2
    s_cbranch_vccz k3_w2
    s_sleep 4
    s_branch k3_spin
k3_w2:
    s_barrier
    buffer_load_dwordx4 v[192:195], v225, s[64:67], s56 offen offset:0
    buffer_load_dwordx4 v[196:199], v225, s[64:67], s56 offen offset:256
    buffer_load_dwordx4 v[200:203], v225, s[64:67], s57 offen offset:0
    buffer_load_dwordx4 v[204:207], v225, s[64:67], s57 offen offset:256
    buffer_load_dwordx4 v[160:163], v225, s[64:67], s76 offen offset:0
    buffer_load_dwordx4 v[164:167], v225, s[64:67], s76 offen offset:256
    buffer_load_dwordx4 v[168:171], v225, s[64:67], s77 offen offset:0
    buffer_load_dwordx4 v[172:175], v225, s[64:67], s77 offen offset:256
    s_waitcnt vmcnt(32)
    v_mfma_f32_16x16x32_bf16 v[0:3], v[80:83], v[64:67], v[0:3]
    v_mfma_f32_16x16x32_bf16 v[4:7], v[84:87], v[64:67], v[4:7]
    v_mfma_f32_16x16x32_bf16 v[16:19], v[80:83], v[68:71], v[16:19]
    v_mfma_f32_16x16x32_bf16 v[20:23], v[84:87], v[68:71], v[20:23]
    v_mfma_f32_16x16x32_bf16 v[8:11], v[88:91], v[64:67], v[8:11]
    v_mfma_f32_16x16x32_bf16 v[12:15], v[92:95], v[64:67], v[12:15]
    s_add_u32 s56, s46, s49
    s_add_u32 s57, s56, 0x40000
    s_lshl_b32 s58, s49, 1
    s_add_u32 s58, s58, s48
    s_add_u32 s49, s49, 16384
    s_and_b32 s49, s49, 0x3ffff
    buffer_load_dwordx4 v[64:67], v225, s[64:67], s56 offen offset:0
    v_mfma_f32_16x16x32_bf16 v[24:27], v[88:91], v[68:71], v[24:27]
    v_mfma_f32_16x16x32_bf16 v[28:31], v[92:95], v[68:71], v[28:31]
    buffer_load_dwordx4 v[68:71], v225, s[64:67], s56 offen offset:256
    v_mfma_f32_16x16x32_bf16 v[32:35], v[80:83], v[72:75], v[32:35]
    v_mfma_f32_16x16x32_bf16 v[48:51], v[80:83], v[76:79], v[48:51]
    buffer_load_dwordx4 v[80:83], v225, s[68:71], s58 offen offset:0
    v_mfma_f32_16x16x32_bf16 v[36:39], v[84:87], v[72:75], v[36:39]
    v_mfma_f32_16x16x32_bf16 v[52:55], v[84:87], v[76:79], v[52:55]
    buffer_load_dwordx4 v[84:87], v225, s[68:71], s58 offen offset:256
    v_mfma_f32_16x16x32_bf16 v[40:43], v[88:91], v[72:75], v[40:43]
    v_mfma_f32_16x16x32_bf16 v[44:47], v[92:95], v[72:75], v[44:47]
    buffer_load_dwordx4 v[72:75], v225, s[64:67], s57 offen offset:0
    v_mfma_f32_16x16x32_bf16 v[56:59], v[88:91], v[76:79], v[56:59]
    buffer_load_dwordx4 v[88:91], v225, s[68:71], s58 offen offset:2048
    v_mfma_f32_16x16x32_bf16 v[60:63], v[92:95], v[76:79], v[60:63]
    buffer_load_dwordx4 v[76:79], v225, s[64:67], s57 offen offset:256
    buffer_load_dwordx4 v[92:95], v225, s[68:71], s58 offen offset:2304
    s_waitcnt vmcnt(32)
    v_mfma_f32_16x16x32_bf16 v[0:3], v[112:115], v[96:99], v[0:3]
    v_mfma_f32_16x16x32_bf16 v[4:7], v[116:119], v[96:99], v[4:7]
    v_mfma_f32_16x16x32_bf16 v[16:19], v[112:115], v[100:103], v[16:19]
    v_mfma_f32_16x16x32_bf16 v[20:23], v[116:119], v[100:103], v[20:23]
    v_mfma_f32_16x16x32_bf16 v[8:11], v[120:123], v[96:99], v[8:11]
    v_mfma_f32_16x16x32_bf16 v[12:15], v[124:127], v[96:99], v[12:15]
    s_add_u32 s76, s46, s49
    s_add_u32 s77, s76, 0x40000
    s_lshl_b32 s78, s49, 1
    s_add_u32 s78, s78, s48
    s_add_u32 s49, s49, 16384
    s_and_b32 s49, s49, 0x3ffff
    buffer_load_dwordx4 v[96:99], v225, s[64:67], s76 offen offset:0
    v_mfma_f32_16x16x32_bf16 v[24:27], v[120:123], v[100:103], v[24:27]
    v_mfma_f32_16x16x32_bf16 v[28:31], v[124:127], v[100:103], v[28:31]
    buffer_load_dwordx4 v[100:103], v225, s[64:67], s76 offen offset:256
    v_mfma_f32_16x16x32_bf16 v[32:35], v[112:115], v[104:107], v[32:35]
    v_mfma_f32_16x16x32_bf16 v[48:51], v[112:115], v[108:111], v[48:51]
    buffer_load_dwordx4 v[112:115], v225, s[68:71], s78 offen offset:0
    v_mfma_f32_16x16x32_bf16 v[36:39], v[116:119], v[104:107], v[36:39]
    v_mfma_f32_16x16x32_bf16 v[52:55], v[116:119], v[108:111], v[52:55]
    buffer_load_dwordx4 v[116:119], v225, s[68:71], s78 offen offset:256
    v_mfma_f32_16x16x32_bf16 v[40:43], v[120:123], v[104:107], v[40:43]
    v_mfma_f32_16x16x32_bf16 v[44:47], v[124:127], v[104:107], v[44:47]
    buffer_load_dwordx4 v[104:107], v225, s[64:67], s77 offen offset:0
    v_mfma_f32_16x16x32_bf16 v[56:59], v[120:123], v[108:111], v[56:59]
    buffer_load_dwordx4 v[120:123], v225, s[68:71], s78 offen offset:2048
    v_mfma_f32_16x16x32_bf16 v[60:63], v[124:127], v[108:111], v[60:63]
    buffer_load_dwordx4 v[108:111], v225, s[64:67], s77 offen offset:256
    buffer_load_dwordx4 v[124:127], v225, s[68:71], s78 offen offset:2304
    s_waitcnt vmcnt(32)
    v_mfma_f32_16x16x32_bf16 v[0:3], v[144:147], v[128:131], v[0:3]
    v_mfma_f32_16x16x32_bf16 v[4:7], v[148:151], v[128:131], v[4:7]
    v_mfma_f32_16x16x32_bf16 v[16:19], v[144:147], v[132:135], v[16:19]
    v_mfma_f32_16x16x32_bf16 v[20:23], v[148:151], v[132:135], v[20:23]
    v_mfma_f32_16x16x32_bf16 v[8:11], v[152:155], v[128:131], v[8:11]
    v_mfma_f32_16x16x32_bf16 v[12:15], v[156:159], v[128:131], v[12:15]
    s_add_u32 s56, s46, s49
    s_add_u32 s57, s56, 0x40000
    s_lshl_b32 s58, s49, 1
    s_add_u32 s58, s58, s48
    s_add_u32 s49, s49, 16384
    s_and_b32 s49, s49, 0x3ffff
    buffer_load_dwordx4 v[128:131], v225, s[64:67], s56 offen offset:0
    v_mfma_f32_16x16x32_bf16 v[24:27], v[152:155], v[132:135], v[24:27]
    v_mfma_f32_16x16x32_bf16 v[28:31], v[156:159], v[132:135], v[28:31]
    buffer_load_dwordx4 v[132:135], v225, s[64:67], s56 offen offset:256
    v_mfma_f32_16x16x32_bf16 v[32:35], v[144:147], v[136:139], v[32:35]
    v_mfma_f32_16x16x32_bf16 v[48:51], v[144:147], v[140:143], v[48:51]
    buffer_load_dwordx4 v[144:147], v225, s[68:71], s58 offen offset:0
    v_mfma_f32_16x16x32_bf16 v[36:39], v[148:151], v[136:139], v[36:39]
    v_mfma_f32_16x16x32_bf16 v[52:55], v[148:151], v[140:143], v[52:55]
    buffer_load_dwordx4 v[148:151], v225, s[68:71], s58 offen offset:256
    v_mfma_f32_16x16x32_bf16 v[40:43], v[152:155], v[136:139], v[40:43]
    v_mfma_f32_16x16x32_bf16 v[44:47], v[156:159], v[136:139], v[44:47]
    buffer_load_dwordx4 v[136:139], v225, s[64:67], s57 offen offset:0
    v_mfma_f32_16x16x32_bf16 v[56:59], v[152:155], v[140:143], v[56:59]
    buffer_load_dwordx4 v[152:155], v225, s[68:71], s58 offen offset:2048
    v_mfma_f32_16x16x32_bf16 v[60:63], v[156:159], v[140:143], v[60:63]
    buffer_load_dwordx4 v[140:143], v225, s[64:67], s57 offen offset:256
    buffer_load_dwordx4 v[156:159], v225, s[68:71], s58 offen offset:2304
    ds_write_b128 v226, v[0:3] offset:0
    ds_write_b128 v226, v[4:7] offset:1024
    ds_write_b128 v226, v[8:11] offset:2048
    ds_write_b128 v226, v[12:15] offset:3072
    ds_write_b128 v226, v[16:19] offset:4096
    ds_write_b128 v226, v[20:23] offset:5120
    ds_write_b128 v226, v[24:27] offset:6144
    ds_write_b128 v226, v[28:31] offset:7168
    ds_write_b128 v226, v[32:35] offset:8192
    ds_write_b128 v226, v[36:39] offset:9216
    ds_write_b128 v226, v[40:43] offset:10240
    ds_write_b128 v226, v[44:47] offset:11264
    ds_write_b128 v226, v[48:51] offset:12288
    ds_write_b128 v226, v[52:55] offset:13312
    ds_write_b128 v226, v[56:59] offset:14336
    ds_write_b128 v226, v[60:63] offset:15360
    s_waitcnt vmcnt(28)
    s_waitcnt lgkmcnt(0)
    v_mfma_f32_16x16x32_bf16 v[0:3], v[208:211], v[192:195], 0
    v_mfma_f32_16x16x32_bf16 v[4:7], v[212:215], v[192:195], 0
    v_mfma_f32_16x16x32_bf16 v[16:19], v[208:211], v[196:199], 0
    v_mfma_f32_16x16x32_bf16 v[20:23], v[212:215], v[196:199], 0
    v_mfma_f32_16x16x32_bf16 v[8:11], v[216:219], v[192:195], 0
    v_mfma_f32_16x16x32_bf16 v[12:15], v[220:223], v[192:195], 0
    s_add_u32 s76, s46, s49
    s_add_u32 s77, s76, 0x40000
    s_lshl_b32 s78, s49, 1
    s_add_u32 s78, s78, s48
    s_add_u32 s49, s49, 16384
    s_and_b32 s49, s49, 0x3ffff
    buffer_load_dwordx4 v[192:195], v225, s[64:67], s76 offen offset:0
    v_mfma_f32_16x16x32_bf16 v[24:27], v[216:219], v[196:199], 0
    v_mfma_f32_16x16x32_bf16 v[28:31], v[220:223], v[196:199], 0
    buffer_load_dwordx4 v[196:199], v225, s[64:67], s76 offen offset:256
    v_mfma_f32_16x16x32_bf16 v[32:35], v[208:211], v[200:203], 0
    v_mfma_f32_16x16x32_bf16 v[48:51], v[208:211], v[204:207], 0
    buffer_load_dwordx4 v[208:211], v225, s[68:71], s78 offen offset:0
    v_mfma_f32_16x16x32_bf16 v[36:39], v[212:215], v[200:203], 0
    v_mfma_f32_16x16x32_bf16 v[52:55], v[212:215], v[204:207], 0
    buffer_load_dwordx4 v[212:215], v225, s[68:71], s78 offen offset:256
    v_mfma_f32_16x16x32_bf16 v[40:43], v[216:219], v[200:203], 0
    v_mfma_f32_16x16x32_bf16 v[44:47], v[220:223], v[200:203], 0
    buffer_load_dwordx4 v[200:203], v225, s[64:67], s77 offen offset:0
    v_mfma_f32_16x16x32_bf16 v[56:59], v[216:219], v[204:207], 0
    buffer_load_dwordx4 v[216:219], v225, s[68:71], s78 offen offset:2048
    v_mfma_f32_16x16x32_bf16 v[60:63], v[220:223], v[204:207], 0
    buffer_load_dwordx4 v[204:207], v225, s[64:67], s77 offen offset:256
    buffer_load_dwordx4 v[220:223], v225, s[68:71], s78 offen offset:2304
    s_waitcnt vmcnt(32)
    v_mfma_f32_16x16x32_bf16 v[0:3], v[176:179], v[160:163], v[0:3]
    v_mfma_f32_16x16x32_bf16 v[4:7], v[180:183], v[160:163], v[4:7]
    v_mfma_f32_16x16x32_bf16 v[16:19], v[176:179], v[164:167], v[16:19]
    v_mfma_f32_16x16x32_bf16 v[20:23], v[180:183], v[164:167], v[20:23]
    v_mfma_f32_16x16x32_bf16 v[8:11], v[184:187], v[160:163], v[8:11]
    v_mfma_f32_16x16x32_bf16 v[12:15], v[188:191], v[160:163], v[12:15]
    s_add_u32 s56, s46, s49
    s_add_u32 s57, s56, 0x40000
    s_lshl_b32 s58, s49, 1
    s_add_u32 s58, s58, s48
    s_add_u32 s49, s49, 16384
    s_and_b32 s49, s49, 0x3ffff
    buffer_load_dwordx4 v[160:163], v225, s[64:67], s56 offen offset:0
    v_mfma_f32_16x16x32_bf16 v[24:27], v[184:187], v[164:167], v[24:27]
    v_mfma_f32_16x16x32_bf16 v[28:31], v[188:191], v[164:167], v[28:31]
    buffer_load_dwordx4 v[164:167], v225, s[64:67], s56 offen offset:256
    v_mfma_f32_16x16x32_bf16 v[32:35], v[176:179], v[168:171], v[32:35]
    v_mfma_f32_16x16x32_bf16 v[48:51], v[176:179], v[172:175], v[48:51]
    buffer_load_dwordx4 v[176:179], v225, s[68:71], s58 offen offset:0
    v_mfma_f32_16x16x32_bf16 v[36:39], v[180:183], v[168:171], v[36:39]
    v_mfma_f32_16x16x32_bf16 v[52:55], v[180:183], v[172:175], v[52:55]
    buffer_load_dwordx4 v[180:183], v225, s[68:71], s58 offen offset:256
    v_mfma_f32_16x16x32_bf16 v[40:43], v[184:187], v[168:171], v[40:43]
    v_mfma_f32_16x16x32_bf16 v[44:47], v[188:191], v[168:171], v[44:47]
    buffer_load_dwordx4 v[168:171], v225, s[64:67], s57 offen offset:0
    v_mfma_f32_16x16x32_bf16 v[56:59], v[184:187], v[172:175], v[56:59]
    buffer_load_dwordx4 v[184:187], v225, s[68:71], s58 offen offset:2048
    v_mfma_f32_16x16x32_bf16 v[60:63], v[188:191], v[172:175], v[60:63]
    buffer_load_dwordx4 v[172:175], v225, s[64:67], s57 offen offset:256
    buffer_load_dwordx4 v[188:191], v225, s[68:71], s58 offen offset:2304
    s_waitcnt vmcnt(32)
    v_mfma_f32_16x16x32_bf16 v[0:3], v[80:83], v[64:67], v[0:3]
    v_mfma_f32_16x16x32_bf16 v[4:7], v[84:87], v[64:67], v[4:7]
    v_mfma_f32_16x16x32_bf16 v[16:19], v[80:83], v[68:71], v[16:19]
    v_mfma_f32_16x16x32_bf16 v[20:23], v[84:87], v[68:71], v[20:23]
    v_mfma_f32_16x16x32_bf16 v[8:11], v[88:91], v[64:67], v[8:11]
    v_mfma_f32_16x16x32_bf16 v[12:15], v[92:95], v[64:67], v[12:15]
    s_add_u32 s76, s46, s49
    s_add_u32 s77, s76, 0x40000
    s_lshl_b32 s78, s49, 1
    s_add_u32 s78, s78, s48
    s_add_u32 s49, s49, 16384
    s_and_b32 s49, s49, 0x3ffff
    buffer_load_dwordx4 v[64:67], v225, s[64:67], s76 offen offset:0
    v_mfma_f32_16x16x32_bf16 v[24:27], v[88:91], v[68:71], v[24:27]
    v_mfma_f32_16x16x32_bf16 v[28:31], v[92:95], v[68:71], v[28:31]
    buffer_load_dwordx4 v[68:71], v225, s[64:67], s76 offen offset:256
    v_mfma_f32_16x16x32_bf16 v[32:35], v[80:83], v[72:75], v[32:35]
    v_mfma_f32_16x16x32_bf16 v[48:51], v[80:83], v[76:79], v[48:51]
    buffer_load_dwordx4 v[80:83], v225, s[68:71], s78 offen offset:0
    v_mfma_f32_16x16x32_bf16 v[36:39], v[84:87], v[72:75], v[36:39]
    v_mfma_f32_16x16x32_bf16 v[52:55], v[84:87], v[76:79], v[52:55]
    buffer_load_dwordx4 v[84:87], v225, s[68:71], s78 offen offset:256
    v_mfma_f32_16x16x32_bf16 v[40:43], v[88:91], v[72:75], v[40:43]
    v_mfma_f32_16x16x32_bf16 v[44:47], v[92:95], v[72:75], v[44:47]
    buffer_load_dwordx4 v[72:75], v225, s[64:67], s77 offen offset:0
    v_mfma_f32_16x16x32_bf16 v[56:59], v[88:91], v[76:79], v[56:59]
    buffer_load_dwordx4 v[88:91], v225, s[68:71], s78 offen offset:2048
    v_mfma_f32_16x16x32_bf16 v[60:63], v[92:95], v[76:79], v[60:63]
    buffer_load_dwordx4 v[76:79], v225, s[64:67], s77 offen offset:256
    buffer_load_dwordx4 v[92:95], v225, s[68:71], s78 offen offset:2304
    s_waitcnt vmcnt(32)
    v_mfma_f32_16x16x32_bf16 v[0:3], v[112:115], v[96:99], v[0:3]
    v_mfma_f32_16x16x32_bf16 v[4:7], v[116:119], v[96:99], v[4:7]
    v_mfma_f32_16x16x32_bf16 v[16:19], v[112:115], v[100:103], v[16:19]
    v_mfma_f32_16x16x32_bf16 v[20:23], v[116:119], v[100:103], v[20:23]
    v_mfma_f32_16x16x32_bf16 v[8:11], v[120:123], v[96:99], v[8:11]
    v_mfma_f32_16x16x32_bf16 v[12:15], v[124:127], v[96:99], v[12:15]
    s_add_u32 s56, s46, s49
    s_add_u32 s57, s56, 0x40000
    s_lshl_b32 s58, s49, 1
    s_add_u32 s58, s58, s48
    s_add_u32 s49, s49, 16384
    s_and_b32 s49, s49, 0x3ffff
    buffer_load_dwordx4 v[96:99], v225, s[64:67], s56 offen offset:0
    v_mfma_f32_16x16x32_bf16 v[24:27], v[120:123], v[100:103], v[24:27]
    v_mfma_f32_16x16x32_bf16 v[28:31], v[124:127], v[100:103], v[28:31]
    buffer_load_dwordx4 v[100:103], v225, s[64:67], s56 offen offset:256
    v_mfma_f32_16x16x32_bf16 v[32:35], v[112:115], v[104:107], v[32:35]
    v_mfma_f32_16x16x32_bf16 v[48:51], v[112:115], v[108:111], v[48:51]
    buffer_load_dwordx4 v[112:115], v225, s[68:71], s58 offen offset:0
    v_mfma_f32_16x16x32_bf16 v[36:39], v[116:119], v[104:107], v[36:39]
    v_mfma_f32_16x16x32_bf16 v[52:55], v[116:119], v[108:111], v[52:55]
    buffer_load_dwordx4 v[116:119], v225, s[68:71], s58 offen offset:256
    v_mfma_f32_16x16x32_bf16 v[40:43], v[120:123], v[104:107], v[40:43]
    v_mfma_f32_16x16x32_bf16 v[44:47], v[124:127], v[104:107], v[44:47]
    buffer_load_dwordx4 v[104:107], v225, s[64:67], s57 offen offset:0
    v_mfma_f32_16x16x32_bf16 v[56:59], v[120:123], v[108:111], v[56:59]
    buffer_load_dwordx4 v[120:123], v225, s[68:71], s58 offen offset:2048
    v_mfma_f32_16x16x32_bf16 v[60:63], v[124:127], v[108:111], v[60:63]
    buffer_load_dwordx4 v[108:111], v225, s[64:67], s57 offen offset:256
    buffer_load_dwordx4 v[124:127], v225, s[68:71], s58 offen offset:2304
    buffer_load_dwordx2 v[230:231], v229, s[60:63], 0 offen offset:0
    buffer_load_dwordx2 v[232:233], v229, s[60:63], 0 offen offset:32
    s_waitcnt vmcnt(34)
    v_mfma_f32_16x16x32_bf16 v[0:3], v[144:147], v[128:131], v[0:3]
    v_mfma_f32_16x16x32_bf16 v[4:7], v[148:151], v[128:131], v[4:7]
    v_mfma_f32_16x16x32_bf16 v[16:19], v[144:147], v[132:135], v[16:19]
    v_mfma_f32_16x16x32_bf16 v[20:23], v[148:151], v[132:135], v[20:23]
    v_mfma_f32_16x16x32_bf16 v[8:11], v[152:155], v[128:131], v[8:11]
    v_mfma_f32_16x16x32_bf16 v[12:15], v[156:159], v[128:131], v[12:15]
    s_add_u32 s76, s46, s49
    s_add_u32 s77, s76, 0x40000
    s_lshl_b32 s78, s49, 1
    s_add_u32 s78, s78, s48
    s_add_u32 s49, s49, 16384
    s_and_b32 s49, s49, 0x3ffff
    buffer_load_dwordx4 v[128:131], v225, s[64:67], s76 offen offset:0
    v_mfma_f32_16x16x32_bf16 v[24:27], v[152:155], v[132:135], v[24:27]
    v_mfma_f32_16x16x32_bf16 v[28:31], v[156:159], v[132:135], v[28:31]
    buffer_load_dwordx4 v[132:135], v225, s[64:67], s76 offen offset:256
    v_mfma_f32_16x16x32_bf16 v[32:35], v[144:147], v[136:139], v[32:35]
    v_mfma_f32_16x16x32_bf16 v[48:51], v[144:147], v[140:143], v[48:51]
    buffer_load_dwordx4 v[144:147], v225, s[68:71], s78 offen offset:0
    v_mfma_f32_16x16x32_bf16 v[36:39], v[148:151], v[136:139], v[36:39]
    v_mfma_f32_16x16x32_bf16 v[52:55], v[148:151], v[140:143], v[52:55]
    buffer_load_dwordx4 v[148:151], v225, s[68:71], s78 offen offset:256
    v_mfma_f32_16x16x32_bf16 v[40:43], v[152:155], v[136:139], v[40:43]
    v_mfma_f32_16x16x32_bf16 v[44:47], v[156:159], v[136:139], v[44:47]
    buffer_load_dwordx4 v[136:139], v225, s[64:67], s77 offen offset:0
    v_mfma_f32_16x16x32_bf16 v[56:59], v[152:155], v[140:143], v[56:59]
    buffer_load_dwordx4 v[152:155], v225, s[68:71], s78 offen offset:2048
    v_mfma_f32_16x16x32_bf16 v[60:63], v[156:159], v[140:143], v[60:63]
    buffer_load_dwordx4 v[140:143], v225, s[64:67], s77 offen offset:256
    buffer_load_dwordx4 v[156:159], v225, s[68:71], s78 offen offset:2304
    s_waitcnt vmcnt(34)
    v_mfma_f32_16x16x32_bf16 v[0:3], v[208:211], v[192:195], v[0:3]
    v_mfma_f32_16x16x32_bf16 v[4:7], v[212:215], v[192:195], v[4:7]
    v_mfma_f32_16x16x32_bf16 v[16:19], v[208:211], v[196:199], v[16:19]
    v_mfma_f32_16x16x32_bf16 v[20:23], v[212:215], v[196:199], v[20:23]
    v_mfma_f32_16x16x32_bf16 v[8:11], v[216:219], v[192:195], v[8:11]
    v_mfma_f32_16x16x32_bf16 v[12:15], v[220:223], v[192:195], v[12:15]
    s_add_u32 s56, s46, s49
    s_add_u32 s57, s56, 0x40000
    s_lshl_b32 s58, s49, 1
    s_add_u32 s58, s58, s48
    s_add_u32 s49, s49, 16384
    s_and_b32 s49, s49, 0x3ffff
    buffer_load_dwordx4 v[192:195], v225, s[64:67], s56 offen offset:0
    v_mfma_f32_16x16x32_bf16 v[24:27], v[216:219], v[196:199], v[24:27]
    v_mfma_f32_16x16x32_bf16 v[28:31], v[220:223], v[196:199], v[28:31]
    buffer_load_dwordx4 v[196:199], v225, s[64:67], s56 offen offset:256
    v_mfma_f32_16x16x32_bf16 v[32:35], v[208:211], v[200:203], v[32:35]
    v_mfma_f32_16x16x32_bf16 v[48:51], v[208:211], v[204:207], v[48:51]
    buffer_load_dwordx4 v[208:211], v225, s[68:71], s58 offen offset:0
    v_mfma_f32_16x16x32_bf16 v[36:39], v[212:215], v[200:203], v[36:39]
    v_mfma_f32_16x16x32_bf16 v[52:55], v[212:215], v[204:207], v[52:55]
    buffer_load_dwordx4 v[212:215], v225, s[68:71], s58 offen offset:256
    v_mfma_f32_16x16x32_bf16 v[40:43], v[216:219], v[200:203], v[40:43]
    v_mfma_f32_16x16x32_bf16 v[44:47], v[220:223], v[200:203], v[44:47]
    buffer_load_dwordx4 v[200:203], v225, s[64:67], s57 offen offset:0
    v_mfma_f32_16x16x32_bf16 v[56:59], v[216:219], v[204:207], v[56:59]
    buffer_load_dwordx4 v[216:219], v225, s[68:71], s58 offen offset:2048
    v_mfma_f32_16x16x32_bf16 v[60:63], v[220:223], v[204:207], v[60:63]
    buffer_load_dwordx4 v[204:207], v225, s[64:67], s57 offen offset:256
    buffer_load_dwordx4 v[220:223], v225, s[68:71], s58 offen offset:2304
    s_waitcnt vmcnt(34)
    v_mfma_f32_16x16x32_bf16 v[0:3], v[176:179], v[160:163], v[0:3]
    v_mfma_f32_16x16x32_bf16 v[4:7], v[180:183], v[160:163], v[4:7]
    v_mfma_f32_16x16x32_bf16 v[16:19], v[176:179], v[164:167], v[16:19]
    v_mfma_f32_16x16x32_bf16 v[20:23], v[180:183], v[164:167], v[20:23]
    v_mfma_f32_16x16x32_bf16 v[8:11], v[184:187], v[160:163], v[8:11]
    v_mfma_f32_16x16x32_bf16 v[12:15], v[188:191], v[160:163], v[12:15]
    s_add_u32 s76, s46, s49
    s_add_u32 s77, s76, 0x40000
    s_lshl_b32 s78, s49, 1
    s_add_u32 s78, s78, s48
    s_add_u32 s49, s49, 16384
    s_and_b32 s49, s49, 0x3ffff
    buffer_load_dwordx4 v[160:163], v225, s[64:67], s76 offen offset:0
    v_mfma_f32_16x16x32_bf16 v[24:27], v[184:187], v[164:167], v[24:27]
    v_mfma_f32_16x16x32_bf16 v[28:31], v[188:191], v[164:167], v[28:31]
    buffer_load_dwordx4 v[164:167], v225, s[64:67], s76 offen offset:256
    v_mfma_f32_16x16x32_bf16 v[32:35], v[176:179], v[168:171], v[32:35]
    v_mfma_f32_16x16x32_bf16 v[48:51], v[176:179], v[172:175], v[48:51]
    buffer_load_dwordx4 v[176:179], v225, s[68:71], s78 offen offset:0
    v_mfma_f32_16x16x32_bf16 v[36:39], v[180:183], v[168:171], v[36:39]
    v_mfma_f32_16x16x32_bf16 v[52:55], v[180:183], v[172:175], v[52:55]
    buffer_load_dwordx4 v[180:183], v225, s[68:71], s78 offen offset:256
    v_mfma_f32_16x16x32_bf16 v[40:43], v[184:187], v[168:171], v[40:43]
    v_mfma_f32_16x16x32_bf16 v[44:47], v[188:191], v[168:171], v[44:47]
    buffer_load_dwordx4 v[168:171], v225, s[64:67], s77 offen offset:0
    v_mfma_f32_16x16x32_bf16 v[56:59], v[184:187], v[172:175], v[56:59]
    buffer_load_dwordx4 v[184:187], v225, s[68:71], s78 offen offset:2048
    v_mfma_f32_16x16x32_bf16 v[60:63], v[188:191], v[172:175], v[60:63]
    buffer_load_dwordx4 v[172:175], v225, s[64:67], s77 offen offset:256
    buffer_load_dwordx4 v[188:191], v225, s[68:71], s78 offen offset:2304
    s_waitcnt vmcnt(34)
    v_mfma_f32_16x16x32_bf16 v[0:3], v[80:83], v[64:67], v[0:3]
    v_mfma_f32_16x16x32_bf16 v[4:7], v[84:87], v[64:67], v[4:7]
    v_mfma_f32_16x16x32_bf16 v[16:19], v[80:83], v[68:71], v[16:19]
    v_mfma_f32_16x16x32_bf16 v[20:23], v[84:87], v[68:71], v[20:23]
    v_mfma_f32_16x16x32_bf16 v[8:11], v[88:91], v[64:67], v[8:11]
    v_mfma_f32_16x16x32_bf16 v[12:15], v[92:95], v[64:67], v[12:15]
    s_add_u32 s56, s46, s49
    s_add_u32 s57, s56, 0x40000
    s_lshl_b32 s58, s49, 1
    s_add_u32 s58, s58, s48
    s_add_u32 s49, s49, 16384
    s_and_b32 s49, s49, 0x3ffff
    buffer_load_dwordx4 v[64:67], v225, s[64:67], s56 offen offset:0
    v_mfma_f32_16x16x32_bf16 v[24:27], v[88:91], v[68:71], v[24:27]
    v_mfma_f32_16x16x32_bf16 v[28:31], v[92:95], v[68:71], v[28:31]
    buffer_load_dwordx4 v[68:71], v225, s[64:67], s56 offen offset:256
    v_mfma_f32_16x16x32_bf16 v[32:35], v[80:83], v[72:75], v[32:35]
    v_mfma_f32_16x16x32_bf16 v[48:51], v[80:83], v[76:79], v[48:51]
    buffer_load_dwordx4 v[80:83], v225, s[68:71], s58 offen offset:0
    v_mfma_f32_16x16x32_bf16 v[36:39], v[84:87], v[72:75], v[36:39]
    v_mfma_f32_16x16x32_bf16 v[52:55], v[84:87], v[76:79], v[52:55]
    buffer_load_dwordx4 v[84:87], v225, s[68:71], s58 offen offset:256
    v_mfma_f32_16x16x32_bf16 v[40:43], v[88:91], v[72:75], v[40:43]
    v_mfma_f32_16x16x32_bf16 v[44:47], v[92:95], v[72:75], v[44:47]
    buffer_load_dwordx4 v[72:75], v225, s[64:67], s57 offen offset:0
    v_mfma_f32_16x16x32_bf16 v[56:59], v[88:91], v[76:79], v[56:59]
    buffer_load_dwordx4 v[88:91], v225, s[68:71], s58 offen offset:2048
    v_mfma_f32_16x16x32_bf16 v[60:63], v[92:95], v[76:79], v[60:63]
    buffer_load_dwordx4 v[76:79], v225, s[64:67], s57 offen offset:256
    buffer_load_dwordx4 v[92:95], v225, s[68:71], s58 offen offset:2304
    s_waitcnt vmcnt(34)
    v_mfma_f32_16x16x32_bf16 v[0:3], v[112:115], v[96:99], v[0:3]
    v_mfma_f32_16x16x32_bf16 v[4:7], v[116:119], v[96:99], v[4:7]
    v_mfma_f32_16x16x32_bf16 v[16:19], v[112:115], v[100:103], v[16:19]
    v_mfma_f32_16x16x32_bf16 v[20:23], v[116:119], v[100:103], v[20:23]
    v_mfma_f32_16x16x32_bf16 v[8:11], v[120:123], v[96:99], v[8:11]
    v_mfma_f32_16x16x32_bf16 v[12:15], v[124:127], v[96:99], v[12:15]
    s_add_u32 s76, s46, s49
    s_add_u32 s77, s76, 0x40000
    s_lshl_b32 s78, s49, 1
    s_add_u32 s78, s78, s48
    s_add_u32 s49, s49, 16384
    s_and_b32 s49, s49, 0x3ffff
    buffer_load_dwordx4 v[96:99], v225, s[64:67], s76 offen offset:0
    v_mfma_f32_16x16x32_bf16 v[24:27], v[120:123], v[100:103], v[24:27]
    v_mfma_f32_16x16x32_bf16 v[28:31], v[124:127], v[100:103], v[28:31]
    buffer_load_dwordx4 v[100:103], v225, s[64:67], s76 offen offset:256
    v_mfma_f32_16x16x32_bf16 v[32:35], v[112:115], v[104:107], v[32:35]
    v_mfma_f32_16x16x32_bf16 v[48:51], v[112:115], v[108:111], v[48:51]
    buffer_load_dwordx4 v[112:115], v225, s[68:71], s78 offen offset:0
    v_mfma_f32_16x16x32_bf16 v[36:39], v[116:119], v[104:107], v[36:39]
    v_mfma_f32_16x16x32_bf16 v[52:55], v[116:119], v[108:111], v[52:55]
    buffer_load_dwordx4 v[116:119], v225, s[68:71], s78 offen offset:256
    v_mfma_f32_16x16x32_bf16 v[40:43], v[120:123], v[104:107], v[40:43]
    v_mfma_f32_16x16x32_bf16 v[44:47], v[124:127], v[104:107], v[44:47]
    buffer_load_dwordx4 v[104:107], v225, s[64:67], s77 offen offset:0
    v_mfma_f32_16x16x32_bf16 v[56:59], v[120:123], v[108:111], v[56:59]
    buffer_load_dwordx4 v[120:123], v225, s[68:71], s78 offen offset:2048
    v_mfma_f32_16x16x32_bf16 v[60:63], v[124:127], v[108:111], v[60:63]
    buffer_load_dwordx4 v[108:111], v225, s[64:67], s77 offen offset:256
    buffer_load_dwordx4 v[124:127], v225, s[68:71], s78 offen offset:2304
    s_waitcnt vmcnt(32)
    v_mfma_f32_16x16x32_bf16 v[0:3], v[144:147], v[128:131], v[0:3]
    v_mfma_f32_16x16x32_bf16 v[4:7], v[148:151], v[128:131], v[4:7]
    v_mfma_f32_16x16x32_bf16 v[16:19], v[144:147], v[132:135], v[16:19]
    v_mfma_f32_16x16x32_bf16 v[20:23], v[148:151], v[132:135], v[20:23]
    v_mfma_f32_16x16x32_bf16 v[8:11], v[152:155], v[128:131], v[8:11]
    v_mfma_f32_16x16x32_bf16 v[12:15], v[156:159], v[128:131], v[12:15]
    s_add_u32 s56, s46, s49
    s_add_u32 s57, s56, 0x40000
    s_lshl_b32 s58, s49, 1
    s_add_u32 s58, s58, s48
    s_add_u32 s49, s49, 16384
    s_and_b32 s49, s49, 0x3ffff
    buffer_load_dwordx4 v[128:131], v225, s[64:67], s56 offen offset:0
    v_mfma_f32_16x16x32_bf16 v[24:27], v[152:155], v[132:135], v[24:27]
    v_mfma_f32_16x16x32_bf16 v[28:31], v[156:159], v[132:135], v[28:31]
    buffer_load_dwordx4 v[132:135], v225, s[64:67], s56 offen offset:256
    v_mfma_f32_16x16x32_bf16 v[32:35], v[144:147], v[136:139], v[32:35]
    v_mfma_f32_16x16x32_bf16 v[48:51], v[144:147], v[140:143], v[48:51]
    buffer_load_dwordx4 v[144:147], v225, s[68:71], s58 offen offset:0
    v_mfma_f32_16x16x32_bf16 v[36:39], v[148:151], v[136:139], v[36:39]
    v_mfma_f32_16x16x32_bf16 v[52:55], v[148:151], v[140:143], v[52:55]
    buffer_load_dwordx4 v[148:151], v225, s[68:71], s58 offen offset:256
    v_mfma_f32_16x16x32_bf16 v[40:43], v[152:155], v[136:139], v[40:43]
    v_mfma_f32_16x16x32_bf16 v[44:47], v[156:159], v[136:139], v[44:47]
    buffer_load_dwordx4 v[136:139], v225, s[64:67], s57 offen offset:0
    v_mfma_f32_16x16x32_bf16 v[56:59], v[152:155], v[140:143], v[56:59]
    buffer_load_dwordx4 v[152:155], v225, s[68:71], s58 offen offset:2048
    v_mfma_f32_16x16x32_bf16 v[60:63], v[156:159], v[140:143], v[60:63]
    buffer_load_dwordx4 v[140:143], v225, s[64:67], s57 offen offset:256
    buffer_load_dwordx4 v[156:159], v225, s[68:71], s58 offen offset:2304
    s_waitcnt vmcnt(32)
    v_mfma_f32_16x16x32_bf16 v[0:3], v[208:211], v[192:195], v[0:3]
    v_mfma_f32_16x16x32_bf16 v[4:7], v[212:215], v[192:195], v[4:7]
    v_mfma_f32_16x16x32_bf16 v[16:19], v[208:211], v[196:199], v[16:19]
    v_mfma_f32_16x16x32_bf16 v[20:23], v[212:215], v[196:199], v[20:23]
    v_mfma_f32_16x16x32_bf16 v[8:11], v[216:219], v[192:195], v[8:11]
    v_mfma_f32_16x16x32_bf16 v[12:15], v[220:223], v[192:195], v[12:15]
    s_add_u32 s76, s46, s49
    s_add_u32 s77, s76, 0x40000
    s_lshl_b32 s78, s49, 1
    s_add_u32 s78, s78, s48
    s_add_u32 s49, s49, 16384
    s_and_b32 s49, s49, 0x3ffff
    buffer_load_dwordx4 v[192:195], v225, s[64:67], s76 offen offset:0
    v_mfma_f32_16x16x32_bf16 v[24:27], v[216:219], v[196:199], v[24:27]
    v_mfma_f32_16x16x32_bf16 v[28:31], v[220:223], v[196:199], v[28:31]
    buffer_load_dwordx4 v[196:199], v225, s[64:67], s76 offen offset:256
    v_mfma_f32_16x16x32_bf16 v[32:35], v[208:211], v[200:203], v[32:35]
    v_mfma_f32_16x16x32_bf16 v[48:51], v[208:211], v[204:207], v[48:51]
    buffer_load_dwordx4 v[208:211], v225, s[68:71], s78 offen offset:0
    v_mfma_f32_16x16x32_bf16 v[36:39], v[212:215], v[200:203], v[36:39]
    v_mfma_f32_16x16x32_bf16 v[52:55], v[212:215], v[204:207], v[52:55]
    buffer_load_dwordx4 v[212:215], v225, s[68:71], s78 offen offset:256
    v_mfma_f32_16x16x32_bf16 v[40:43], v[216:219], v[200:203], v[40:43]
    v_mfma_f32_16x16x32_bf16 v[44:47], v[220:223], v[200:203], v[44:47]
    buffer_load_dwordx4 v[200:203], v225, s[64:67], s77 offen offset:0
    v_mfma_f32_16x16x32_bf16 v[56:59], v[216:219], v[204:207], v[56:59]
    buffer_load_dwordx4 v[216:219], v225, s[68:71], s78 offen offset:2048
    v_mfma_f32_16x16x32_bf16 v[60:63], v[220:223], v[204:207], v[60:63]
    buffer_load_dwordx4 v[204:207], v225, s[64:67], s77 offen offset:256
    buffer_load_dwordx4 v[220:223], v225, s[68:71], s78 offen offset:2304
    s_waitcnt vmcnt(32)
    v_mfma_f32_16x16x32_bf16 v[0:3], v[176:179], v[160:163], v[0:3]
    v_mfma_f32_16x16x32_bf16 v[4:7], v[180:183], v[160:163], v[4:7]
    v_mfma_f32_16x16x32_bf16 v[16:19], v[176:179], v[164:167], v[16:19]
    v_mfma_f32_16x16x32_bf16 v[20:23], v[180:183], v[164:167], v[20:23]
    v_mfma_f32_16x16x32_bf16 v[8:11], v[184:187], v[160:163], v[8:11]
    v_mfma_f32_16x16x32_bf16 v[12:15], v[188:191], v[160:163], v[12:15]
    v_mfma_f32_16x16x32_bf16 v[24:27], v[184:187], v[164:167], v[24:27]
    v_mfma_f32_16x16x32_bf16 v[28:31], v[188:191], v[164:167], v[28:31]
    v_mfma_f32_16x16x32_bf16 v[32:35], v[176:179], v[168:171], v[32:35]
    v_mfma_f32_16x16x32_bf16 v[48:51], v[176:179], v[172:175], v[48:51]
    v_mfma_f32_16x16x32_bf16 v[36:39], v[180:183], v[168:171], v[36:39]
    v_mfma_f32_16x16x32_bf16 v[52:55], v[180:183], v[172:175], v[52:55]
    v_mfma_f32_16x16x32_bf16 v[40:43], v[184:187], v[168:171], v[40:43]
    v_mfma_f32_16x16x32_bf16 v[44:47], v[188:191], v[168:171], v[44:47]
    v_mfma_f32_16x16x32_bf16 v[56:59], v[184:187], v[172:175], v[56:59]
    v_mfma_f32_16x16x32_bf16 v[60:63], v[188:191], v[172:175], v[60:63]
    s_barrier
    ds_read_b128 v[160:163], v227 offset:0
    ds_read_b128 v[164:167], v227 offset:1024
    ds_read_b128 v[168:171], v227 offset:16384
    ds_read_b128 v[172:175], v227 offset:17408
    ds_read_b128 v[176:179], v227 offset:32768
    ds_read_b128 v[180:183], v227 offset:33792
    ds_read_b128 v[184:187], v227 offset:49152
    ds_read_b128 v[188:191], v227 offset:50176
    s_waitcnt vmcnt(24)
    v_mfma_f32_16x16x32_bf16 v[0:3], v[80:83], v[64:67], v[0:3]
    v_mfma_f32_16x16x32_bf16 v[4:7], v[84:87], v[64:67], v[4:7]
    v_mfma_f32_16x16x32_bf16 v[16:19], v[80:83], v[68:71], v[16:19]
    v_mfma_f32_16x16x32_bf16 v[20:23], v[84:87], v[68:71], v[20:23]
    v_mfma_f32_16x16x32_bf16 v[8:11], v[88:91], v[64:67], v[8:11]
    v_mfma_f32_16x16x32_bf16 v[12:15], v[92:95], v[64:67], v[12:15]
    v_mfma_f32_16x16x32_bf16 v[24:27], v[88:91], v[68:71], v[24:27]
    v_mfma_f32_16x16x32_bf16 v[28:31], v[92:95], v[68:71], v[28:31]
    v_mfma_f32_16x16x32_bf16 v[32:35], v[80:83], v[72:75], v[32:35]
    v_mfma_f32_16x16x32_bf16 v[48:51], v[80:83], v[76:79], v[48:51]
    v_mfma_f32_16x16x32_bf16 v[36:39], v[84:87], v[72:75], v[36:39]
    v_mfma_f32_16x16x32_bf16 v[52:55], v[84:87], v[76:79], v[52:55]
    v_mfma_f32_16x16x32_bf16 v[40:43], v[88:91], v[72:75], v[40:43]
    v_mfma_f32_16x16x32_bf16 v[44:47], v[92:95], v[72:75], v[44:47]
    v_mfma_f32_16x16x32_bf16 v[56:59], v[88:91], v[76:79], v[56:59]
    v_mfma_f32_16x16x32_bf16 v[60:63], v[92:95], v[76:79], v[60:63]
    s_waitcnt lgkmcnt(6)
    s_waitcnt lgkmcnt(4)
    v_add_f32 v236, v160, v168
    v_add_f32 v237, v161, v169
    v_add_f32 v238, v162, v170
    v_add_f32 v239, v163, v171
    v_add_f32 v240, v164, v172
    v_add_f32 v241, v165, v173
    v_add_f32 v242, v166, v174
    v_add_f32 v243, v167, v175
    s_waitcnt lgkmcnt(2)
    v_add_f32 v236, v236, v176
    v_add_f32 v237, v237, v177
    v_add_f32 v238, v238, v178
    v_add_f32 v239, v239, v179
    v_add_f32 v240, v240, v180
    v_add_f32 v241, v241, v181
    v_add_f32 v242, v242, v182
    v_add_f32 v243, v243, v183
    s_waitcnt lgkmcnt(0)
    v_add_f32 v236, v236, v184
    v_add_f32 v237, v237, v185
    v_add_f32 v238, v238, v186
    v_add_f32 v239, v239, v187
    v_add_f32 v240, v240, v188
    v_add_f32 v241, v241, v189
    v_add_f32 v242, v242, v190
    v_add_f32 v243, v243, v191
    ds_read_b128 v[64:67], v228 offset:0
    ds_read_b128 v[68:71], v228 offset:1024
    ds_read_b128 v[72:75], v228 offset:16384
    ds_read_b128 v[76:79], v228 offset:17408
    ds_read_b128 v[80:83], v228 offset:32768
    ds_read_b128 v[84:87], v228 offset:33792
    ds_read_b128 v[88:91], v228 offset:49152
    ds_read_b128 v[92:95], v228 offset:50176
    s_waitcnt vmcnt(16)
    v_mfma_f32_16x16x32_bf16 v[0:3], v[112:115], v[96:99], v[0:3]
    v_mfma_f32_16x16x32_bf16 v[4:7], v[116:119], v[96:99], v[4:7]
    v_mfma_f32_16x16x32_bf16 v[16:19], v[112:115], v[100:103], v[16:19]
    v_mfma_f32_16x16x32_bf16 v[20:23], v[116:119], v[100:103], v[20:23]
    v_mfma_f32_16x16x32_bf16 v[8:11], v[120:123], v[96:99], v[8:11]
    v_mfma_f32_16x16x32_bf16 v[12:15], v[124:127], v[96:99], v[12:15]
    v_mfma_f32_16x16x32_bf16 v[24:27], v[120:123], v[100:103], v[24:27]
    v_mfma_f32_16x16x32_bf16 v[28:31], v[124:127], v[100:103], v[28:31]
    v_mfma_f32_16x16x32_bf16 v[32:35], v[112:115], v[104:107], v[32:35]
    v_mfma_f32_16x16x32_bf16 v[48:51], v[112:115], v[108:111], v[48:51]
    v_mfma_f32_16x16x32_bf16 v[36:39], v[116:119], v[104:107], v[36:39]
    v_mfma_f32_16x16x32_bf16 v[52:55], v[116:119], v[108:111], v[52:55]
    v_mfma_f32_16x16x32_bf16 v[40:43], v[120:123], v[104:107], v[40:43]
    v_mfma_f32_16x16x32_bf16 v[44:47], v[124:127], v[104:107], v[44:47]
    v_mfma_f32_16x16x32_bf16 v[56:59], v[120:123], v[108:111], v[56:59]
    v_mfma_f32_16x16x32_bf16 v[60:63], v[124:127], v[108:111], v[60:63]
    s_waitcnt lgkmcnt(6)
    v_add_f32 v236, v236, v64
    v_add_f32 v237, v237, v65
    v_add_f32 v238, v238, v66
    v_add_f32 v239, v239, v67
    v_add_f32 v240, v240, v68
    v_add_f32 v241, v241, v69
    v_add_f32 v242, v242, v70
    v_add_f32 v243, v243, v71
    s_waitcnt lgkmcnt(4)
    v_add_f32 v236, v236, v72
    v_add_f32 v237, v237, v73
    v_add_f32 v238, v238, v74
    v_add_f32 v239, v239, v75
    v_add_f32 v240, v240, v76
    v_add_f32 v241, v241, v77
    v_add_f32 v242, v242, v78
    v_add_f32 v243, v243, v79
    s_waitcnt lgkmcnt(2)
    v_add_f32 v236, v236, v80
    v_add_f32 v237, v237, v81
    v_add_f32 v238, v238, v82
    v_add_f32 v239, v239, v83
    v_add_f32 v240, v240, v84
    v_add_f32 v241, v241, v85
    v_add_f32 v242, v242, v86
    v_add_f32 v243, v243, v87
    s_waitcnt lgkmcnt(0)
    v_add_f32 v236, v236, v88
    v_add_f32 v237, v237, v89
    v_add_f32 v238, v238, v90
    v_add_f32 v239, v239, v91
    v_add_f32 v240, v240, v92
    v_add_f32 v241, v241, v93
    v_add_f32 v242, v242, v94
    v_add_f32 v243, v243, v95
    s_barrier
    s_waitcnt vmcnt(8)
    v_mfma_f32_16x16x32_bf16 v[0:3], v[144:147], v[128:131], v[0:3]
    v_mfma_f32_16x16x32_bf16 v[4:7], v[148:151], v[128:131], v[4:7]
    v_mfma_f32_16x16x32_bf16 v[16:19], v[144:147], v[132:135], v[16:19]
    v_mfma_f32_16x16x32_bf16 v[20:23], v[148:151], v[132:135], v[20:23]
    v_mfma_f32_16x16x32_bf16 v[8:11], v[152:155], v[128:131], v[8:11]
    v_mfma_f32_16x16x32_bf16 v[12:15], v[156:159], v[128:131], v[12:15]
    v_mfma_f32_16x16x32_bf16 v[24:27], v[152:155], v[132:135], v[24:27]
    v_mfma_f32_16x16x32_bf16 v[28:31], v[156:159], v[132:135], v[28:31]
    v_mfma_f32_16x16x32_bf16 v[32:35], v[144:147], v[136:139], v[32:35]
    v_mfma_f32_16x16x32_bf16 v[48:51], v[144:147], v[140:143], v[48:51]
    v_mfma_f32_16x16x32_bf16 v[36:39], v[148:151], v[136:139], v[36:39]
    v_mfma_f32_16x16x32_bf16 v[52:55], v[148:151], v[140:143], v[52:55]
    v_mfma_f32_16x16x32_bf16 v[40:43], v[152:155], v[136:139], v[40:43]
    v_mfma_f32_16x16x32_bf16 v[44:47], v[156:159], v[136:139], v[44:47]
    v_mfma_f32_16x16x32_bf16 v[56:59], v[152:155], v[140:143], v[56:59]
    v_mfma_f32_16x16x32_bf16 v[60:63], v[156:159], v[140:143], v[60:63]
    s_waitcnt vmcnt(0)
    v_mfma_f32_16x16x32_bf16 v[0:3], v[208:211], v[192:195], v[0:3]
    v_mfma_f32_16x16x32_bf16 v[4:7], v[212:215], v[192:195], v[4:7]
    v_mfma_f32_16x16x32_bf16 v[16:19], v[208:211], v[196:199], v[16:19]
    v_mfma_f32_16x16x32_bf16 v[20:23], v[212:215], v[196:199], v[20:23]
    v_mfma_f32_16x16x32_bf16 v[8:11], v[216:219], v[192:195], v[8:11]
    v_mfma_f32_16x16x32_bf16 v[12:15], v[220:223], v[192:195], v[12:15]
    v_mfma_f32_16x16x32_bf16 v[24:27], v[216:219], v[196:199], v[24:27]
    v_mfma_f32_16x16x32_bf16 v[28:31], v[220:223], v[196:199], v[28:31]
    v_mfma_f32_16x16x32_bf16 v[32:35], v[208:211], v[200:203], v[32:35]
    v_mfma_f32_16x16x32_bf16 v[48:51], v[208:211], v[204:207], v[48:51]
    v_mfma_f32_16x16x32_bf16 v[36:39], v[212:215], v[200:203], v[36:39]
    v_mfma_f32_16x16x32_bf16 v[52:55], v[212:215], v[204:207], v[52:55]
    v_mfma_f32_16x16x32_bf16 v[40:43], v[216:219], v[200:203], v[40:43]
    v_mfma_f32_16x16x32_bf16 v[44:47], v[220:223], v[200:203], v[44:47]
    v_mfma_f32_16x16x32_bf16 v[56:59], v[216:219], v[204:207], v[56:59]
    v_mfma_f32_16x16x32_bf16 v[60:63], v[220:223], v[204:207], v[60:63]
    ds_write_b128 v226, v[0:3] offset:0
    ds_write_b128 v226, v[4:7] offset:1024
    ds_write_b128 v226, v[8:11] offset:2048
    ds_write_b128 v226, v[12:15] offset:3072
    ds_write_b128 v226, v[16:19] offset:4096
    ds_write_b128 v226, v[20:23] offset:5120
    ds_write_b128 v226, v[24:27] offset:6144
    ds_write_b128 v226, v[28:31] offset:7168
    ds_write_b128 v226, v[32:35] offset:8192
    ds_write_b128 v226, v[36:39] offset:9216
    ds_write_b128 v226, v[40:43] offset:10240
    ds_write_b128 v226, v[44:47] offset:11264
    ds_write_b128 v226, v[48:51] offset:12288
    ds_write_b128 v226, v[52:55] offset:13312
    ds_write_b128 v226, v[56:59] offset:14336
    ds_write_b128 v226, v[60:63] offset:15360
    s_waitcnt lgkmcnt(0)
    s_barrier
    ds_read_b128 v[64:67], v227 offset:0
    ds_read_b128 v[68:71], v227 offset:1024
    ds_read_b128 v[72:75], v227 offset:16384
    ds_read_b128 v[76:79], v227 offset:17408
    ds_read_b128 v[80:83], v227 offset:32768
    ds_read_b128 v[84:87], v227 offset:33792
    ds_read_b128 v[88:91], v227 offset:49152
    ds_read_b128 v[92:95], v227 offset:50176
    ds_read_b128 v[96:99], v228 offset:0
    ds_read_b128 v[100:103], v228 offset:1024
    ds_read_b128 v[104:107], v228 offset:16384
    ds_read_b128 v[108:111], v228 offset:17408
    ds_read_b128 v[112:115], v228 offset:32768
    ds_read_b128 v[116:119], v228 offset:33792
    ds_read_b128 v[120:123], v228 offset:49152
    ds_read_b128 v[124:127], v228 offset:50176
    v_cvt_pk_bf16_f32 v246, v236, v237
    v_cvt_pk_bf16_f32 v247, v238, v239
    v_cvt_pk_bf16_f32 v248, v240, v241
    v_cvt_pk_bf16_f32 v249, v242, v243
    v_lshlrev_b32 v236, 16, v246
    v_and_b32 v237, 0xffff0000, v246
    v_lshlrev_b32 v238, 16, v247
    v_and_b32 v239, 0xffff0000, v247
    v_lshlrev_b32 v240, 16, v248
    v_and_b32 v241, 0xffff0000, v248
    v_lshlrev_b32 v242, 16, v249
    v_and_b32 v243, 0xffff0000, v249
    v_mul_f32 v136, 0xbfb8aa3b, v236
    v_mul_f32 v137, 0xbfb8aa3b, v237
    v_mul_f32 v138, 0xbfb8aa3b, v238
    v_mul_f32 v139, 0xbfb8aa3b, v239
    v_mul_f32 v140, 0xbfb8aa3b, v240
    v_mul_f32 v141, 0xbfb8aa3b, v241
    v_mul_f32 v142, 0xbfb8aa3b, v242
    v_mul_f32 v143, 0xbfb8aa3b, v243
    v_exp_f32 v136, v136
    v_exp_f32 v137, v137
    v_exp_f32 v138, v138
    v_exp_f32 v139, v139
    v_exp_f32 v140, v140
    v_exp_f32 v141, v141
    v_exp_f32 v142, v142
    v_exp_f32 v143, v143
    v_add_f32 v136, 1.0, v136
    v_add_f32 v137, 1.0, v137
    v_add_f32 v138, 1.0, v138
    v_add_f32 v139, 1.0, v139
    v_add_f32 v140, 1.0, v140
    v_add_f32 v141, 1.0, v141
    v_add_f32 v142, 1.0, v142
    v_add_f32 v143, 1.0, v143
    v_rcp_f32 v136, v136
    v_rcp_f32 v137, v137
    v_rcp_f32 v138, v138
    v_rcp_f32 v139, v139
    v_rcp_f32 v140, v140
    v_rcp_f32 v141, v141
    v_rcp_f32 v142, v142
    v_rcp_f32 v143, v143
    v_mul_f32 v236, v236, v136
    v_mul_f32 v237, v237, v137
    v_mul_f32 v238, v238, v138
    v_mul_f32 v239, v239, v139
    v_mul_f32 v240, v240, v140
    v_mul_f32 v241, v241, v141
    v_mul_f32 v242, v242, v142
    v_mul_f32 v243, v243, v143
    v_cvt_pk_bf16_f32 v246, v236, v237
    v_cvt_pk_bf16_f32 v247, v238, v239
    v_cvt_pk_bf16_f32 v248, v240, v241
    v_cvt_pk_bf16_f32 v249, v242, v243
    v_lshlrev_b32 v236, 16, v246
    v_and_b32 v237, 0xffff0000, v246
    v_lshlrev_b32 v238, 16, v247
    v_and_b32 v239, 0xffff0000, v247
    v_lshlrev_b32 v240, 16, v248
    v_and_b32 v241, 0xffff0000, v248
    v_lshlrev_b32 v242, 16, v249
    v_and_b32 v243, 0xffff0000, v249
    v_lshlrev_b32 v144, 16, v230
    v_and_b32 v145, 0xffff0000, v230
    v_lshlrev_b32 v146, 16, v231
    v_and_b32 v147, 0xffff0000, v231
    v_lshlrev_b32 v148, 16, v232
    v_and_b32 v149, 0xffff0000, v232
    v_lshlrev_b32 v150, 16, v233
    v_and_b32 v151, 0xffff0000, v233
    s_waitcnt lgkmcnt(14)
    s_waitcnt lgkmcnt(12)
    v_add_f32 v128, v64, v72
    v_add_f32 v129, v65, v73
    v_add_f32 v130, v66, v74
    v_add_f32 v131, v67, v75
    v_add_f32 v132, v68, v76
    v_add_f32 v133, v69, v77
    v_add_f32 v134, v70, v78
    v_add_f32 v135, v71, v79
    s_waitcnt lgkmcnt(10)
    v_add_f32 v128, v128, v80
    v_add_f32 v129, v129, v81
    v_add_f32 v130, v130, v82
    v_add_f32 v131, v131, v83
    v_add_f32 v132, v132, v84
    v_add_f32 v133, v133, v85
    v_add_f32 v134, v134, v86
    v_add_f32 v135, v135, v87
    s_waitcnt lgkmcnt(8)
    v_add_f32 v128, v128, v88
    v_add_f32 v129, v129, v89
    v_add_f32 v130, v130, v90
    v_add_f32 v131, v131, v91
    v_add_f32 v132, v132, v92
    v_add_f32 v133, v133, v93
    v_add_f32 v134, v134, v94
    v_add_f32 v135, v135, v95
    s_waitcnt lgkmcnt(6)
    v_add_f32 v128, v128, v96
    v_add_f32 v129, v129, v97
    v_add_f32 v130, v130, v98
    v_add_f32 v131, v131, v99
    v_add_f32 v132, v132, v100
    v_add_f32 v133, v133, v101
    v_add_f32 v134, v134, v102
    v_add_f32 v135, v135, v103
    s_waitcnt lgkmcnt(4)
    v_add_f32 v128, v128, v104
    v_add_f32 v129, v129, v105
    v_add_f32 v130, v130, v106
    v_add_f32 v131, v131, v107
    v_add_f32 v132, v132, v108
    v_add_f32 v133, v133, v109
    v_add_f32 v134, v134, v110
    v_add_f32 v135, v135, v111
    s_waitcnt lgkmcnt(2)
    v_add_f32 v128, v128, v112
    v_add_f32 v129, v129, v113
    v_add_f32 v130, v130, v114
    v_add_f32 v131, v131, v115
    v_add_f32 v132, v132, v116
    v_add_f32 v133, v133, v117
    v_add_f32 v134, v134, v118
    v_add_f32 v135, v135, v119
    s_waitcnt lgkmcnt(0)
    v_add_f32 v128, v128, v120
    v_add_f32 v129, v129, v121
    v_add_f32 v130, v130, v122
    v_add_f32 v131, v131, v123
    v_add_f32 v132, v132, v124
    v_add_f32 v133, v133, v125
    v_add_f32 v134, v134, v126
    v_add_f32 v135, v135, v127
    v_cvt_pk_bf16_f32 v246, v128, v129
    v_cvt_pk_bf16_f32 v247, v130, v131
    v_cvt_pk_bf16_f32 v248, v132, v133
    v_cvt_pk_bf16_f32 v249, v134, v135
    v_lshlrev_b32 v128, 16, v246
    v_and_b32 v129, 0xffff0000, v246
    v_lshlrev_b32 v130, 16, v247
    v_and_b32 v131, 0xffff0000, v247
    v_lshlrev_b32 v132, 16, v248
    v_and_b32 v133, 0xffff0000, v248
    v_lshlrev_b32 v134, 16, v249
    v_and_b32 v135, 0xffff0000, v249
    v_mul_f32 v128, v128, v236
    v_mul_f32 v129, v129, v237
    v_mul_f32 v130, v130, v238
    v_mul_f32 v131, v131, v239
    v_mul_f32 v132, v132, v240
    v_mul_f32 v133, v133, v241
    v_mul_f32 v134, v134, v242
    v_mul_f32 v135, v135, v243
    v_cvt_pk_bf16_f32 v246, v128, v129
    v_cvt_pk_bf16_f32 v247, v130, v131
    v_cvt_pk_bf16_f32 v248, v132, v133
    v_cvt_pk_bf16_f32 v249, v134, v135
    v_lshlrev_b32 v128, 16, v246
    v_and_b32 v129, 0xffff0000, v246
    v_lshlrev_b32 v130, 16, v247
    v_and_b32 v131, 0xffff0000, v247
    v_lshlrev_b32 v132, 16, v248
    v_and_b32 v133, 0xffff0000, v248
    v_lshlrev_b32 v134, 16, v249
    v_and_b32 v135, 0xffff0000, v249
    v_add_f32 v128, v128, v144
    v_add_f32 v129, v129, v145
    v_add_f32 v130, v130, v146
    v_add_f32 v131, v131, v147
    v_add_f32 v132, v132, v148
    v_add_f32 v133, v133, v149
    v_add_f32 v134, v134, v150
    v_add_f32 v135, v135, v151
    v_cvt_pk_bf16_f32 v230, v128, v129
    v_cvt_pk_bf16_f32 v231, v130, v131
    v_cvt_pk_bf16_f32 v232, v132, v133
    v_cvt_pk_bf16_f32 v233, v134, v135
    buffer_store_dwordx2 v[230:231], v229, s[72:75], 0 offen offset:0
    buffer_store_dwordx2 v[232:233], v229, s[72:75], 0 offen offset:32
k2_kernel_end:
    s_endpgm
.section .rodata,"a"
.p2align 6
.amdhsa_kernel k2_kernel
  .amdhsa_next_free_vgpr 256
  .amdhsa_next_free_sgpr 102
  .amdhsa_accum_offset 256
  .amdhsa_group_segment_fixed_size 0
  .amdhsa_kernarg_size 104
  .amdhsa_user_sgpr_count 2
  .amdhsa_user_sgpr_kernarg_segment_ptr 1
  .amdhsa_system_sgpr_workgroup_id_x 1
.end_amdhsa_kernel
```
